```python
import torch

def _softmax(x, axis=-1):
    return torch.softmax(x, dim=axis)
def _gelu(x):
    return torch.nn.functional.gelu(x, approximate="tanh")
def _silu(x):
    return torch.nn.functional.silu(x)
def _sigmoid(x):
    return torch.sigmoid(x)
def _layernorm(x, axis=-1, eps=1e-5):
    m = x.mean(dim=axis, keepdim=True)
    v = x.var(dim=axis, keepdim=True, unbiased=False)
    return (x - m) / torch.sqrt(v + eps)
def _scatter_add(tgt, idx, src, axis=0):
    return tgt.clone().index_add_(axis, idx, src)
def _segment_sum(src, seg, n):
    out = torch.zeros((n,) + src.shape[1:], dtype=src.dtype)
    return out.index_add_(0, seg, src)
def _pad(x, pw):
    flat = tuple(v for pair in reversed(pw) for v in pair)
    return torch.nn.functional.pad(x, flat)

kernel_name = 'parallel_sum__softmax_full_mha__moe_arch_mod__prompt'

def setup_inputs():

    _w = (lambda a: (lambda t: t.to(torch.bfloat16) if t.is_floating_point() else t)(torch.as_tensor(a)))
    def _A_setup():
        B, S, D = 1, 2048, 640
        return {
            "x": _w((lambda *s: torch.randn(*s, dtype=torch.bfloat16) * 0.05)(B, S, D)),
            "wqkv": _w((lambda *s: torch.randn(*s, dtype=torch.bfloat16) * 0.2)(D, 3 * D)),
            "wo": _w((lambda *s: torch.randn(*s, dtype=torch.bfloat16) * 0.2)(D, D)),
        }
    _A_in = _A_setup()

    def _B_setup():
        B, S, D, F, C = 1, 2048, 640, 1728, 2
        return {
            "x": _w((lambda *s: torch.randn(*s, dtype=torch.bfloat16) * 0.05)(B, S, D)),
            "w_r": _w((lambda *s: torch.randn(*s, dtype=torch.bfloat16) * 0.8)(D)),
            "w_gate": _w((lambda *s: torch.randn(*s, dtype=torch.bfloat16) * 0.2)(D, F)),
            "w_up": _w((lambda *s: torch.randn(*s, dtype=torch.bfloat16) * 0.2)(D, F)),
            "w_down": _w((lambda *s: torch.randn(*s, dtype=torch.bfloat16) * 0.2)(F, D)),
        }
    _B_in = _B_setup()

    return {
        "A_x": _A_in["x"],
        "A_wqkv": _A_in["wqkv"],
        "A_wo": _A_in["wo"],
        "B_x": _B_in["x"],
        "B_w_r": _B_in["w_r"],
        "B_w_gate": _B_in["w_gate"],
        "B_w_up": _B_in["w_up"],
        "B_w_down": _B_in["w_down"],
    }

def reference(A_x, A_wqkv, A_wo, B_x, B_w_r, B_w_gate, B_w_up, B_w_down):
    def _A_ref(x, wqkv, wo):
        B, S, D = x.shape
        H = 32; Dh = D // H
        qkv = (lambda x, *d: x.permute(*d))((x @ wqkv).reshape(B, S, 3, H, Dh), 2, 0, 3, 1, 4)
        q, k, v = qkv[0], qkv[1], qkv[2]
        scale = Dh ** -0.5
        scores = torch.einsum("bhqd,bhkd->bhqk", q, k) * scale
        p = _softmax(scores, axis=-1)
        o = torch.einsum("bhqk,bhkd->bhqd", p, v)
        return (lambda x, *d: x.permute(*d))(o, 0, 2, 1, 3).reshape(B, S, D) @ wo

    def _B_ref(x, w_r, w_gate, w_up, w_down):
        B, S, D = x.shape
        C = 2
        r = x @ w_r
        idx = torch.argsort(-r, axis=-1)[:, :C]
        idx_e = (lambda x, n, axis: torch.repeat_interleave(x, n, dim=axis))(idx.reshape(B, C, 1), D, axis=2)
        x_sel = (lambda x, i, axis: torch.take_along_dim(x, i, dim=axis))(x, idx_e, axis=1)
        g = _silu(x_sel @ w_gate)
        u = x_sel @ w_up
        y = (g * u) @ w_down
        r_sel = _sigmoid((lambda x, i, axis: torch.take_along_dim(x, i, dim=axis))(r, idx, axis=1))
        y = y * r_sel.reshape(B, C, 1)
        b_off = (torch.arange(B) * S).reshape(B, 1)
        flat_idx = (idx + b_off).reshape(B * C)
        zero = (x * 0.0).reshape(B * S, D)
        upd = _scatter_add(zero, flat_idx, y.reshape(B * C, D), axis=0)
        return x + upd.reshape(B, S, D)

    x = A_x
    xn = _layernorm(x, axis=-1)
    return x + _A_ref(xn, A_wqkv, A_wo) + _B_ref(xn, B_w_r, B_w_gate, B_w_up, B_w_down)
```

```asm
; @launch kernel=k1_kernel grid=(256,1,1) block=(512,1,1) lds=152064
; @launch kernel=k2_kernel grid=(256,1,1) block=(576,1,1) lds=163840
.amdgcn_target "amdgcn-amd-amdhsa--gfx950"
.text
.globl k1_kernel
.p2align 8
.type k1_kernel,@function
k1_kernel:
    s_cmp_ge_u32 s2, 256
    s_cbranch_scc1 LK1_exit
    s_load_dwordx4 s[44:47], s[0:1], 0
    s_load_dwordx2 s[50:51], s[0:1], 32
    s_load_dwordx2 s[48:49], s[0:1], 16
    s_load_dwordx2 s[52:53], s[0:1], 80
    s_and_b32 s16, s2, 7
    s_lshl_b32 s16, s16, 2
    s_lshr_b32 s24, s2, 6
    s_add_u32 s16, s16, s24
    s_bfe_u32 s17, s2, 0x30003
    v_and_b32 v1, 63, v0
    v_lshrrev_b32 v28, 6, v0
    v_and_b32 v2, 15, v0
    v_bfe_u32 v3, v0, 4, 2
    v_readfirstlane_b32 s18, v28
    s_mov_b32 s30, 0x05040100
    s_mov_b32 s31, 0x07060302
    s_lshl_b32 s24, s16, 6
    s_and_b32 s25, s18, 3
    s_lshl_b32 s25, s25, 4
    s_add_u32 s24, s24, s25
    v_add_u32 v28, s24, v3
    v_mul_u32_u24 v5, 0x500, v28
    v_lshl_add_u32 v5, v2, 4, v5
    s_lshr_b32 s41, s18, 2
    s_and_b32 s28, s18, 3
    s_lshl_b32 s19, s17, 2
    s_add_u32 s19, s19, s28
    s_lshl_b32 s28, s19, 7
    s_mul_i32 s29, s41, 307200
    s_add_u32 s28, s28, s29
    s_mov_b32 s29, 614400
    v_mul_lo_u32 v4, v3, s29
    v_bfe_u32 v29, v2, 2, 1
    v_mul_u32_u24 v30, 3840, v29
    v_add_u32 v4, v4, v30
    v_lshrrev_b32 v30, 3, v2
    v_lshl_add_u32 v4, v30, 6, v4
    v_and_b32 v30, 3, v2
    v_lshl_add_u32 v4, v30, 4, v4
    v_add_u32 v4, s28, v4
    v_cmp_eq_u32 vcc, 1, v29
    v_mov_b32 v252, 0x05040100
    v_mov_b32 v30, 0x01000504
    v_cndmask_b32 v252, v252, v30, vcc
    v_mov_b32 v253, 0x07060302
    v_mov_b32 v30, 0x03020706
    v_cndmask_b32 v253, v253, v30, vcc
    s_mov_b32 s20, 0
    s_mov_b32 s21, 7680
    s_mov_b32 s22, 15360
    s_mov_b32 s23, 23040
    s_waitcnt lgkmcnt(0)
    s_mov_b32 s4, s44
    s_mov_b32 s5, s45
    s_mov_b32 s6, 2621440
    s_mov_b32 s7, 0x00020000
    s_mov_b32 s8, s46
    s_mov_b32 s9, s47
    s_mov_b32 s10, 2457600
    s_mov_b32 s11, 0x00020000
    s_mov_b32 s36, s50
    s_mov_b32 s37, s51
    s_mov_b32 s38, 1280
    s_mov_b32 s39, 0x00020000
    s_mov_b32 s12, s52
    s_mov_b32 s13, s53
    s_mov_b32 s14, 16777216
    s_mov_b32 s15, 0x00020000
    s_cmp_ge_u32 s19, 30
    s_cselect_b32 s10, 0, s10
    s_cmp_lg_u32 s41, 0
    s_cbranch_scc1 LK1_ld1
    s_mov_b32 s26, 0
    buffer_load_dwordx4 v[168:171], v5, s[4:7], s26 offen offset:0
    buffer_load_dwordx4 v[172:175], v5, s[4:7], s26 offen offset:256
    buffer_load_dwordx4 v[176:179], v5, s[4:7], s26 offen offset:512
    buffer_load_dwordx4 v[180:183], v5, s[4:7], s26 offen offset:768
    buffer_load_dwordx4 v[184:187], v5, s[4:7], s26 offen offset:1024
    s_mov_b32 s26, 5120
    buffer_load_dwordx4 v[188:191], v5, s[4:7], s26 offen offset:0
    buffer_load_dwordx4 v[192:195], v5, s[4:7], s26 offen offset:256
    buffer_load_dwordx4 v[196:199], v5, s[4:7], s26 offen offset:512
    buffer_load_dwordx4 v[200:203], v5, s[4:7], s26 offen offset:768
    buffer_load_dwordx4 v[204:207], v5, s[4:7], s26 offen offset:1024
    s_mov_b32 s26, 10240
    buffer_load_dwordx4 v[208:211], v5, s[4:7], s26 offen offset:0
    buffer_load_dwordx4 v[212:215], v5, s[4:7], s26 offen offset:256
    buffer_load_dwordx4 v[216:219], v5, s[4:7], s26 offen offset:512
    buffer_load_dwordx4 v[220:223], v5, s[4:7], s26 offen offset:768
    buffer_load_dwordx4 v[224:227], v5, s[4:7], s26 offen offset:1024
    s_mov_b32 s26, 15360
    buffer_load_dwordx4 v[228:231], v5, s[4:7], s26 offen offset:0
    buffer_load_dwordx4 v[232:235], v5, s[4:7], s26 offen offset:256
    buffer_load_dwordx4 v[236:239], v5, s[4:7], s26 offen offset:512
    buffer_load_dwordx4 v[240:243], v5, s[4:7], s26 offen offset:768
    buffer_load_dwordx4 v[244:247], v5, s[4:7], s26 offen offset:1024
    s_barrier
    buffer_load_dwordx4 v[40:43], v4, s[8:11], s20 offen
    buffer_load_dwordx4 v[44:47], v4, s[8:11], s21 offen
    buffer_load_dwordx4 v[48:51], v4, s[8:11], s22 offen
    buffer_load_dwordx4 v[52:55], v4, s[8:11], s23 offen
    s_add_u32 s20, s20, 30720
    s_add_u32 s21, s21, 30720
    s_add_u32 s22, s22, 30720
    s_add_u32 s23, s23, 30720
    buffer_load_dwordx4 v[56:59], v4, s[8:11], s20 offen
    buffer_load_dwordx4 v[60:63], v4, s[8:11], s21 offen
    buffer_load_dwordx4 v[64:67], v4, s[8:11], s22 offen
    buffer_load_dwordx4 v[68:71], v4, s[8:11], s23 offen
    s_add_u32 s20, s20, 30720
    s_add_u32 s21, s21, 30720
    s_add_u32 s22, s22, 30720
    s_add_u32 s23, s23, 30720
    s_branch LK1_ld2
LK1_ld1:
    s_barrier
    s_cmp_ge_u32 s18, 6
    s_cbranch_scc1 LK1_nowarm
    s_mul_i32 s26, s2, 9600
    s_and_b32 s27, s18, 1
    s_lshl_b32 s27, s27, 13
    s_add_u32 s26, s26, s27
    s_mov_b32 s60, s46
    s_mov_b32 s61, s47
    s_mov_b32 s62, 2457600
    s_mov_b32 s63, 0x00020000
    v_lshlrev_b32 v31, 7, v1
    s_cmp_eq_u32 s18, 4
    s_cbranch_scc1 LK1_w64
    s_mov_b32 exec_lo, 0x7ff
    s_mov_b32 exec_hi, 0
LK1_w64:
    buffer_load_dword v254, v31, s[60:63], s26 offen
    s_mov_b64 exec, -1
LK1_nowarm:
    buffer_load_dwordx4 v[40:43], v4, s[8:11], s20 offen
    buffer_load_dwordx4 v[44:47], v4, s[8:11], s21 offen
    buffer_load_dwordx4 v[48:51], v4, s[8:11], s22 offen
    buffer_load_dwordx4 v[52:55], v4, s[8:11], s23 offen
    s_add_u32 s20, s20, 30720
    s_add_u32 s21, s21, 30720
    s_add_u32 s22, s22, 30720
    s_add_u32 s23, s23, 30720
    buffer_load_dwordx4 v[56:59], v4, s[8:11], s20 offen
    buffer_load_dwordx4 v[60:63], v4, s[8:11], s21 offen
    buffer_load_dwordx4 v[64:67], v4, s[8:11], s22 offen
    buffer_load_dwordx4 v[68:71], v4, s[8:11], s23 offen
    s_add_u32 s20, s20, 30720
    s_add_u32 s21, s21, 30720
    s_add_u32 s22, s22, 30720
    s_add_u32 s23, s23, 30720
    buffer_load_dwordx4 v[72:75], v4, s[8:11], s20 offen
    buffer_load_dwordx4 v[76:79], v4, s[8:11], s21 offen
    buffer_load_dwordx4 v[80:83], v4, s[8:11], s22 offen
    buffer_load_dwordx4 v[84:87], v4, s[8:11], s23 offen
    s_add_u32 s20, s20, 30720
    s_add_u32 s21, s21, 30720
    s_add_u32 s22, s22, 30720
    s_add_u32 s23, s23, 30720
    buffer_load_dwordx4 v[88:91], v4, s[8:11], s20 offen
    buffer_load_dwordx4 v[92:95], v4, s[8:11], s21 offen
    buffer_load_dwordx4 v[96:99], v4, s[8:11], s22 offen
    buffer_load_dwordx4 v[100:103], v4, s[8:11], s23 offen
    s_add_u32 s20, s20, 30720
    s_add_u32 s21, s21, 30720
    s_add_u32 s22, s22, 30720
    s_add_u32 s23, s23, 30720
    buffer_load_dwordx4 v[104:107], v4, s[8:11], s20 offen
    buffer_load_dwordx4 v[108:111], v4, s[8:11], s21 offen
    buffer_load_dwordx4 v[112:115], v4, s[8:11], s22 offen
    buffer_load_dwordx4 v[116:119], v4, s[8:11], s23 offen
    s_add_u32 s20, s20, 30720
    s_add_u32 s21, s21, 30720
    s_add_u32 s22, s22, 30720
    s_add_u32 s23, s23, 30720
    buffer_load_dwordx4 v[120:123], v4, s[8:11], s20 offen
    buffer_load_dwordx4 v[124:127], v4, s[8:11], s21 offen
    buffer_load_dwordx4 v[128:131], v4, s[8:11], s22 offen
    buffer_load_dwordx4 v[132:135], v4, s[8:11], s23 offen
    s_add_u32 s20, s20, 30720
    s_add_u32 s21, s21, 30720
    s_add_u32 s22, s22, 30720
    s_add_u32 s23, s23, 30720
    buffer_load_dwordx4 v[136:139], v4, s[8:11], s20 offen
    buffer_load_dwordx4 v[140:143], v4, s[8:11], s21 offen
    buffer_load_dwordx4 v[144:147], v4, s[8:11], s22 offen
    buffer_load_dwordx4 v[148:151], v4, s[8:11], s23 offen
    s_add_u32 s20, s20, 30720
    s_add_u32 s21, s21, 30720
    s_add_u32 s22, s22, 30720
    s_add_u32 s23, s23, 30720
LK1_ld2:
    v_add_u32 v32, s25, v3
    v_mul_u32_u24 v28, 336, v32
    v_add_u32 v28, 512, v28
    v_add_u32 v29, 0, v2
    v_mul_u32_u24 v30, 205, v29
    v_lshrrev_b32 v30, 12, v30
    v_mul_u32_u24 v31, 20, v30
    v_sub_u32 v31, v29, v31
    v_mul_u32_u24 v30, 21504, v30
    v_lshl_add_u32 v31, v31, 4, v30
    v_add_u32 v6, v31, v28
    v_add_u32 v29, 16, v2
    v_mul_u32_u24 v30, 205, v29
    v_lshrrev_b32 v30, 12, v30
    v_mul_u32_u24 v31, 20, v30
    v_sub_u32 v31, v29, v31
    v_mul_u32_u24 v30, 21504, v30
    v_lshl_add_u32 v31, v31, 4, v30
    v_add_u32 v7, v31, v28
    v_add_u32 v29, 32, v2
    v_mul_u32_u24 v30, 205, v29
    v_lshrrev_b32 v30, 12, v30
    v_mul_u32_u24 v31, 20, v30
    v_sub_u32 v31, v29, v31
    v_mul_u32_u24 v30, 21504, v30
    v_lshl_add_u32 v31, v31, 4, v30
    v_add_u32 v8, v31, v28
    v_add_u32 v29, 48, v2
    v_mul_u32_u24 v30, 205, v29
    v_lshrrev_b32 v30, 12, v30
    v_mul_u32_u24 v31, 20, v30
    v_sub_u32 v31, v29, v31
    v_mul_u32_u24 v30, 21504, v30
    v_lshl_add_u32 v31, v31, 4, v30
    v_add_u32 v9, v31, v28
    v_add_u32 v29, 64, v2
    v_mul_u32_u24 v30, 205, v29
    v_lshrrev_b32 v30, 12, v30
    v_mul_u32_u24 v31, 20, v30
    v_sub_u32 v31, v29, v31
    v_mul_u32_u24 v30, 21504, v30
    v_lshl_add_u32 v31, v31, 4, v30
    v_add_u32 v10, v31, v28
    v_lshlrev_b32 v39, 2, v32
    s_mul_i32 s40, s41, 160
    s_add_u32 s40, s40, 512
    v_mul_u32_u24 v11, 21504, v3
    v_mul_u32_u24 v28, 336, v2
    v_add3_u32 v11, v11, v28, s40
    v_and_b32 v36, 1, v1
    v_cmp_eq_u32 s[58:59], 0, v36
    v_lshlrev_b32 v36, 4, v36
    v_and_b32 v37, 2, v1
    v_cmp_eq_u32 s[54:55], 0, v37
    v_mov_b32 v37, 0x3f80
    v_lshlrev_b32 v37, v36, v37
    v_cndmask_b32 v12, 0, v37, s[54:55]
    v_cndmask_b32 v13, v37, 0, s[54:55]
    v_mov_b32 v14, 0x3f803f80
    v_mov_b32 v15, 0x3f803f80
    v_cmp_eq_u32 s[56:57], 0, v2
    s_cmp_lg_u32 s41, 0
    s_cbranch_scc1 LK1_conv1
    s_waitcnt vmcnt(8)
    v_mfma_f32_4x4x4_16b_bf16 v[132:135], v[14:15], v[168:169], 0
    buffer_load_dwordx4 v[72:75], v4, s[8:11], s20 offen
    v_mfma_f32_4x4x4_16b_bf16 v[96:99], v[14:15], v[188:189], 0
    v_mfma_f32_4x4x4_16b_bf16 v[136:139], v[168:169], v[168:169], 0
    v_mfma_f32_4x4x4_16b_bf16 v[100:103], v[188:189], v[188:189], 0
    v_mfma_f32_4x4x4_16b_bf16 v[132:135], v[14:15], v[170:171], v[132:135]
    v_mfma_f32_4x4x4_16b_bf16 v[96:99], v[14:15], v[190:191], v[96:99]
    v_mfma_f32_4x4x4_16b_bf16 v[136:139], v[170:171], v[170:171], v[136:139]
    v_mfma_f32_4x4x4_16b_bf16 v[100:103], v[190:191], v[190:191], v[100:103]
    v_mfma_f32_4x4x4_16b_bf16 v[132:135], v[14:15], v[172:173], v[132:135]
    v_mfma_f32_4x4x4_16b_bf16 v[96:99], v[14:15], v[192:193], v[96:99]
    v_mfma_f32_4x4x4_16b_bf16 v[136:139], v[172:173], v[172:173], v[136:139]
    v_mfma_f32_4x4x4_16b_bf16 v[100:103], v[192:193], v[192:193], v[100:103]
    v_mfma_f32_4x4x4_16b_bf16 v[132:135], v[14:15], v[174:175], v[132:135]
    v_mfma_f32_4x4x4_16b_bf16 v[96:99], v[14:15], v[194:195], v[96:99]
    v_mfma_f32_4x4x4_16b_bf16 v[136:139], v[174:175], v[174:175], v[136:139]
    v_mfma_f32_4x4x4_16b_bf16 v[100:103], v[194:195], v[194:195], v[100:103]
    v_mfma_f32_4x4x4_16b_bf16 v[132:135], v[14:15], v[176:177], v[132:135]
    v_mfma_f32_4x4x4_16b_bf16 v[96:99], v[14:15], v[196:197], v[96:99]
    v_mfma_f32_4x4x4_16b_bf16 v[136:139], v[176:177], v[176:177], v[136:139]
    v_mfma_f32_4x4x4_16b_bf16 v[100:103], v[196:197], v[196:197], v[100:103]
    v_mfma_f32_4x4x4_16b_bf16 v[132:135], v[14:15], v[178:179], v[132:135]
    v_mfma_f32_4x4x4_16b_bf16 v[96:99], v[14:15], v[198:199], v[96:99]
    v_mfma_f32_4x4x4_16b_bf16 v[136:139], v[178:179], v[178:179], v[136:139]
    v_mfma_f32_4x4x4_16b_bf16 v[100:103], v[198:199], v[198:199], v[100:103]
    v_mfma_f32_4x4x4_16b_bf16 v[132:135], v[14:15], v[180:181], v[132:135]
    v_mfma_f32_4x4x4_16b_bf16 v[96:99], v[14:15], v[200:201], v[96:99]
    v_mfma_f32_4x4x4_16b_bf16 v[136:139], v[180:181], v[180:181], v[136:139]
    v_mfma_f32_4x4x4_16b_bf16 v[100:103], v[200:201], v[200:201], v[100:103]
    v_mfma_f32_4x4x4_16b_bf16 v[132:135], v[14:15], v[182:183], v[132:135]
    v_mfma_f32_4x4x4_16b_bf16 v[96:99], v[14:15], v[202:203], v[96:99]
    v_mfma_f32_4x4x4_16b_bf16 v[136:139], v[182:183], v[182:183], v[136:139]
    v_mfma_f32_4x4x4_16b_bf16 v[100:103], v[202:203], v[202:203], v[100:103]
    v_mfma_f32_4x4x4_16b_bf16 v[132:135], v[14:15], v[184:185], v[132:135]
    v_mfma_f32_4x4x4_16b_bf16 v[96:99], v[14:15], v[204:205], v[96:99]
    v_mfma_f32_4x4x4_16b_bf16 v[136:139], v[184:185], v[184:185], v[136:139]
    v_mfma_f32_4x4x4_16b_bf16 v[100:103], v[204:205], v[204:205], v[100:103]
    v_mfma_f32_4x4x4_16b_bf16 v[132:135], v[14:15], v[186:187], v[132:135]
    v_mfma_f32_4x4x4_16b_bf16 v[96:99], v[14:15], v[206:207], v[96:99]
    v_mfma_f32_4x4x4_16b_bf16 v[136:139], v[186:187], v[186:187], v[136:139]
    v_mfma_f32_4x4x4_16b_bf16 v[100:103], v[206:207], v[206:207], v[100:103]
    s_nop 3
    v_cndmask_b32 v146, v137, v136, s[58:59]
    v_cndmask_b32 v110, v101, v100, s[58:59]
    v_cndmask_b32 v147, v139, v138, s[58:59]
    buffer_load_dwordx4 v[76:79], v4, s[8:11], s21 offen
    v_cndmask_b32 v111, v103, v102, s[58:59]
    v_cndmask_b32 v146, v147, v146, s[54:55]
    v_cndmask_b32 v110, v111, v110, s[54:55]
    v_mov_b32 v144, v132
    v_mov_b32 v108, v96
    s_nop 0
    v_add_f32_dpp v144, v144, v144 row_ror:8 row_mask:0xf bank_mask:0xf
    v_add_f32_dpp v108, v108, v108 row_ror:8 row_mask:0xf bank_mask:0xf
    v_add_f32_dpp v146, v146, v146 row_ror:8 row_mask:0xf bank_mask:0xf
    v_add_f32_dpp v110, v110, v110 row_ror:8 row_mask:0xf bank_mask:0xf
    v_add_f32_dpp v144, v144, v144 row_ror:4 row_mask:0xf bank_mask:0xf
    v_add_f32_dpp v108, v108, v108 row_ror:4 row_mask:0xf bank_mask:0xf
    v_add_f32_dpp v146, v146, v146 row_ror:4 row_mask:0xf bank_mask:0xf
    v_add_f32_dpp v110, v110, v110 row_ror:4 row_mask:0xf bank_mask:0xf
    v_add_f32_dpp v144, v144, v144 row_ror:2 row_mask:0xf bank_mask:0xf
    v_add_f32_dpp v108, v108, v108 row_ror:2 row_mask:0xf bank_mask:0xf
    v_add_f32_dpp v146, v146, v146 row_ror:2 row_mask:0xf bank_mask:0xf
    v_add_f32_dpp v110, v110, v110 row_ror:2 row_mask:0xf bank_mask:0xf
    v_add_f32_dpp v144, v144, v144 row_ror:1 row_mask:0xf bank_mask:0xf
    v_add_f32_dpp v108, v108, v108 row_ror:1 row_mask:0xf bank_mask:0xf
    v_add_f32_dpp v146, v146, v146 row_ror:1 row_mask:0xf bank_mask:0xf
    v_add_f32_dpp v110, v110, v110 row_ror:1 row_mask:0xf bank_mask:0xf
    v_mul_f32 v144, 0x3acccccd, v144
    v_mul_f32 v108, 0x3acccccd, v108
    v_cvt_pk_bf16_f32 v145, 0, v144
    v_cvt_pk_bf16_f32 v109, 0, v108
    v_sub_f32 v140, 0, v145
    v_sub_f32 v104, 0, v109
    v_sub_f32 v141, 0, v145
    v_sub_f32 v105, 0, v109
    v_sub_f32 v142, 0, v145
    v_sub_f32 v106, 0, v109
    v_sub_f32 v143, 0, v145
    v_sub_f32 v107, 0, v109
    v_mul_f32 v146, 0x3acccccd, v146
    v_mul_f32 v110, 0x3acccccd, v110
    v_fma_f32 v146, -v144, v144, v146
    v_fma_f32 v110, -v108, v108, v110
    v_mfma_f32_4x4x4_16b_bf16 v[152:155], v[12:13], v[168:169], v[140:143]
    v_mfma_f32_4x4x4_16b_bf16 v[116:119], v[12:13], v[188:189], v[104:107]
    v_max_f32 v146, 0, v146
    v_max_f32 v110, 0, v110
    v_mfma_f32_4x4x4_16b_bf16 v[156:159], v[12:13], v[170:171], v[140:143]
    buffer_load_dwordx4 v[80:83], v4, s[8:11], s22 offen
    v_mfma_f32_4x4x4_16b_bf16 v[120:123], v[12:13], v[190:191], v[104:107]
    v_cvt_pk_bf16_f32 v146, 0, v146
    v_cvt_pk_bf16_f32 v110, 0, v110
    v_mfma_f32_4x4x4_16b_bf16 v[160:163], v[12:13], v[172:173], v[140:143]
    v_mfma_f32_4x4x4_16b_bf16 v[124:127], v[12:13], v[192:193], v[104:107]
    v_add_f32 v146, 0x3727c5ac, v146
    v_add_f32 v110, 0x3727c5ac, v110
    v_cvt_pk_bf16_f32 v168, v152, v153
    v_cvt_pk_bf16_f32 v188, v116, v117
    v_cvt_pk_bf16_f32 v169, v154, v155
    v_cvt_pk_bf16_f32 v189, v118, v119
    v_mfma_f32_4x4x4_16b_bf16 v[164:167], v[12:13], v[174:175], v[140:143]
    v_mfma_f32_4x4x4_16b_bf16 v[128:131], v[12:13], v[194:195], v[104:107]
    v_cvt_pk_bf16_f32 v146, 0, v146
    v_cvt_pk_bf16_f32 v110, 0, v110
    v_cvt_pk_bf16_f32 v170, v156, v157
    v_cvt_pk_bf16_f32 v190, v120, v121
    v_cvt_pk_bf16_f32 v171, v158, v159
    v_cvt_pk_bf16_f32 v191, v122, v123
    ds_write_b128 v6, v[168:171] offset:0
    ds_write_b128 v6, v[188:191] offset:1344
    v_mfma_f32_4x4x4_16b_bf16 v[152:155], v[12:13], v[176:177], v[140:143]
    v_mfma_f32_4x4x4_16b_bf16 v[116:119], v[12:13], v[196:197], v[104:107]
    v_sqrt_f32 v146, v146
    v_sqrt_f32 v110, v110
    v_cvt_pk_bf16_f32 v172, v160, v161
    v_cvt_pk_bf16_f32 v192, v124, v125
    v_cvt_pk_bf16_f32 v173, v162, v163
    v_cvt_pk_bf16_f32 v193, v126, v127
    v_mfma_f32_4x4x4_16b_bf16 v[156:159], v[12:13], v[178:179], v[140:143]
    v_mfma_f32_4x4x4_16b_bf16 v[120:123], v[12:13], v[198:199], v[104:107]
    v_cvt_pk_bf16_f32 v146, 0, v146
    v_cvt_pk_bf16_f32 v110, 0, v110
    v_cvt_pk_bf16_f32 v174, v164, v165
    v_cvt_pk_bf16_f32 v194, v128, v129
    v_cvt_pk_bf16_f32 v175, v166, v167
    v_cvt_pk_bf16_f32 v195, v130, v131
    ds_write_b128 v7, v[172:175] offset:0
    ds_write_b128 v7, v[192:195] offset:1344
    v_mfma_f32_4x4x4_16b_bf16 v[160:163], v[12:13], v[180:181], v[140:143]
    v_mfma_f32_4x4x4_16b_bf16 v[124:127], v[12:13], v[200:201], v[104:107]
    v_rcp_f32 v147, v146
    v_rcp_f32 v111, v110
    buffer_load_dwordx4 v[84:87], v4, s[8:11], s23 offen
    v_cvt_pk_bf16_f32 v176, v152, v153
    v_cvt_pk_bf16_f32 v196, v116, v117
    v_cvt_pk_bf16_f32 v177, v154, v155
    v_cvt_pk_bf16_f32 v197, v118, v119
    v_mfma_f32_4x4x4_16b_bf16 v[164:167], v[12:13], v[182:183], v[140:143]
    v_mfma_f32_4x4x4_16b_bf16 v[128:131], v[12:13], v[202:203], v[104:107]
    v_fma_f32 v148, -v146, v147, 1.0
    v_fma_f32 v112, -v110, v111, 1.0
    v_cvt_pk_bf16_f32 v178, v156, v157
    v_cvt_pk_bf16_f32 v198, v120, v121
    v_cvt_pk_bf16_f32 v179, v158, v159
    v_cvt_pk_bf16_f32 v199, v122, v123
    ds_write_b128 v8, v[176:179] offset:0
    ds_write_b128 v8, v[196:199] offset:1344
    v_mfma_f32_4x4x4_16b_bf16 v[152:155], v[12:13], v[184:185], v[140:143]
    v_mfma_f32_4x4x4_16b_bf16 v[116:119], v[12:13], v[204:205], v[104:107]
    v_fma_f32 v147, v148, v147, v147
    v_fma_f32 v111, v112, v111, v111
    v_cvt_pk_bf16_f32 v180, v160, v161
    v_cvt_pk_bf16_f32 v200, v124, v125
    v_cvt_pk_bf16_f32 v181, v162, v163
    v_cvt_pk_bf16_f32 v201, v126, v127
    v_mfma_f32_4x4x4_16b_bf16 v[156:159], v[12:13], v[186:187], v[140:143]
    v_mfma_f32_4x4x4_16b_bf16 v[120:123], v[12:13], v[206:207], v[104:107]
    v_cvt_pk_bf16_f32 v182, v164, v165
    v_cvt_pk_bf16_f32 v202, v128, v129
    v_cvt_pk_bf16_f32 v183, v166, v167
    v_cvt_pk_bf16_f32 v203, v130, v131
    ds_write_b128 v9, v[180:183] offset:0
    ds_write_b128 v9, v[200:203] offset:1344
    v_cvt_pk_bf16_f32 v184, v152, v153
    v_cvt_pk_bf16_f32 v204, v116, v117
    v_cvt_pk_bf16_f32 v185, v154, v155
    v_cvt_pk_bf16_f32 v205, v118, v119
    v_cvt_pk_bf16_f32 v186, v156, v157
    v_cvt_pk_bf16_f32 v206, v120, v121
    v_cvt_pk_bf16_f32 v187, v158, v159
    v_cvt_pk_bf16_f32 v207, v122, v123
    ds_write_b128 v10, v[184:187] offset:0
    ds_write_b128 v10, v[204:207] offset:1344
    s_mov_b64 exec, s[56:57]
    ds_write_b32 v39, v147 offset:0
    ds_write_b32 v39, v111 offset:16
    s_mov_b64 exec, -1
    s_add_u32 s20, s20, 30720
    v_mfma_f32_4x4x4_16b_bf16 v[132:135], v[14:15], v[208:209], 0
    v_mfma_f32_4x4x4_16b_bf16 v[96:99], v[14:15], v[228:229], 0
    v_mfma_f32_4x4x4_16b_bf16 v[136:139], v[208:209], v[208:209], 0
    v_mfma_f32_4x4x4_16b_bf16 v[100:103], v[228:229], v[228:229], 0
    v_mfma_f32_4x4x4_16b_bf16 v[132:135], v[14:15], v[210:211], v[132:135]
    v_mfma_f32_4x4x4_16b_bf16 v[96:99], v[14:15], v[230:231], v[96:99]
    v_mfma_f32_4x4x4_16b_bf16 v[136:139], v[210:211], v[210:211], v[136:139]
    v_mfma_f32_4x4x4_16b_bf16 v[100:103], v[230:231], v[230:231], v[100:103]
    v_mfma_f32_4x4x4_16b_bf16 v[132:135], v[14:15], v[212:213], v[132:135]
    v_mfma_f32_4x4x4_16b_bf16 v[96:99], v[14:15], v[232:233], v[96:99]
    v_mfma_f32_4x4x4_16b_bf16 v[136:139], v[212:213], v[212:213], v[136:139]
    v_mfma_f32_4x4x4_16b_bf16 v[100:103], v[232:233], v[232:233], v[100:103]
    v_mfma_f32_4x4x4_16b_bf16 v[132:135], v[14:15], v[214:215], v[132:135]
    v_mfma_f32_4x4x4_16b_bf16 v[96:99], v[14:15], v[234:235], v[96:99]
    v_mfma_f32_4x4x4_16b_bf16 v[136:139], v[214:215], v[214:215], v[136:139]
    v_mfma_f32_4x4x4_16b_bf16 v[100:103], v[234:235], v[234:235], v[100:103]
    v_mfma_f32_4x4x4_16b_bf16 v[132:135], v[14:15], v[216:217], v[132:135]
    v_mfma_f32_4x4x4_16b_bf16 v[96:99], v[14:15], v[236:237], v[96:99]
    v_mfma_f32_4x4x4_16b_bf16 v[136:139], v[216:217], v[216:217], v[136:139]
    v_mfma_f32_4x4x4_16b_bf16 v[100:103], v[236:237], v[236:237], v[100:103]
    v_mfma_f32_4x4x4_16b_bf16 v[132:135], v[14:15], v[218:219], v[132:135]
    v_mfma_f32_4x4x4_16b_bf16 v[96:99], v[14:15], v[238:239], v[96:99]
    v_mfma_f32_4x4x4_16b_bf16 v[136:139], v[218:219], v[218:219], v[136:139]
    v_mfma_f32_4x4x4_16b_bf16 v[100:103], v[238:239], v[238:239], v[100:103]
    v_mfma_f32_4x4x4_16b_bf16 v[132:135], v[14:15], v[220:221], v[132:135]
    v_mfma_f32_4x4x4_16b_bf16 v[96:99], v[14:15], v[240:241], v[96:99]
    v_mfma_f32_4x4x4_16b_bf16 v[136:139], v[220:221], v[220:221], v[136:139]
    v_mfma_f32_4x4x4_16b_bf16 v[100:103], v[240:241], v[240:241], v[100:103]
    v_mfma_f32_4x4x4_16b_bf16 v[132:135], v[14:15], v[222:223], v[132:135]
    v_mfma_f32_4x4x4_16b_bf16 v[96:99], v[14:15], v[242:243], v[96:99]
    v_mfma_f32_4x4x4_16b_bf16 v[136:139], v[222:223], v[222:223], v[136:139]
    v_mfma_f32_4x4x4_16b_bf16 v[100:103], v[242:243], v[242:243], v[100:103]
    v_mfma_f32_4x4x4_16b_bf16 v[132:135], v[14:15], v[224:225], v[132:135]
    v_mfma_f32_4x4x4_16b_bf16 v[96:99], v[14:15], v[244:245], v[96:99]
    v_mfma_f32_4x4x4_16b_bf16 v[136:139], v[224:225], v[224:225], v[136:139]
    v_mfma_f32_4x4x4_16b_bf16 v[100:103], v[244:245], v[244:245], v[100:103]
    v_mfma_f32_4x4x4_16b_bf16 v[132:135], v[14:15], v[226:227], v[132:135]
    v_mfma_f32_4x4x4_16b_bf16 v[96:99], v[14:15], v[246:247], v[96:99]
    v_mfma_f32_4x4x4_16b_bf16 v[136:139], v[226:227], v[226:227], v[136:139]
    v_mfma_f32_4x4x4_16b_bf16 v[100:103], v[246:247], v[246:247], v[100:103]
    s_nop 3
    v_cndmask_b32 v146, v137, v136, s[58:59]
    s_add_u32 s21, s21, 30720
    v_cndmask_b32 v110, v101, v100, s[58:59]
    v_cndmask_b32 v147, v139, v138, s[58:59]
    v_cndmask_b32 v111, v103, v102, s[58:59]
    v_cndmask_b32 v146, v147, v146, s[54:55]
    v_cndmask_b32 v110, v111, v110, s[54:55]
    v_mov_b32 v144, v132
    v_mov_b32 v108, v96
    s_nop 0
    v_add_f32_dpp v144, v144, v144 row_ror:8 row_mask:0xf bank_mask:0xf
    v_add_f32_dpp v108, v108, v108 row_ror:8 row_mask:0xf bank_mask:0xf
    v_add_f32_dpp v146, v146, v146 row_ror:8 row_mask:0xf bank_mask:0xf
    v_add_f32_dpp v110, v110, v110 row_ror:8 row_mask:0xf bank_mask:0xf
    v_add_f32_dpp v144, v144, v144 row_ror:4 row_mask:0xf bank_mask:0xf
    v_add_f32_dpp v108, v108, v108 row_ror:4 row_mask:0xf bank_mask:0xf
    v_add_f32_dpp v146, v146, v146 row_ror:4 row_mask:0xf bank_mask:0xf
    v_add_f32_dpp v110, v110, v110 row_ror:4 row_mask:0xf bank_mask:0xf
    v_add_f32_dpp v144, v144, v144 row_ror:2 row_mask:0xf bank_mask:0xf
    v_add_f32_dpp v108, v108, v108 row_ror:2 row_mask:0xf bank_mask:0xf
    v_add_f32_dpp v146, v146, v146 row_ror:2 row_mask:0xf bank_mask:0xf
    v_add_f32_dpp v110, v110, v110 row_ror:2 row_mask:0xf bank_mask:0xf
    v_add_f32_dpp v144, v144, v144 row_ror:1 row_mask:0xf bank_mask:0xf
    v_add_f32_dpp v108, v108, v108 row_ror:1 row_mask:0xf bank_mask:0xf
    v_add_f32_dpp v146, v146, v146 row_ror:1 row_mask:0xf bank_mask:0xf
    v_add_f32_dpp v110, v110, v110 row_ror:1 row_mask:0xf bank_mask:0xf
    v_mul_f32 v144, 0x3acccccd, v144
    v_mul_f32 v108, 0x3acccccd, v108
    v_cvt_pk_bf16_f32 v145, 0, v144
    v_cvt_pk_bf16_f32 v109, 0, v108
    v_sub_f32 v140, 0, v145
    v_sub_f32 v104, 0, v109
    v_sub_f32 v141, 0, v145
    v_sub_f32 v105, 0, v109
    v_sub_f32 v142, 0, v145
    v_sub_f32 v106, 0, v109
    v_sub_f32 v143, 0, v145
    v_sub_f32 v107, 0, v109
    v_mul_f32 v146, 0x3acccccd, v146
    v_mul_f32 v110, 0x3acccccd, v110
    v_fma_f32 v146, -v144, v144, v146
    v_fma_f32 v110, -v108, v108, v110
    v_mfma_f32_4x4x4_16b_bf16 v[152:155], v[12:13], v[208:209], v[140:143]
    v_mfma_f32_4x4x4_16b_bf16 v[116:119], v[12:13], v[228:229], v[104:107]
    v_max_f32 v146, 0, v146
    s_add_u32 s22, s22, 30720
    v_max_f32 v110, 0, v110
    v_mfma_f32_4x4x4_16b_bf16 v[156:159], v[12:13], v[210:211], v[140:143]
    v_mfma_f32_4x4x4_16b_bf16 v[120:123], v[12:13], v[230:231], v[104:107]
    v_cvt_pk_bf16_f32 v146, 0, v146
    v_cvt_pk_bf16_f32 v110, 0, v110
    v_mfma_f32_4x4x4_16b_bf16 v[160:163], v[12:13], v[212:213], v[140:143]
    v_mfma_f32_4x4x4_16b_bf16 v[124:127], v[12:13], v[232:233], v[104:107]
    v_add_f32 v146, 0x3727c5ac, v146
    v_add_f32 v110, 0x3727c5ac, v110
    v_cvt_pk_bf16_f32 v208, v152, v153
    v_cvt_pk_bf16_f32 v228, v116, v117
    v_cvt_pk_bf16_f32 v209, v154, v155
    v_cvt_pk_bf16_f32 v229, v118, v119
    v_mfma_f32_4x4x4_16b_bf16 v[164:167], v[12:13], v[214:215], v[140:143]
    v_mfma_f32_4x4x4_16b_bf16 v[128:131], v[12:13], v[234:235], v[104:107]
    v_cvt_pk_bf16_f32 v146, 0, v146
    v_cvt_pk_bf16_f32 v110, 0, v110
    v_cvt_pk_bf16_f32 v210, v156, v157
    v_cvt_pk_bf16_f32 v230, v120, v121
    v_cvt_pk_bf16_f32 v211, v158, v159
    v_cvt_pk_bf16_f32 v231, v122, v123
    ds_write_b128 v6, v[208:211] offset:2688
    ds_write_b128 v6, v[228:231] offset:4032
    v_mfma_f32_4x4x4_16b_bf16 v[152:155], v[12:13], v[216:217], v[140:143]
    v_mfma_f32_4x4x4_16b_bf16 v[116:119], v[12:13], v[236:237], v[104:107]
    v_sqrt_f32 v146, v146
    v_sqrt_f32 v110, v110
    v_cvt_pk_bf16_f32 v212, v160, v161
    v_cvt_pk_bf16_f32 v232, v124, v125
    v_cvt_pk_bf16_f32 v213, v162, v163
    v_cvt_pk_bf16_f32 v233, v126, v127
    v_mfma_f32_4x4x4_16b_bf16 v[156:159], v[12:13], v[218:219], v[140:143]
    v_mfma_f32_4x4x4_16b_bf16 v[120:123], v[12:13], v[238:239], v[104:107]
    v_cvt_pk_bf16_f32 v146, 0, v146
    v_cvt_pk_bf16_f32 v110, 0, v110
    v_cvt_pk_bf16_f32 v214, v164, v165
    v_cvt_pk_bf16_f32 v234, v128, v129
    v_cvt_pk_bf16_f32 v215, v166, v167
    v_cvt_pk_bf16_f32 v235, v130, v131
    ds_write_b128 v7, v[212:215] offset:2688
    ds_write_b128 v7, v[232:235] offset:4032
    v_mfma_f32_4x4x4_16b_bf16 v[160:163], v[12:13], v[220:221], v[140:143]
    v_mfma_f32_4x4x4_16b_bf16 v[124:127], v[12:13], v[240:241], v[104:107]
    s_add_u32 s23, s23, 30720
    v_rcp_f32 v147, v146
    v_rcp_f32 v111, v110
    v_cvt_pk_bf16_f32 v216, v152, v153
    v_cvt_pk_bf16_f32 v236, v116, v117
    v_cvt_pk_bf16_f32 v217, v154, v155
    v_cvt_pk_bf16_f32 v237, v118, v119
    v_mfma_f32_4x4x4_16b_bf16 v[164:167], v[12:13], v[222:223], v[140:143]
    v_mfma_f32_4x4x4_16b_bf16 v[128:131], v[12:13], v[242:243], v[104:107]
    v_fma_f32 v148, -v146, v147, 1.0
    v_fma_f32 v112, -v110, v111, 1.0
    v_cvt_pk_bf16_f32 v218, v156, v157
    v_cvt_pk_bf16_f32 v238, v120, v121
    v_cvt_pk_bf16_f32 v219, v158, v159
    v_cvt_pk_bf16_f32 v239, v122, v123
    ds_write_b128 v8, v[216:219] offset:2688
    ds_write_b128 v8, v[236:239] offset:4032
    v_mfma_f32_4x4x4_16b_bf16 v[152:155], v[12:13], v[224:225], v[140:143]
    v_mfma_f32_4x4x4_16b_bf16 v[116:119], v[12:13], v[244:245], v[104:107]
    v_fma_f32 v147, v148, v147, v147
    v_fma_f32 v111, v112, v111, v111
    v_cvt_pk_bf16_f32 v220, v160, v161
    v_cvt_pk_bf16_f32 v240, v124, v125
    v_cvt_pk_bf16_f32 v221, v162, v163
    v_cvt_pk_bf16_f32 v241, v126, v127
    v_mfma_f32_4x4x4_16b_bf16 v[156:159], v[12:13], v[226:227], v[140:143]
    v_mfma_f32_4x4x4_16b_bf16 v[120:123], v[12:13], v[246:247], v[104:107]
    v_cvt_pk_bf16_f32 v222, v164, v165
    v_cvt_pk_bf16_f32 v242, v128, v129
    v_cvt_pk_bf16_f32 v223, v166, v167
    v_cvt_pk_bf16_f32 v243, v130, v131
    ds_write_b128 v9, v[220:223] offset:2688
    ds_write_b128 v9, v[240:243] offset:4032
    v_cvt_pk_bf16_f32 v224, v152, v153
    v_cvt_pk_bf16_f32 v244, v116, v117
    v_cvt_pk_bf16_f32 v225, v154, v155
    v_cvt_pk_bf16_f32 v245, v118, v119
    v_cvt_pk_bf16_f32 v226, v156, v157
    v_cvt_pk_bf16_f32 v246, v120, v121
    v_cvt_pk_bf16_f32 v227, v158, v159
    v_cvt_pk_bf16_f32 v247, v122, v123
    ds_write_b128 v10, v[224:227] offset:2688
    ds_write_b128 v10, v[244:247] offset:4032
    s_mov_b64 exec, s[56:57]
    ds_write_b32 v39, v147 offset:32
    ds_write_b32 v39, v111 offset:48
    s_mov_b64 exec, -1
    s_branch LK1_noln
LK1_conv1:
    s_waitcnt vmcnt(24)
    v_mov_b32_dpp v248, v40 row_shl:4 row_mask:0xf bank_mask:0x5
    v_mov_b32_dpp v248, v42 row_shr:4 row_mask:0xf bank_mask:0xa
    v_mov_b32_dpp v249, v41 row_shl:4 row_mask:0xf bank_mask:0x5
    v_mov_b32_dpp v249, v43 row_shr:4 row_mask:0xf bank_mask:0xa
    v_mov_b32_dpp v40, v42 quad_perm:[0,1,2,3] row_mask:0xf bank_mask:0xa
    v_mov_b32_dpp v41, v43 quad_perm:[0,1,2,3] row_mask:0xf bank_mask:0xa
    v_perm_b32 v152, v248, v40, v252
    v_perm_b32 v156, v248, v40, v253
    v_perm_b32 v160, v249, v41, v252
    v_perm_b32 v164, v249, v41, v253
    v_mov_b32_dpp v250, v44 row_shl:4 row_mask:0xf bank_mask:0x5
    v_mov_b32_dpp v250, v46 row_shr:4 row_mask:0xf bank_mask:0xa
    v_mov_b32_dpp v251, v45 row_shl:4 row_mask:0xf bank_mask:0x5
    v_mov_b32_dpp v251, v47 row_shr:4 row_mask:0xf bank_mask:0xa
    v_mov_b32_dpp v44, v46 quad_perm:[0,1,2,3] row_mask:0xf bank_mask:0xa
    v_mov_b32_dpp v45, v47 quad_perm:[0,1,2,3] row_mask:0xf bank_mask:0xa
    v_perm_b32 v153, v250, v44, v252
    v_perm_b32 v157, v250, v44, v253
    v_perm_b32 v161, v251, v45, v252
    v_perm_b32 v165, v251, v45, v253
    v_mov_b32_dpp v248, v48 row_shl:4 row_mask:0xf bank_mask:0x5
    v_mov_b32_dpp v248, v50 row_shr:4 row_mask:0xf bank_mask:0xa
    v_mov_b32_dpp v249, v49 row_shl:4 row_mask:0xf bank_mask:0x5
    v_mov_b32_dpp v249, v51 row_shr:4 row_mask:0xf bank_mask:0xa
    v_mov_b32_dpp v48, v50 quad_perm:[0,1,2,3] row_mask:0xf bank_mask:0xa
    v_mov_b32_dpp v49, v51 quad_perm:[0,1,2,3] row_mask:0xf bank_mask:0xa
    v_perm_b32 v154, v248, v48, v252
    v_perm_b32 v158, v248, v48, v253
    v_perm_b32 v162, v249, v49, v252
    v_perm_b32 v166, v249, v49, v253
    v_mov_b32_dpp v250, v52 row_shl:4 row_mask:0xf bank_mask:0x5
    v_mov_b32_dpp v250, v54 row_shr:4 row_mask:0xf bank_mask:0xa
    v_mov_b32_dpp v251, v53 row_shl:4 row_mask:0xf bank_mask:0x5
    v_mov_b32_dpp v251, v55 row_shr:4 row_mask:0xf bank_mask:0xa
    v_mov_b32_dpp v52, v54 quad_perm:[0,1,2,3] row_mask:0xf bank_mask:0xa
    v_mov_b32_dpp v53, v55 quad_perm:[0,1,2,3] row_mask:0xf bank_mask:0xa
    v_perm_b32 v155, v250, v52, v252
    v_perm_b32 v159, v250, v52, v253
    v_perm_b32 v163, v251, v53, v252
    v_perm_b32 v167, v251, v53, v253
    s_waitcnt vmcnt(20)
    v_mov_b32_dpp v248, v56 row_shl:4 row_mask:0xf bank_mask:0x5
    v_mov_b32_dpp v248, v58 row_shr:4 row_mask:0xf bank_mask:0xa
    v_mov_b32_dpp v249, v57 row_shl:4 row_mask:0xf bank_mask:0x5
    v_mov_b32_dpp v249, v59 row_shr:4 row_mask:0xf bank_mask:0xa
    v_mov_b32_dpp v56, v58 quad_perm:[0,1,2,3] row_mask:0xf bank_mask:0xa
    v_mov_b32_dpp v57, v59 quad_perm:[0,1,2,3] row_mask:0xf bank_mask:0xa
    v_perm_b32 v40, v248, v56, v252
    v_perm_b32 v44, v248, v56, v253
    v_perm_b32 v48, v249, v57, v252
    v_perm_b32 v52, v249, v57, v253
    v_mov_b32_dpp v250, v60 row_shl:4 row_mask:0xf bank_mask:0x5
    v_mov_b32_dpp v250, v62 row_shr:4 row_mask:0xf bank_mask:0xa
    v_mov_b32_dpp v251, v61 row_shl:4 row_mask:0xf bank_mask:0x5
    v_mov_b32_dpp v251, v63 row_shr:4 row_mask:0xf bank_mask:0xa
    v_mov_b32_dpp v60, v62 quad_perm:[0,1,2,3] row_mask:0xf bank_mask:0xa
    v_mov_b32_dpp v61, v63 quad_perm:[0,1,2,3] row_mask:0xf bank_mask:0xa
    v_perm_b32 v41, v250, v60, v252
    v_perm_b32 v45, v250, v60, v253
    v_perm_b32 v49, v251, v61, v252
    v_perm_b32 v53, v251, v61, v253
    v_mov_b32_dpp v248, v64 row_shl:4 row_mask:0xf bank_mask:0x5
    v_mov_b32_dpp v248, v66 row_shr:4 row_mask:0xf bank_mask:0xa
    v_mov_b32_dpp v249, v65 row_shl:4 row_mask:0xf bank_mask:0x5
    v_mov_b32_dpp v249, v67 row_shr:4 row_mask:0xf bank_mask:0xa
    v_mov_b32_dpp v64, v66 quad_perm:[0,1,2,3] row_mask:0xf bank_mask:0xa
    v_mov_b32_dpp v65, v67 quad_perm:[0,1,2,3] row_mask:0xf bank_mask:0xa
    v_perm_b32 v42, v248, v64, v252
    v_perm_b32 v46, v248, v64, v253
    v_perm_b32 v50, v249, v65, v252
    v_perm_b32 v54, v249, v65, v253
    v_mov_b32_dpp v250, v68 row_shl:4 row_mask:0xf bank_mask:0x5
    v_mov_b32_dpp v250, v70 row_shr:4 row_mask:0xf bank_mask:0xa
    v_mov_b32_dpp v251, v69 row_shl:4 row_mask:0xf bank_mask:0x5
    v_mov_b32_dpp v251, v71 row_shr:4 row_mask:0xf bank_mask:0xa
    v_mov_b32_dpp v68, v70 quad_perm:[0,1,2,3] row_mask:0xf bank_mask:0xa
    v_mov_b32_dpp v69, v71 quad_perm:[0,1,2,3] row_mask:0xf bank_mask:0xa
    v_perm_b32 v43, v250, v68, v252
    v_perm_b32 v47, v250, v68, v253
    v_perm_b32 v51, v251, v69, v252
    v_perm_b32 v55, v251, v69, v253
LK1_noln:
    s_waitcnt lgkmcnt(0)
    s_barrier
    s_cmp_ge_u32 s19, 30
    s_cbranch_scc1 LK1_xn
    s_cmp_ge_u32 s19, 20
    s_cbranch_scc1 LK1_gemmV
    s_cmp_lg_u32 s41, 0
    s_cbranch_scc1 LK1_g1Q
    ds_read_b128 v[232:235], v11 offset:0
    ds_read_b128 v[236:239], v11 offset:5376
    ds_read_b128 v[240:243], v11 offset:10752
    ds_read_b128 v[244:247], v11 offset:16128
    buffer_load_dwordx4 v[88:91], v4, s[8:11], s20 offen
    buffer_load_dwordx4 v[92:95], v4, s[8:11], s21 offen
    buffer_load_dwordx4 v[96:99], v4, s[8:11], s22 offen
    buffer_load_dwordx4 v[100:103], v4, s[8:11], s23 offen
    s_add_u32 s20, s20, 30720
    s_add_u32 s21, s21, 30720
    s_add_u32 s22, s22, 30720
    s_add_u32 s23, s23, 30720
    buffer_load_dwordx4 v[104:107], v4, s[8:11], s20 offen
    buffer_load_dwordx4 v[108:111], v4, s[8:11], s21 offen
    buffer_load_dwordx4 v[112:115], v4, s[8:11], s22 offen
    buffer_load_dwordx4 v[116:119], v4, s[8:11], s23 offen
    s_add_u32 s20, s20, 30720
    s_add_u32 s21, s21, 30720
    s_add_u32 s22, s22, 30720
    s_add_u32 s23, s23, 30720
    buffer_load_dwordx4 v[120:123], v4, s[8:11], s20 offen
    buffer_load_dwordx4 v[124:127], v4, s[8:11], s21 offen
    buffer_load_dwordx4 v[128:131], v4, s[8:11], s22 offen
    buffer_load_dwordx4 v[132:135], v4, s[8:11], s23 offen
    s_add_u32 s20, s20, 30720
    s_add_u32 s21, s21, 30720
    s_add_u32 s22, s22, 30720
    s_add_u32 s23, s23, 30720
    buffer_load_dwordx4 v[136:139], v4, s[8:11], s20 offen
    buffer_load_dwordx4 v[140:143], v4, s[8:11], s21 offen
    buffer_load_dwordx4 v[144:147], v4, s[8:11], s22 offen
    buffer_load_dwordx4 v[148:151], v4, s[8:11], s23 offen
    s_add_u32 s20, s20, 30720
    s_add_u32 s21, s21, 30720
    s_add_u32 s22, s22, 30720
    s_add_u32 s23, s23, 30720
    s_waitcnt vmcnt(24)
    v_mov_b32_dpp v248, v40 row_shl:4 row_mask:0xf bank_mask:0x5
    v_mov_b32_dpp v248, v42 row_shr:4 row_mask:0xf bank_mask:0xa
    v_mov_b32_dpp v249, v41 row_shl:4 row_mask:0xf bank_mask:0x5
    v_mov_b32_dpp v249, v43 row_shr:4 row_mask:0xf bank_mask:0xa
    v_mov_b32_dpp v40, v42 quad_perm:[0,1,2,3] row_mask:0xf bank_mask:0xa
    v_mov_b32_dpp v41, v43 quad_perm:[0,1,2,3] row_mask:0xf bank_mask:0xa
    v_perm_b32 v152, v248, v40, v252
    v_perm_b32 v156, v248, v40, v253
    v_perm_b32 v160, v249, v41, v252
    v_perm_b32 v164, v249, v41, v253
    v_mov_b32_dpp v250, v44 row_shl:4 row_mask:0xf bank_mask:0x5
    v_mov_b32_dpp v250, v46 row_shr:4 row_mask:0xf bank_mask:0xa
    v_mov_b32_dpp v251, v45 row_shl:4 row_mask:0xf bank_mask:0x5
    v_mov_b32_dpp v251, v47 row_shr:4 row_mask:0xf bank_mask:0xa
    v_mov_b32_dpp v44, v46 quad_perm:[0,1,2,3] row_mask:0xf bank_mask:0xa
    v_mov_b32_dpp v45, v47 quad_perm:[0,1,2,3] row_mask:0xf bank_mask:0xa
    v_perm_b32 v153, v250, v44, v252
    v_perm_b32 v157, v250, v44, v253
    v_perm_b32 v161, v251, v45, v252
    v_perm_b32 v165, v251, v45, v253
    v_mov_b32_dpp v248, v48 row_shl:4 row_mask:0xf bank_mask:0x5
    v_mov_b32_dpp v248, v50 row_shr:4 row_mask:0xf bank_mask:0xa
    v_mov_b32_dpp v249, v49 row_shl:4 row_mask:0xf bank_mask:0x5
    v_mov_b32_dpp v249, v51 row_shr:4 row_mask:0xf bank_mask:0xa
    v_mov_b32_dpp v48, v50 quad_perm:[0,1,2,3] row_mask:0xf bank_mask:0xa
    v_mov_b32_dpp v49, v51 quad_perm:[0,1,2,3] row_mask:0xf bank_mask:0xa
    v_perm_b32 v154, v248, v48, v252
    v_perm_b32 v158, v248, v48, v253
    v_perm_b32 v162, v249, v49, v252
    v_perm_b32 v166, v249, v49, v253
    v_mov_b32_dpp v250, v52 row_shl:4 row_mask:0xf bank_mask:0x5
    v_mov_b32_dpp v250, v54 row_shr:4 row_mask:0xf bank_mask:0xa
    v_mov_b32_dpp v251, v53 row_shl:4 row_mask:0xf bank_mask:0x5
    v_mov_b32_dpp v251, v55 row_shr:4 row_mask:0xf bank_mask:0xa
    v_mov_b32_dpp v52, v54 quad_perm:[0,1,2,3] row_mask:0xf bank_mask:0xa
    v_mov_b32_dpp v53, v55 quad_perm:[0,1,2,3] row_mask:0xf bank_mask:0xa
    v_perm_b32 v155, v250, v52, v252
    v_perm_b32 v159, v250, v52, v253
    v_perm_b32 v163, v251, v53, v252
    v_perm_b32 v167, v251, v53, v253
    s_waitcnt lgkmcnt(0)
    ds_read_b128 v[12:15], v11 offset:16
    ds_read_b128 v[16:19], v11 offset:5392
    ds_read_b128 v[20:23], v11 offset:10768
    ds_read_b128 v[24:27], v11 offset:16144
    v_mfma_f32_16x16x32_bf16 v[168:171], v[152:155], v[232:235], 0
    s_waitcnt vmcnt(20)
    v_mov_b32_dpp v248, v56 row_shl:4 row_mask:0xf bank_mask:0x5
    v_mov_b32_dpp v248, v58 row_shr:4 row_mask:0xf bank_mask:0xa
    v_mfma_f32_16x16x32_bf16 v[184:187], v[152:155], v[236:239], 0
    v_mov_b32_dpp v249, v57 row_shl:4 row_mask:0xf bank_mask:0x5
    v_mov_b32_dpp v249, v59 row_shr:4 row_mask:0xf bank_mask:0xa
    v_mov_b32_dpp v56, v58 quad_perm:[0,1,2,3] row_mask:0xf bank_mask:0xa
    v_mfma_f32_16x16x32_bf16 v[200:203], v[152:155], v[240:243], 0
    v_mov_b32_dpp v57, v59 quad_perm:[0,1,2,3] row_mask:0xf bank_mask:0xa
    v_perm_b32 v40, v248, v56, v252
    v_mfma_f32_16x16x32_bf16 v[216:219], v[152:155], v[244:247], 0
    v_perm_b32 v44, v248, v56, v253
    v_perm_b32 v48, v249, v57, v252
    v_perm_b32 v52, v249, v57, v253
    v_mfma_f32_16x16x32_bf16 v[172:175], v[156:159], v[232:235], 0
    v_mov_b32_dpp v250, v60 row_shl:4 row_mask:0xf bank_mask:0x5
    v_mov_b32_dpp v250, v62 row_shr:4 row_mask:0xf bank_mask:0xa
    v_mfma_f32_16x16x32_bf16 v[188:191], v[156:159], v[236:239], 0
    v_mov_b32_dpp v251, v61 row_shl:4 row_mask:0xf bank_mask:0x5
    v_mov_b32_dpp v251, v63 row_shr:4 row_mask:0xf bank_mask:0xa
    v_mov_b32_dpp v60, v62 quad_perm:[0,1,2,3] row_mask:0xf bank_mask:0xa
    v_mfma_f32_16x16x32_bf16 v[204:207], v[156:159], v[240:243], 0
    v_mov_b32_dpp v61, v63 quad_perm:[0,1,2,3] row_mask:0xf bank_mask:0xa
    v_perm_b32 v41, v250, v60, v252
    v_mfma_f32_16x16x32_bf16 v[220:223], v[156:159], v[244:247], 0
    v_perm_b32 v45, v250, v60, v253
    v_perm_b32 v49, v251, v61, v252
    v_perm_b32 v53, v251, v61, v253
    v_mfma_f32_16x16x32_bf16 v[176:179], v[160:163], v[232:235], 0
    v_mov_b32_dpp v248, v64 row_shl:4 row_mask:0xf bank_mask:0x5
    v_mov_b32_dpp v248, v66 row_shr:4 row_mask:0xf bank_mask:0xa
    v_mov_b32_dpp v249, v65 row_shl:4 row_mask:0xf bank_mask:0x5
    v_mfma_f32_16x16x32_bf16 v[192:195], v[160:163], v[236:239], 0
    v_mov_b32_dpp v249, v67 row_shr:4 row_mask:0xf bank_mask:0xa
    v_mov_b32_dpp v64, v66 quad_perm:[0,1,2,3] row_mask:0xf bank_mask:0xa
    v_mfma_f32_16x16x32_bf16 v[208:211], v[160:163], v[240:243], 0
    v_mov_b32_dpp v65, v67 quad_perm:[0,1,2,3] row_mask:0xf bank_mask:0xa
    v_perm_b32 v42, v248, v64, v252
    v_perm_b32 v46, v248, v64, v253
    v_mfma_f32_16x16x32_bf16 v[224:227], v[160:163], v[244:247], 0
    v_perm_b32 v50, v249, v65, v252
    v_perm_b32 v54, v249, v65, v253
    v_mfma_f32_16x16x32_bf16 v[180:183], v[164:167], v[232:235], 0
    v_mov_b32_dpp v250, v68 row_shl:4 row_mask:0xf bank_mask:0x5
    v_mov_b32_dpp v250, v70 row_shr:4 row_mask:0xf bank_mask:0xa
    v_mov_b32_dpp v251, v69 row_shl:4 row_mask:0xf bank_mask:0x5
    v_mfma_f32_16x16x32_bf16 v[196:199], v[164:167], v[236:239], 0
    v_mov_b32_dpp v251, v71 row_shr:4 row_mask:0xf bank_mask:0xa
    v_mov_b32_dpp v68, v70 quad_perm:[0,1,2,3] row_mask:0xf bank_mask:0xa
    v_mfma_f32_16x16x32_bf16 v[212:215], v[164:167], v[240:243], 0
    v_mov_b32_dpp v69, v71 quad_perm:[0,1,2,3] row_mask:0xf bank_mask:0xa
    v_perm_b32 v43, v250, v68, v252
    v_perm_b32 v47, v250, v68, v253
    v_mfma_f32_16x16x32_bf16 v[228:231], v[164:167], v[244:247], 0
    v_perm_b32 v51, v251, v69, v252
    v_perm_b32 v55, v251, v69, v253
    buffer_load_dwordx4 v[152:155], v4, s[8:11], s20 offen
    buffer_load_dwordx4 v[156:159], v4, s[8:11], s21 offen
    buffer_load_dwordx4 v[160:163], v4, s[8:11], s22 offen
    buffer_load_dwordx4 v[164:167], v4, s[8:11], s23 offen
    s_add_u32 s20, s20, 30720
    s_add_u32 s21, s21, 30720
    s_add_u32 s22, s22, 30720
    s_add_u32 s23, s23, 30720
    s_waitcnt lgkmcnt(0)
    ds_read_b128 v[232:235], v11 offset:32
    ds_read_b128 v[236:239], v11 offset:5408
    ds_read_b128 v[240:243], v11 offset:10784
    ds_read_b128 v[244:247], v11 offset:16160
    v_mfma_f32_16x16x32_bf16 v[168:171], v[40:43], v[12:15], v[168:171]
    s_waitcnt vmcnt(20)
    v_mov_b32_dpp v248, v72 row_shl:4 row_mask:0xf bank_mask:0x5
    v_mov_b32_dpp v248, v74 row_shr:4 row_mask:0xf bank_mask:0xa
    v_mfma_f32_16x16x32_bf16 v[184:187], v[40:43], v[16:19], v[184:187]
    v_mov_b32_dpp v249, v73 row_shl:4 row_mask:0xf bank_mask:0x5
    v_mov_b32_dpp v249, v75 row_shr:4 row_mask:0xf bank_mask:0xa
    v_mov_b32_dpp v72, v74 quad_perm:[0,1,2,3] row_mask:0xf bank_mask:0xa
    v_mfma_f32_16x16x32_bf16 v[200:203], v[40:43], v[20:23], v[200:203]
    v_mov_b32_dpp v73, v75 quad_perm:[0,1,2,3] row_mask:0xf bank_mask:0xa
    v_perm_b32 v56, v248, v72, v252
    v_mfma_f32_16x16x32_bf16 v[216:219], v[40:43], v[24:27], v[216:219]
    v_perm_b32 v60, v248, v72, v253
    v_perm_b32 v64, v249, v73, v252
    v_perm_b32 v68, v249, v73, v253
    v_mfma_f32_16x16x32_bf16 v[172:175], v[44:47], v[12:15], v[172:175]
    v_mov_b32_dpp v250, v76 row_shl:4 row_mask:0xf bank_mask:0x5
    v_mov_b32_dpp v250, v78 row_shr:4 row_mask:0xf bank_mask:0xa
    v_mfma_f32_16x16x32_bf16 v[188:191], v[44:47], v[16:19], v[188:191]
    v_mov_b32_dpp v251, v77 row_shl:4 row_mask:0xf bank_mask:0x5
    v_mov_b32_dpp v251, v79 row_shr:4 row_mask:0xf bank_mask:0xa
    v_mov_b32_dpp v76, v78 quad_perm:[0,1,2,3] row_mask:0xf bank_mask:0xa
    v_mfma_f32_16x16x32_bf16 v[204:207], v[44:47], v[20:23], v[204:207]
    v_mov_b32_dpp v77, v79 quad_perm:[0,1,2,3] row_mask:0xf bank_mask:0xa
    v_perm_b32 v57, v250, v76, v252
    v_mfma_f32_16x16x32_bf16 v[220:223], v[44:47], v[24:27], v[220:223]
    v_perm_b32 v61, v250, v76, v253
    v_perm_b32 v65, v251, v77, v252
    v_perm_b32 v69, v251, v77, v253
    v_mfma_f32_16x16x32_bf16 v[176:179], v[48:51], v[12:15], v[176:179]
    v_mov_b32_dpp v248, v80 row_shl:4 row_mask:0xf bank_mask:0x5
    v_mov_b32_dpp v248, v82 row_shr:4 row_mask:0xf bank_mask:0xa
    v_mov_b32_dpp v249, v81 row_shl:4 row_mask:0xf bank_mask:0x5
    v_mfma_f32_16x16x32_bf16 v[192:195], v[48:51], v[16:19], v[192:195]
    v_mov_b32_dpp v249, v83 row_shr:4 row_mask:0xf bank_mask:0xa
    v_mov_b32_dpp v80, v82 quad_perm:[0,1,2,3] row_mask:0xf bank_mask:0xa
    v_mfma_f32_16x16x32_bf16 v[208:211], v[48:51], v[20:23], v[208:211]
    v_mov_b32_dpp v81, v83 quad_perm:[0,1,2,3] row_mask:0xf bank_mask:0xa
    v_perm_b32 v58, v248, v80, v252
    v_perm_b32 v62, v248, v80, v253
    v_mfma_f32_16x16x32_bf16 v[224:227], v[48:51], v[24:27], v[224:227]
    v_perm_b32 v66, v249, v81, v252
    v_perm_b32 v70, v249, v81, v253
    v_mfma_f32_16x16x32_bf16 v[180:183], v[52:55], v[12:15], v[180:183]
    v_mov_b32_dpp v250, v84 row_shl:4 row_mask:0xf bank_mask:0x5
    v_mov_b32_dpp v250, v86 row_shr:4 row_mask:0xf bank_mask:0xa
    v_mov_b32_dpp v251, v85 row_shl:4 row_mask:0xf bank_mask:0x5
    v_mfma_f32_16x16x32_bf16 v[196:199], v[52:55], v[16:19], v[196:199]
    v_mov_b32_dpp v251, v87 row_shr:4 row_mask:0xf bank_mask:0xa
    v_mov_b32_dpp v84, v86 quad_perm:[0,1,2,3] row_mask:0xf bank_mask:0xa
    v_mfma_f32_16x16x32_bf16 v[212:215], v[52:55], v[20:23], v[212:215]
    v_mov_b32_dpp v85, v87 quad_perm:[0,1,2,3] row_mask:0xf bank_mask:0xa
    v_perm_b32 v59, v250, v84, v252
    v_perm_b32 v63, v250, v84, v253
    v_mfma_f32_16x16x32_bf16 v[228:231], v[52:55], v[24:27], v[228:231]
    v_perm_b32 v67, v251, v85, v252
    v_perm_b32 v71, v251, v85, v253
    buffer_load_dwordx4 v[40:43], v4, s[8:11], s20 offen
    buffer_load_dwordx4 v[44:47], v4, s[8:11], s21 offen
    buffer_load_dwordx4 v[48:51], v4, s[8:11], s22 offen
    buffer_load_dwordx4 v[52:55], v4, s[8:11], s23 offen
    s_add_u32 s20, s20, 30720
    s_add_u32 s21, s21, 30720
    s_add_u32 s22, s22, 30720
    s_add_u32 s23, s23, 30720
    s_waitcnt lgkmcnt(0)
    ds_read_b128 v[12:15], v11 offset:48
    ds_read_b128 v[16:19], v11 offset:5424
    ds_read_b128 v[20:23], v11 offset:10800
    ds_read_b128 v[24:27], v11 offset:16176
    v_mfma_f32_16x16x32_bf16 v[168:171], v[56:59], v[232:235], v[168:171]
    s_waitcnt vmcnt(20)
    v_mov_b32_dpp v248, v88 row_shl:4 row_mask:0xf bank_mask:0x5
    v_mov_b32_dpp v248, v90 row_shr:4 row_mask:0xf bank_mask:0xa
    v_mfma_f32_16x16x32_bf16 v[184:187], v[56:59], v[236:239], v[184:187]
    v_mov_b32_dpp v249, v89 row_shl:4 row_mask:0xf bank_mask:0x5
    v_mov_b32_dpp v249, v91 row_shr:4 row_mask:0xf bank_mask:0xa
    v_mov_b32_dpp v88, v90 quad_perm:[0,1,2,3] row_mask:0xf bank_mask:0xa
    v_mfma_f32_16x16x32_bf16 v[200:203], v[56:59], v[240:243], v[200:203]
    v_mov_b32_dpp v89, v91 quad_perm:[0,1,2,3] row_mask:0xf bank_mask:0xa
    v_perm_b32 v72, v248, v88, v252
    v_mfma_f32_16x16x32_bf16 v[216:219], v[56:59], v[244:247], v[216:219]
    v_perm_b32 v76, v248, v88, v253
    v_perm_b32 v80, v249, v89, v252
    v_perm_b32 v84, v249, v89, v253
    v_mfma_f32_16x16x32_bf16 v[172:175], v[60:63], v[232:235], v[172:175]
    v_mov_b32_dpp v250, v92 row_shl:4 row_mask:0xf bank_mask:0x5
    v_mov_b32_dpp v250, v94 row_shr:4 row_mask:0xf bank_mask:0xa
    v_mfma_f32_16x16x32_bf16 v[188:191], v[60:63], v[236:239], v[188:191]
    v_mov_b32_dpp v251, v93 row_shl:4 row_mask:0xf bank_mask:0x5
    v_mov_b32_dpp v251, v95 row_shr:4 row_mask:0xf bank_mask:0xa
    v_mov_b32_dpp v92, v94 quad_perm:[0,1,2,3] row_mask:0xf bank_mask:0xa
    v_mfma_f32_16x16x32_bf16 v[204:207], v[60:63], v[240:243], v[204:207]
    v_mov_b32_dpp v93, v95 quad_perm:[0,1,2,3] row_mask:0xf bank_mask:0xa
    v_perm_b32 v73, v250, v92, v252
    v_mfma_f32_16x16x32_bf16 v[220:223], v[60:63], v[244:247], v[220:223]
    v_perm_b32 v77, v250, v92, v253
    v_perm_b32 v81, v251, v93, v252
    v_perm_b32 v85, v251, v93, v253
    v_mfma_f32_16x16x32_bf16 v[176:179], v[64:67], v[232:235], v[176:179]
    v_mov_b32_dpp v248, v96 row_shl:4 row_mask:0xf bank_mask:0x5
    v_mov_b32_dpp v248, v98 row_shr:4 row_mask:0xf bank_mask:0xa
    v_mov_b32_dpp v249, v97 row_shl:4 row_mask:0xf bank_mask:0x5
    v_mfma_f32_16x16x32_bf16 v[192:195], v[64:67], v[236:239], v[192:195]
    v_mov_b32_dpp v249, v99 row_shr:4 row_mask:0xf bank_mask:0xa
    v_mov_b32_dpp v96, v98 quad_perm:[0,1,2,3] row_mask:0xf bank_mask:0xa
    v_mfma_f32_16x16x32_bf16 v[208:211], v[64:67], v[240:243], v[208:211]
    v_mov_b32_dpp v97, v99 quad_perm:[0,1,2,3] row_mask:0xf bank_mask:0xa
    v_perm_b32 v74, v248, v96, v252
    v_perm_b32 v78, v248, v96, v253
    v_mfma_f32_16x16x32_bf16 v[224:227], v[64:67], v[244:247], v[224:227]
    v_perm_b32 v82, v249, v97, v252
    v_perm_b32 v86, v249, v97, v253
    v_mfma_f32_16x16x32_bf16 v[180:183], v[68:71], v[232:235], v[180:183]
    v_mov_b32_dpp v250, v100 row_shl:4 row_mask:0xf bank_mask:0x5
    v_mov_b32_dpp v250, v102 row_shr:4 row_mask:0xf bank_mask:0xa
    v_mov_b32_dpp v251, v101 row_shl:4 row_mask:0xf bank_mask:0x5
    v_mfma_f32_16x16x32_bf16 v[196:199], v[68:71], v[236:239], v[196:199]
    v_mov_b32_dpp v251, v103 row_shr:4 row_mask:0xf bank_mask:0xa
    v_mov_b32_dpp v100, v102 quad_perm:[0,1,2,3] row_mask:0xf bank_mask:0xa
    v_mfma_f32_16x16x32_bf16 v[212:215], v[68:71], v[240:243], v[212:215]
    v_mov_b32_dpp v101, v103 quad_perm:[0,1,2,3] row_mask:0xf bank_mask:0xa
    v_perm_b32 v75, v250, v100, v252
    v_perm_b32 v79, v250, v100, v253
    v_mfma_f32_16x16x32_bf16 v[228:231], v[68:71], v[244:247], v[228:231]
    v_perm_b32 v83, v251, v101, v252
    v_perm_b32 v87, v251, v101, v253
    buffer_load_dwordx4 v[56:59], v4, s[8:11], s20 offen
    buffer_load_dwordx4 v[60:63], v4, s[8:11], s21 offen
    buffer_load_dwordx4 v[64:67], v4, s[8:11], s22 offen
    buffer_load_dwordx4 v[68:71], v4, s[8:11], s23 offen
    s_add_u32 s20, s20, 30720
    s_add_u32 s21, s21, 30720
    s_add_u32 s22, s22, 30720
    s_add_u32 s23, s23, 30720
    s_waitcnt lgkmcnt(0)
    ds_read_b128 v[232:235], v11 offset:64
    ds_read_b128 v[236:239], v11 offset:5440
    ds_read_b128 v[240:243], v11 offset:10816
    ds_read_b128 v[244:247], v11 offset:16192
    v_mfma_f32_16x16x32_bf16 v[168:171], v[72:75], v[12:15], v[168:171]
    s_waitcnt vmcnt(20)
    v_mov_b32_dpp v248, v104 row_shl:4 row_mask:0xf bank_mask:0x5
    v_mov_b32_dpp v248, v106 row_shr:4 row_mask:0xf bank_mask:0xa
    v_mfma_f32_16x16x32_bf16 v[184:187], v[72:75], v[16:19], v[184:187]
    v_mov_b32_dpp v249, v105 row_shl:4 row_mask:0xf bank_mask:0x5
    v_mov_b32_dpp v249, v107 row_shr:4 row_mask:0xf bank_mask:0xa
    v_mov_b32_dpp v104, v106 quad_perm:[0,1,2,3] row_mask:0xf bank_mask:0xa
    v_mfma_f32_16x16x32_bf16 v[200:203], v[72:75], v[20:23], v[200:203]
    v_mov_b32_dpp v105, v107 quad_perm:[0,1,2,3] row_mask:0xf bank_mask:0xa
    v_perm_b32 v88, v248, v104, v252
    v_mfma_f32_16x16x32_bf16 v[216:219], v[72:75], v[24:27], v[216:219]
    v_perm_b32 v92, v248, v104, v253
    v_perm_b32 v96, v249, v105, v252
    v_perm_b32 v100, v249, v105, v253
    v_mfma_f32_16x16x32_bf16 v[172:175], v[76:79], v[12:15], v[172:175]
    v_mov_b32_dpp v250, v108 row_shl:4 row_mask:0xf bank_mask:0x5
    v_mov_b32_dpp v250, v110 row_shr:4 row_mask:0xf bank_mask:0xa
    v_mfma_f32_16x16x32_bf16 v[188:191], v[76:79], v[16:19], v[188:191]
    v_mov_b32_dpp v251, v109 row_shl:4 row_mask:0xf bank_mask:0x5
    v_mov_b32_dpp v251, v111 row_shr:4 row_mask:0xf bank_mask:0xa
    v_mov_b32_dpp v108, v110 quad_perm:[0,1,2,3] row_mask:0xf bank_mask:0xa
    v_mfma_f32_16x16x32_bf16 v[204:207], v[76:79], v[20:23], v[204:207]
    v_mov_b32_dpp v109, v111 quad_perm:[0,1,2,3] row_mask:0xf bank_mask:0xa
    v_perm_b32 v89, v250, v108, v252
    v_mfma_f32_16x16x32_bf16 v[220:223], v[76:79], v[24:27], v[220:223]
    v_perm_b32 v93, v250, v108, v253
    v_perm_b32 v97, v251, v109, v252
    v_perm_b32 v101, v251, v109, v253
    v_mfma_f32_16x16x32_bf16 v[176:179], v[80:83], v[12:15], v[176:179]
    v_mov_b32_dpp v248, v112 row_shl:4 row_mask:0xf bank_mask:0x5
    v_mov_b32_dpp v248, v114 row_shr:4 row_mask:0xf bank_mask:0xa
    v_mov_b32_dpp v249, v113 row_shl:4 row_mask:0xf bank_mask:0x5
    v_mfma_f32_16x16x32_bf16 v[192:195], v[80:83], v[16:19], v[192:195]
    v_mov_b32_dpp v249, v115 row_shr:4 row_mask:0xf bank_mask:0xa
    v_mov_b32_dpp v112, v114 quad_perm:[0,1,2,3] row_mask:0xf bank_mask:0xa
    v_mfma_f32_16x16x32_bf16 v[208:211], v[80:83], v[20:23], v[208:211]
    v_mov_b32_dpp v113, v115 quad_perm:[0,1,2,3] row_mask:0xf bank_mask:0xa
    v_perm_b32 v90, v248, v112, v252
    v_perm_b32 v94, v248, v112, v253
    v_mfma_f32_16x16x32_bf16 v[224:227], v[80:83], v[24:27], v[224:227]
    v_perm_b32 v98, v249, v113, v252
    v_perm_b32 v102, v249, v113, v253
    v_mfma_f32_16x16x32_bf16 v[180:183], v[84:87], v[12:15], v[180:183]
    v_mov_b32_dpp v250, v116 row_shl:4 row_mask:0xf bank_mask:0x5
    v_mov_b32_dpp v250, v118 row_shr:4 row_mask:0xf bank_mask:0xa
    v_mov_b32_dpp v251, v117 row_shl:4 row_mask:0xf bank_mask:0x5
    v_mfma_f32_16x16x32_bf16 v[196:199], v[84:87], v[16:19], v[196:199]
    v_mov_b32_dpp v251, v119 row_shr:4 row_mask:0xf bank_mask:0xa
    v_mov_b32_dpp v116, v118 quad_perm:[0,1,2,3] row_mask:0xf bank_mask:0xa
    v_mfma_f32_16x16x32_bf16 v[212:215], v[84:87], v[20:23], v[212:215]
    v_mov_b32_dpp v117, v119 quad_perm:[0,1,2,3] row_mask:0xf bank_mask:0xa
    v_perm_b32 v91, v250, v116, v252
    v_perm_b32 v95, v250, v116, v253
    v_mfma_f32_16x16x32_bf16 v[228:231], v[84:87], v[24:27], v[228:231]
    v_perm_b32 v99, v251, v117, v252
    v_perm_b32 v103, v251, v117, v253
    s_waitcnt lgkmcnt(0)
    ds_read_b128 v[12:15], v11 offset:80
    ds_read_b128 v[16:19], v11 offset:5456
    ds_read_b128 v[20:23], v11 offset:10832
    ds_read_b128 v[24:27], v11 offset:16208
    v_mfma_f32_16x16x32_bf16 v[168:171], v[88:91], v[232:235], v[168:171]
    s_waitcnt vmcnt(16)
    v_mov_b32_dpp v248, v120 row_shl:4 row_mask:0xf bank_mask:0x5
    v_mov_b32_dpp v248, v122 row_shr:4 row_mask:0xf bank_mask:0xa
    v_mfma_f32_16x16x32_bf16 v[184:187], v[88:91], v[236:239], v[184:187]
    v_mov_b32_dpp v249, v121 row_shl:4 row_mask:0xf bank_mask:0x5
    v_mov_b32_dpp v249, v123 row_shr:4 row_mask:0xf bank_mask:0xa
    v_mov_b32_dpp v120, v122 quad_perm:[0,1,2,3] row_mask:0xf bank_mask:0xa
    v_mfma_f32_16x16x32_bf16 v[200:203], v[88:91], v[240:243], v[200:203]
    v_mov_b32_dpp v121, v123 quad_perm:[0,1,2,3] row_mask:0xf bank_mask:0xa
    v_perm_b32 v104, v248, v120, v252
    v_mfma_f32_16x16x32_bf16 v[216:219], v[88:91], v[244:247], v[216:219]
    v_perm_b32 v108, v248, v120, v253
    v_perm_b32 v112, v249, v121, v252
    v_perm_b32 v116, v249, v121, v253
    v_mfma_f32_16x16x32_bf16 v[172:175], v[92:95], v[232:235], v[172:175]
    v_mov_b32_dpp v250, v124 row_shl:4 row_mask:0xf bank_mask:0x5
    v_mov_b32_dpp v250, v126 row_shr:4 row_mask:0xf bank_mask:0xa
    v_mfma_f32_16x16x32_bf16 v[188:191], v[92:95], v[236:239], v[188:191]
    v_mov_b32_dpp v251, v125 row_shl:4 row_mask:0xf bank_mask:0x5
    v_mov_b32_dpp v251, v127 row_shr:4 row_mask:0xf bank_mask:0xa
    v_mov_b32_dpp v124, v126 quad_perm:[0,1,2,3] row_mask:0xf bank_mask:0xa
    v_mfma_f32_16x16x32_bf16 v[204:207], v[92:95], v[240:243], v[204:207]
    v_mov_b32_dpp v125, v127 quad_perm:[0,1,2,3] row_mask:0xf bank_mask:0xa
    v_perm_b32 v105, v250, v124, v252
    v_mfma_f32_16x16x32_bf16 v[220:223], v[92:95], v[244:247], v[220:223]
    v_perm_b32 v109, v250, v124, v253
    v_perm_b32 v113, v251, v125, v252
    v_perm_b32 v117, v251, v125, v253
    v_mfma_f32_16x16x32_bf16 v[176:179], v[96:99], v[232:235], v[176:179]
    v_mov_b32_dpp v248, v128 row_shl:4 row_mask:0xf bank_mask:0x5
    v_mov_b32_dpp v248, v130 row_shr:4 row_mask:0xf bank_mask:0xa
    v_mov_b32_dpp v249, v129 row_shl:4 row_mask:0xf bank_mask:0x5
    v_mfma_f32_16x16x32_bf16 v[192:195], v[96:99], v[236:239], v[192:195]
    v_mov_b32_dpp v249, v131 row_shr:4 row_mask:0xf bank_mask:0xa
    v_mov_b32_dpp v128, v130 quad_perm:[0,1,2,3] row_mask:0xf bank_mask:0xa
    v_mfma_f32_16x16x32_bf16 v[208:211], v[96:99], v[240:243], v[208:211]
    v_mov_b32_dpp v129, v131 quad_perm:[0,1,2,3] row_mask:0xf bank_mask:0xa
    v_perm_b32 v106, v248, v128, v252
    v_perm_b32 v110, v248, v128, v253
    v_mfma_f32_16x16x32_bf16 v[224:227], v[96:99], v[244:247], v[224:227]
    v_perm_b32 v114, v249, v129, v252
    v_perm_b32 v118, v249, v129, v253
    v_mfma_f32_16x16x32_bf16 v[180:183], v[100:103], v[232:235], v[180:183]
    v_mov_b32_dpp v250, v132 row_shl:4 row_mask:0xf bank_mask:0x5
    v_mov_b32_dpp v250, v134 row_shr:4 row_mask:0xf bank_mask:0xa
    v_mov_b32_dpp v251, v133 row_shl:4 row_mask:0xf bank_mask:0x5
    v_mfma_f32_16x16x32_bf16 v[196:199], v[100:103], v[236:239], v[196:199]
    v_mov_b32_dpp v251, v135 row_shr:4 row_mask:0xf bank_mask:0xa
    v_mov_b32_dpp v132, v134 quad_perm:[0,1,2,3] row_mask:0xf bank_mask:0xa
    v_mfma_f32_16x16x32_bf16 v[212:215], v[100:103], v[240:243], v[212:215]
    v_mov_b32_dpp v133, v135 quad_perm:[0,1,2,3] row_mask:0xf bank_mask:0xa
    v_perm_b32 v107, v250, v132, v252
    v_perm_b32 v111, v250, v132, v253
    v_mfma_f32_16x16x32_bf16 v[228:231], v[100:103], v[244:247], v[228:231]
    v_perm_b32 v115, v251, v133, v252
    v_perm_b32 v119, v251, v133, v253
    s_waitcnt lgkmcnt(0)
    ds_read_b128 v[232:235], v11 offset:96
    ds_read_b128 v[236:239], v11 offset:5472
    ds_read_b128 v[240:243], v11 offset:10848
    ds_read_b128 v[244:247], v11 offset:16224
    v_mfma_f32_16x16x32_bf16 v[168:171], v[104:107], v[12:15], v[168:171]
    s_waitcnt vmcnt(12)
    v_mov_b32_dpp v248, v136 row_shl:4 row_mask:0xf bank_mask:0x5
    v_mov_b32_dpp v248, v138 row_shr:4 row_mask:0xf bank_mask:0xa
    v_mfma_f32_16x16x32_bf16 v[184:187], v[104:107], v[16:19], v[184:187]
    v_mov_b32_dpp v249, v137 row_shl:4 row_mask:0xf bank_mask:0x5
    v_mov_b32_dpp v249, v139 row_shr:4 row_mask:0xf bank_mask:0xa
    v_mov_b32_dpp v136, v138 quad_perm:[0,1,2,3] row_mask:0xf bank_mask:0xa
    v_mfma_f32_16x16x32_bf16 v[200:203], v[104:107], v[20:23], v[200:203]
    v_mov_b32_dpp v137, v139 quad_perm:[0,1,2,3] row_mask:0xf bank_mask:0xa
    v_perm_b32 v120, v248, v136, v252
    v_mfma_f32_16x16x32_bf16 v[216:219], v[104:107], v[24:27], v[216:219]
    v_perm_b32 v124, v248, v136, v253
    v_perm_b32 v128, v249, v137, v252
    v_perm_b32 v132, v249, v137, v253
    v_mfma_f32_16x16x32_bf16 v[172:175], v[108:111], v[12:15], v[172:175]
    v_mov_b32_dpp v250, v140 row_shl:4 row_mask:0xf bank_mask:0x5
    v_mov_b32_dpp v250, v142 row_shr:4 row_mask:0xf bank_mask:0xa
    v_mfma_f32_16x16x32_bf16 v[188:191], v[108:111], v[16:19], v[188:191]
    v_mov_b32_dpp v251, v141 row_shl:4 row_mask:0xf bank_mask:0x5
    v_mov_b32_dpp v251, v143 row_shr:4 row_mask:0xf bank_mask:0xa
    v_mov_b32_dpp v140, v142 quad_perm:[0,1,2,3] row_mask:0xf bank_mask:0xa
    v_mfma_f32_16x16x32_bf16 v[204:207], v[108:111], v[20:23], v[204:207]
    v_mov_b32_dpp v141, v143 quad_perm:[0,1,2,3] row_mask:0xf bank_mask:0xa
    v_perm_b32 v121, v250, v140, v252
    v_mfma_f32_16x16x32_bf16 v[220:223], v[108:111], v[24:27], v[220:223]
    v_perm_b32 v125, v250, v140, v253
    v_perm_b32 v129, v251, v141, v252
    v_perm_b32 v133, v251, v141, v253
    v_mfma_f32_16x16x32_bf16 v[176:179], v[112:115], v[12:15], v[176:179]
    v_mov_b32_dpp v248, v144 row_shl:4 row_mask:0xf bank_mask:0x5
    v_mov_b32_dpp v248, v146 row_shr:4 row_mask:0xf bank_mask:0xa
    v_mov_b32_dpp v249, v145 row_shl:4 row_mask:0xf bank_mask:0x5
    v_mfma_f32_16x16x32_bf16 v[192:195], v[112:115], v[16:19], v[192:195]
    v_mov_b32_dpp v249, v147 row_shr:4 row_mask:0xf bank_mask:0xa
    v_mov_b32_dpp v144, v146 quad_perm:[0,1,2,3] row_mask:0xf bank_mask:0xa
    v_mfma_f32_16x16x32_bf16 v[208:211], v[112:115], v[20:23], v[208:211]
    v_mov_b32_dpp v145, v147 quad_perm:[0,1,2,3] row_mask:0xf bank_mask:0xa
    v_perm_b32 v122, v248, v144, v252
    v_perm_b32 v126, v248, v144, v253
    v_mfma_f32_16x16x32_bf16 v[224:227], v[112:115], v[24:27], v[224:227]
    v_perm_b32 v130, v249, v145, v252
    v_perm_b32 v134, v249, v145, v253
    v_mfma_f32_16x16x32_bf16 v[180:183], v[116:119], v[12:15], v[180:183]
    v_mov_b32_dpp v250, v148 row_shl:4 row_mask:0xf bank_mask:0x5
    v_mov_b32_dpp v250, v150 row_shr:4 row_mask:0xf bank_mask:0xa
    v_mov_b32_dpp v251, v149 row_shl:4 row_mask:0xf bank_mask:0x5
    v_mfma_f32_16x16x32_bf16 v[196:199], v[116:119], v[16:19], v[196:199]
    v_mov_b32_dpp v251, v151 row_shr:4 row_mask:0xf bank_mask:0xa
    v_mov_b32_dpp v148, v150 quad_perm:[0,1,2,3] row_mask:0xf bank_mask:0xa
    v_mfma_f32_16x16x32_bf16 v[212:215], v[116:119], v[20:23], v[212:215]
    v_mov_b32_dpp v149, v151 quad_perm:[0,1,2,3] row_mask:0xf bank_mask:0xa
    v_perm_b32 v123, v250, v148, v252
    v_perm_b32 v127, v250, v148, v253
    v_mfma_f32_16x16x32_bf16 v[228:231], v[116:119], v[24:27], v[228:231]
    v_perm_b32 v131, v251, v149, v252
    v_perm_b32 v135, v251, v149, v253
    s_waitcnt lgkmcnt(0)
    ds_read_b128 v[12:15], v11 offset:112
    ds_read_b128 v[16:19], v11 offset:5488
    ds_read_b128 v[20:23], v11 offset:10864
    ds_read_b128 v[24:27], v11 offset:16240
    v_mfma_f32_16x16x32_bf16 v[168:171], v[120:123], v[232:235], v[168:171]
    s_waitcnt vmcnt(8)
    v_mov_b32_dpp v248, v152 row_shl:4 row_mask:0xf bank_mask:0x5
    v_mov_b32_dpp v248, v154 row_shr:4 row_mask:0xf bank_mask:0xa
    v_mfma_f32_16x16x32_bf16 v[184:187], v[120:123], v[236:239], v[184:187]
    v_mov_b32_dpp v249, v153 row_shl:4 row_mask:0xf bank_mask:0x5
    v_mov_b32_dpp v249, v155 row_shr:4 row_mask:0xf bank_mask:0xa
    v_mov_b32_dpp v152, v154 quad_perm:[0,1,2,3] row_mask:0xf bank_mask:0xa
    v_mfma_f32_16x16x32_bf16 v[200:203], v[120:123], v[240:243], v[200:203]
    v_mov_b32_dpp v153, v155 quad_perm:[0,1,2,3] row_mask:0xf bank_mask:0xa
    v_perm_b32 v136, v248, v152, v252
    v_mfma_f32_16x16x32_bf16 v[216:219], v[120:123], v[244:247], v[216:219]
    v_perm_b32 v140, v248, v152, v253
    v_perm_b32 v144, v249, v153, v252
    v_perm_b32 v148, v249, v153, v253
    v_mfma_f32_16x16x32_bf16 v[172:175], v[124:127], v[232:235], v[172:175]
    v_mov_b32_dpp v250, v156 row_shl:4 row_mask:0xf bank_mask:0x5
    v_mov_b32_dpp v250, v158 row_shr:4 row_mask:0xf bank_mask:0xa
    v_mfma_f32_16x16x32_bf16 v[188:191], v[124:127], v[236:239], v[188:191]
    v_mov_b32_dpp v251, v157 row_shl:4 row_mask:0xf bank_mask:0x5
    v_mov_b32_dpp v251, v159 row_shr:4 row_mask:0xf bank_mask:0xa
    v_mov_b32_dpp v156, v158 quad_perm:[0,1,2,3] row_mask:0xf bank_mask:0xa
    v_mfma_f32_16x16x32_bf16 v[204:207], v[124:127], v[240:243], v[204:207]
    v_mov_b32_dpp v157, v159 quad_perm:[0,1,2,3] row_mask:0xf bank_mask:0xa
    v_perm_b32 v137, v250, v156, v252
    v_mfma_f32_16x16x32_bf16 v[220:223], v[124:127], v[244:247], v[220:223]
    v_perm_b32 v141, v250, v156, v253
    v_perm_b32 v145, v251, v157, v252
    v_perm_b32 v149, v251, v157, v253
    v_mfma_f32_16x16x32_bf16 v[176:179], v[128:131], v[232:235], v[176:179]
    v_mov_b32_dpp v248, v160 row_shl:4 row_mask:0xf bank_mask:0x5
    v_mov_b32_dpp v248, v162 row_shr:4 row_mask:0xf bank_mask:0xa
    v_mov_b32_dpp v249, v161 row_shl:4 row_mask:0xf bank_mask:0x5
    v_mfma_f32_16x16x32_bf16 v[192:195], v[128:131], v[236:239], v[192:195]
    v_mov_b32_dpp v249, v163 row_shr:4 row_mask:0xf bank_mask:0xa
    v_mov_b32_dpp v160, v162 quad_perm:[0,1,2,3] row_mask:0xf bank_mask:0xa
    v_mfma_f32_16x16x32_bf16 v[208:211], v[128:131], v[240:243], v[208:211]
    v_mov_b32_dpp v161, v163 quad_perm:[0,1,2,3] row_mask:0xf bank_mask:0xa
    v_perm_b32 v138, v248, v160, v252
    v_perm_b32 v142, v248, v160, v253
    v_mfma_f32_16x16x32_bf16 v[224:227], v[128:131], v[244:247], v[224:227]
    v_perm_b32 v146, v249, v161, v252
    v_perm_b32 v150, v249, v161, v253
    v_mfma_f32_16x16x32_bf16 v[180:183], v[132:135], v[232:235], v[180:183]
    v_mov_b32_dpp v250, v164 row_shl:4 row_mask:0xf bank_mask:0x5
    v_mov_b32_dpp v250, v166 row_shr:4 row_mask:0xf bank_mask:0xa
    v_mov_b32_dpp v251, v165 row_shl:4 row_mask:0xf bank_mask:0x5
    v_mfma_f32_16x16x32_bf16 v[196:199], v[132:135], v[236:239], v[196:199]
    v_mov_b32_dpp v251, v167 row_shr:4 row_mask:0xf bank_mask:0xa
    v_mov_b32_dpp v164, v166 quad_perm:[0,1,2,3] row_mask:0xf bank_mask:0xa
    v_mfma_f32_16x16x32_bf16 v[212:215], v[132:135], v[240:243], v[212:215]
    v_mov_b32_dpp v165, v167 quad_perm:[0,1,2,3] row_mask:0xf bank_mask:0xa
    v_perm_b32 v139, v250, v164, v252
    v_perm_b32 v143, v250, v164, v253
    v_mfma_f32_16x16x32_bf16 v[228:231], v[132:135], v[244:247], v[228:231]
    v_perm_b32 v147, v251, v165, v252
    v_perm_b32 v151, v251, v165, v253
    s_waitcnt lgkmcnt(0)
    ds_read_b128 v[232:235], v11 offset:128
    ds_read_b128 v[236:239], v11 offset:5504
    ds_read_b128 v[240:243], v11 offset:10880
    ds_read_b128 v[244:247], v11 offset:16256
    v_mfma_f32_16x16x32_bf16 v[168:171], v[136:139], v[12:15], v[168:171]
    s_waitcnt vmcnt(4)
    v_mov_b32_dpp v248, v40 row_shl:4 row_mask:0xf bank_mask:0x5
    v_mov_b32_dpp v248, v42 row_shr:4 row_mask:0xf bank_mask:0xa
    v_mfma_f32_16x16x32_bf16 v[184:187], v[136:139], v[16:19], v[184:187]
    v_mov_b32_dpp v249, v41 row_shl:4 row_mask:0xf bank_mask:0x5
    v_mov_b32_dpp v249, v43 row_shr:4 row_mask:0xf bank_mask:0xa
    v_mov_b32_dpp v40, v42 quad_perm:[0,1,2,3] row_mask:0xf bank_mask:0xa
    v_mfma_f32_16x16x32_bf16 v[200:203], v[136:139], v[20:23], v[200:203]
    v_mov_b32_dpp v41, v43 quad_perm:[0,1,2,3] row_mask:0xf bank_mask:0xa
    v_perm_b32 v152, v248, v40, v252
    v_mfma_f32_16x16x32_bf16 v[216:219], v[136:139], v[24:27], v[216:219]
    v_perm_b32 v156, v248, v40, v253
    v_perm_b32 v160, v249, v41, v252
    v_perm_b32 v164, v249, v41, v253
    v_mfma_f32_16x16x32_bf16 v[172:175], v[140:143], v[12:15], v[172:175]
    v_mov_b32_dpp v250, v44 row_shl:4 row_mask:0xf bank_mask:0x5
    v_mov_b32_dpp v250, v46 row_shr:4 row_mask:0xf bank_mask:0xa
    v_mfma_f32_16x16x32_bf16 v[188:191], v[140:143], v[16:19], v[188:191]
    v_mov_b32_dpp v251, v45 row_shl:4 row_mask:0xf bank_mask:0x5
    v_mov_b32_dpp v251, v47 row_shr:4 row_mask:0xf bank_mask:0xa
    v_mov_b32_dpp v44, v46 quad_perm:[0,1,2,3] row_mask:0xf bank_mask:0xa
    v_mfma_f32_16x16x32_bf16 v[204:207], v[140:143], v[20:23], v[204:207]
    v_mov_b32_dpp v45, v47 quad_perm:[0,1,2,3] row_mask:0xf bank_mask:0xa
    v_perm_b32 v153, v250, v44, v252
    v_mfma_f32_16x16x32_bf16 v[220:223], v[140:143], v[24:27], v[220:223]
    v_perm_b32 v157, v250, v44, v253
    v_perm_b32 v161, v251, v45, v252
    v_perm_b32 v165, v251, v45, v253
    v_mfma_f32_16x16x32_bf16 v[176:179], v[144:147], v[12:15], v[176:179]
    v_mov_b32_dpp v248, v48 row_shl:4 row_mask:0xf bank_mask:0x5
    v_mov_b32_dpp v248, v50 row_shr:4 row_mask:0xf bank_mask:0xa
    v_mov_b32_dpp v249, v49 row_shl:4 row_mask:0xf bank_mask:0x5
    v_mfma_f32_16x16x32_bf16 v[192:195], v[144:147], v[16:19], v[192:195]
    v_mov_b32_dpp v249, v51 row_shr:4 row_mask:0xf bank_mask:0xa
    v_mov_b32_dpp v48, v50 quad_perm:[0,1,2,3] row_mask:0xf bank_mask:0xa
    v_mfma_f32_16x16x32_bf16 v[208:211], v[144:147], v[20:23], v[208:211]
    v_mov_b32_dpp v49, v51 quad_perm:[0,1,2,3] row_mask:0xf bank_mask:0xa
    v_perm_b32 v154, v248, v48, v252
    v_perm_b32 v158, v248, v48, v253
    v_mfma_f32_16x16x32_bf16 v[224:227], v[144:147], v[24:27], v[224:227]
    v_perm_b32 v162, v249, v49, v252
    v_perm_b32 v166, v249, v49, v253
    v_mfma_f32_16x16x32_bf16 v[180:183], v[148:151], v[12:15], v[180:183]
    v_mov_b32_dpp v250, v52 row_shl:4 row_mask:0xf bank_mask:0x5
    v_mov_b32_dpp v250, v54 row_shr:4 row_mask:0xf bank_mask:0xa
    v_mov_b32_dpp v251, v53 row_shl:4 row_mask:0xf bank_mask:0x5
    v_mfma_f32_16x16x32_bf16 v[196:199], v[148:151], v[16:19], v[196:199]
    v_mov_b32_dpp v251, v55 row_shr:4 row_mask:0xf bank_mask:0xa
    v_mov_b32_dpp v52, v54 quad_perm:[0,1,2,3] row_mask:0xf bank_mask:0xa
    v_mfma_f32_16x16x32_bf16 v[212:215], v[148:151], v[20:23], v[212:215]
    v_mov_b32_dpp v53, v55 quad_perm:[0,1,2,3] row_mask:0xf bank_mask:0xa
    v_perm_b32 v155, v250, v52, v252
    v_perm_b32 v159, v250, v52, v253
    v_mfma_f32_16x16x32_bf16 v[228:231], v[148:151], v[24:27], v[228:231]
    v_perm_b32 v163, v251, v53, v252
    v_perm_b32 v167, v251, v53, v253
    s_waitcnt lgkmcnt(0)
    ds_read_b128 v[12:15], v11 offset:144
    ds_read_b128 v[16:19], v11 offset:5520
    ds_read_b128 v[20:23], v11 offset:10896
    ds_read_b128 v[24:27], v11 offset:16272
    v_mfma_f32_16x16x32_bf16 v[168:171], v[152:155], v[232:235], v[168:171]
    s_waitcnt vmcnt(0)
    v_mov_b32_dpp v248, v56 row_shl:4 row_mask:0xf bank_mask:0x5
    v_mov_b32_dpp v248, v58 row_shr:4 row_mask:0xf bank_mask:0xa
    v_mfma_f32_16x16x32_bf16 v[184:187], v[152:155], v[236:239], v[184:187]
    v_mov_b32_dpp v249, v57 row_shl:4 row_mask:0xf bank_mask:0x5
    v_mov_b32_dpp v249, v59 row_shr:4 row_mask:0xf bank_mask:0xa
    v_mov_b32_dpp v56, v58 quad_perm:[0,1,2,3] row_mask:0xf bank_mask:0xa
    v_mfma_f32_16x16x32_bf16 v[200:203], v[152:155], v[240:243], v[200:203]
    v_mov_b32_dpp v57, v59 quad_perm:[0,1,2,3] row_mask:0xf bank_mask:0xa
    v_perm_b32 v40, v248, v56, v252
    v_mfma_f32_16x16x32_bf16 v[216:219], v[152:155], v[244:247], v[216:219]
    v_perm_b32 v44, v248, v56, v253
    v_perm_b32 v48, v249, v57, v252
    v_perm_b32 v52, v249, v57, v253
    v_mfma_f32_16x16x32_bf16 v[172:175], v[156:159], v[232:235], v[172:175]
    v_mov_b32_dpp v250, v60 row_shl:4 row_mask:0xf bank_mask:0x5
    v_mov_b32_dpp v250, v62 row_shr:4 row_mask:0xf bank_mask:0xa
    v_mfma_f32_16x16x32_bf16 v[188:191], v[156:159], v[236:239], v[188:191]
    v_mov_b32_dpp v251, v61 row_shl:4 row_mask:0xf bank_mask:0x5
    v_mov_b32_dpp v251, v63 row_shr:4 row_mask:0xf bank_mask:0xa
    v_mov_b32_dpp v60, v62 quad_perm:[0,1,2,3] row_mask:0xf bank_mask:0xa
    v_mfma_f32_16x16x32_bf16 v[204:207], v[156:159], v[240:243], v[204:207]
    v_mov_b32_dpp v61, v63 quad_perm:[0,1,2,3] row_mask:0xf bank_mask:0xa
    v_perm_b32 v41, v250, v60, v252
    v_mfma_f32_16x16x32_bf16 v[220:223], v[156:159], v[244:247], v[220:223]
    v_perm_b32 v45, v250, v60, v253
    v_perm_b32 v49, v251, v61, v252
    v_perm_b32 v53, v251, v61, v253
    v_mfma_f32_16x16x32_bf16 v[176:179], v[160:163], v[232:235], v[176:179]
    v_mov_b32_dpp v248, v64 row_shl:4 row_mask:0xf bank_mask:0x5
    v_mov_b32_dpp v248, v66 row_shr:4 row_mask:0xf bank_mask:0xa
    v_mov_b32_dpp v249, v65 row_shl:4 row_mask:0xf bank_mask:0x5
    v_mfma_f32_16x16x32_bf16 v[192:195], v[160:163], v[236:239], v[192:195]
    v_mov_b32_dpp v249, v67 row_shr:4 row_mask:0xf bank_mask:0xa
    v_mov_b32_dpp v64, v66 quad_perm:[0,1,2,3] row_mask:0xf bank_mask:0xa
    v_mfma_f32_16x16x32_bf16 v[208:211], v[160:163], v[240:243], v[208:211]
    v_mov_b32_dpp v65, v67 quad_perm:[0,1,2,3] row_mask:0xf bank_mask:0xa
    v_perm_b32 v42, v248, v64, v252
    v_perm_b32 v46, v248, v64, v253
    v_mfma_f32_16x16x32_bf16 v[224:227], v[160:163], v[244:247], v[224:227]
    v_perm_b32 v50, v249, v65, v252
    v_perm_b32 v54, v249, v65, v253
    v_mfma_f32_16x16x32_bf16 v[180:183], v[164:167], v[232:235], v[180:183]
    v_mov_b32_dpp v250, v68 row_shl:4 row_mask:0xf bank_mask:0x5
    v_mov_b32_dpp v250, v70 row_shr:4 row_mask:0xf bank_mask:0xa
    v_mov_b32_dpp v251, v69 row_shl:4 row_mask:0xf bank_mask:0x5
    v_mfma_f32_16x16x32_bf16 v[196:199], v[164:167], v[236:239], v[196:199]
    v_mov_b32_dpp v251, v71 row_shr:4 row_mask:0xf bank_mask:0xa
    v_mov_b32_dpp v68, v70 quad_perm:[0,1,2,3] row_mask:0xf bank_mask:0xa
    v_mfma_f32_16x16x32_bf16 v[212:215], v[164:167], v[240:243], v[212:215]
    v_mov_b32_dpp v69, v71 quad_perm:[0,1,2,3] row_mask:0xf bank_mask:0xa
    v_perm_b32 v43, v250, v68, v252
    v_perm_b32 v47, v250, v68, v253
    v_mfma_f32_16x16x32_bf16 v[228:231], v[164:167], v[244:247], v[228:231]
    v_perm_b32 v51, v251, v69, v252
    v_perm_b32 v55, v251, v69, v253
    s_waitcnt lgkmcnt(0)
    v_mfma_f32_16x16x32_bf16 v[168:171], v[40:43], v[12:15], v[168:171]
    v_mfma_f32_16x16x32_bf16 v[184:187], v[40:43], v[16:19], v[184:187]
    v_mfma_f32_16x16x32_bf16 v[200:203], v[40:43], v[20:23], v[200:203]
    v_mfma_f32_16x16x32_bf16 v[216:219], v[40:43], v[24:27], v[216:219]
    v_mfma_f32_16x16x32_bf16 v[172:175], v[44:47], v[12:15], v[172:175]
    v_mfma_f32_16x16x32_bf16 v[188:191], v[44:47], v[16:19], v[188:191]
    v_mfma_f32_16x16x32_bf16 v[204:207], v[44:47], v[20:23], v[204:207]
    v_mfma_f32_16x16x32_bf16 v[220:223], v[44:47], v[24:27], v[220:223]
    v_mfma_f32_16x16x32_bf16 v[176:179], v[48:51], v[12:15], v[176:179]
    v_mfma_f32_16x16x32_bf16 v[192:195], v[48:51], v[16:19], v[192:195]
    v_mfma_f32_16x16x32_bf16 v[208:211], v[48:51], v[20:23], v[208:211]
    v_mfma_f32_16x16x32_bf16 v[224:227], v[48:51], v[24:27], v[224:227]
    v_mfma_f32_16x16x32_bf16 v[180:183], v[52:55], v[12:15], v[180:183]
    v_mfma_f32_16x16x32_bf16 v[196:199], v[52:55], v[16:19], v[196:199]
    v_mfma_f32_16x16x32_bf16 v[212:215], v[52:55], v[20:23], v[212:215]
    v_mfma_f32_16x16x32_bf16 v[228:231], v[52:55], v[24:27], v[228:231]
    s_branch LK1_g2Q
LK1_g1Q:
    ds_read_b128 v[232:235], v11 offset:0
    ds_read_b128 v[236:239], v11 offset:5376
    ds_read_b128 v[240:243], v11 offset:10752
    ds_read_b128 v[244:247], v11 offset:16128
    s_waitcnt lgkmcnt(0)
    ds_read_b128 v[12:15], v11 offset:16
    ds_read_b128 v[16:19], v11 offset:5392
    ds_read_b128 v[20:23], v11 offset:10768
    ds_read_b128 v[24:27], v11 offset:16144
    v_mfma_f32_16x16x32_bf16 v[168:171], v[152:155], v[232:235], 0
    v_mfma_f32_16x16x32_bf16 v[184:187], v[152:155], v[236:239], 0
    v_mfma_f32_16x16x32_bf16 v[200:203], v[152:155], v[240:243], 0
    v_mfma_f32_16x16x32_bf16 v[216:219], v[152:155], v[244:247], 0
    v_mfma_f32_16x16x32_bf16 v[172:175], v[156:159], v[232:235], 0
    v_mfma_f32_16x16x32_bf16 v[188:191], v[156:159], v[236:239], 0
    v_mfma_f32_16x16x32_bf16 v[204:207], v[156:159], v[240:243], 0
    v_mfma_f32_16x16x32_bf16 v[220:223], v[156:159], v[244:247], 0
    v_mfma_f32_16x16x32_bf16 v[176:179], v[160:163], v[232:235], 0
    v_mfma_f32_16x16x32_bf16 v[192:195], v[160:163], v[236:239], 0
    v_mfma_f32_16x16x32_bf16 v[208:211], v[160:163], v[240:243], 0
    v_mfma_f32_16x16x32_bf16 v[224:227], v[160:163], v[244:247], 0
    v_mfma_f32_16x16x32_bf16 v[180:183], v[164:167], v[232:235], 0
    v_mfma_f32_16x16x32_bf16 v[196:199], v[164:167], v[236:239], 0
    v_mfma_f32_16x16x32_bf16 v[212:215], v[164:167], v[240:243], 0
    v_mfma_f32_16x16x32_bf16 v[228:231], v[164:167], v[244:247], 0
    buffer_load_dwordx4 v[152:155], v4, s[8:11], s20 offen
    buffer_load_dwordx4 v[156:159], v4, s[8:11], s21 offen
    buffer_load_dwordx4 v[160:163], v4, s[8:11], s22 offen
    buffer_load_dwordx4 v[164:167], v4, s[8:11], s23 offen
    s_add_u32 s20, s20, 30720
    s_add_u32 s21, s21, 30720
    s_add_u32 s22, s22, 30720
    s_add_u32 s23, s23, 30720
    s_waitcnt lgkmcnt(0)
    ds_read_b128 v[232:235], v11 offset:32
    ds_read_b128 v[236:239], v11 offset:5408
    ds_read_b128 v[240:243], v11 offset:10784
    ds_read_b128 v[244:247], v11 offset:16160
    v_mfma_f32_16x16x32_bf16 v[168:171], v[40:43], v[12:15], v[168:171]
    s_waitcnt vmcnt(20)
    v_mov_b32_dpp v248, v72 row_shl:4 row_mask:0xf bank_mask:0x5
    v_mov_b32_dpp v248, v74 row_shr:4 row_mask:0xf bank_mask:0xa
    v_mfma_f32_16x16x32_bf16 v[184:187], v[40:43], v[16:19], v[184:187]
    v_mov_b32_dpp v249, v73 row_shl:4 row_mask:0xf bank_mask:0x5
    v_mov_b32_dpp v249, v75 row_shr:4 row_mask:0xf bank_mask:0xa
    v_mov_b32_dpp v72, v74 quad_perm:[0,1,2,3] row_mask:0xf bank_mask:0xa
    v_mfma_f32_16x16x32_bf16 v[200:203], v[40:43], v[20:23], v[200:203]
    v_mov_b32_dpp v73, v75 quad_perm:[0,1,2,3] row_mask:0xf bank_mask:0xa
    v_perm_b32 v56, v248, v72, v252
    v_mfma_f32_16x16x32_bf16 v[216:219], v[40:43], v[24:27], v[216:219]
    v_perm_b32 v60, v248, v72, v253
    v_perm_b32 v64, v249, v73, v252
    v_perm_b32 v68, v249, v73, v253
    v_mfma_f32_16x16x32_bf16 v[172:175], v[44:47], v[12:15], v[172:175]
    v_mov_b32_dpp v250, v76 row_shl:4 row_mask:0xf bank_mask:0x5
    v_mov_b32_dpp v250, v78 row_shr:4 row_mask:0xf bank_mask:0xa
    v_mfma_f32_16x16x32_bf16 v[188:191], v[44:47], v[16:19], v[188:191]
    v_mov_b32_dpp v251, v77 row_shl:4 row_mask:0xf bank_mask:0x5
    v_mov_b32_dpp v251, v79 row_shr:4 row_mask:0xf bank_mask:0xa
    v_mov_b32_dpp v76, v78 quad_perm:[0,1,2,3] row_mask:0xf bank_mask:0xa
    v_mfma_f32_16x16x32_bf16 v[204:207], v[44:47], v[20:23], v[204:207]
    v_mov_b32_dpp v77, v79 quad_perm:[0,1,2,3] row_mask:0xf bank_mask:0xa
    v_perm_b32 v57, v250, v76, v252
    v_mfma_f32_16x16x32_bf16 v[220:223], v[44:47], v[24:27], v[220:223]
    v_perm_b32 v61, v250, v76, v253
    v_perm_b32 v65, v251, v77, v252
    v_perm_b32 v69, v251, v77, v253
    v_mfma_f32_16x16x32_bf16 v[176:179], v[48:51], v[12:15], v[176:179]
    v_mov_b32_dpp v248, v80 row_shl:4 row_mask:0xf bank_mask:0x5
    v_mov_b32_dpp v248, v82 row_shr:4 row_mask:0xf bank_mask:0xa
    v_mov_b32_dpp v249, v81 row_shl:4 row_mask:0xf bank_mask:0x5
    v_mfma_f32_16x16x32_bf16 v[192:195], v[48:51], v[16:19], v[192:195]
    v_mov_b32_dpp v249, v83 row_shr:4 row_mask:0xf bank_mask:0xa
    v_mov_b32_dpp v80, v82 quad_perm:[0,1,2,3] row_mask:0xf bank_mask:0xa
    v_mfma_f32_16x16x32_bf16 v[208:211], v[48:51], v[20:23], v[208:211]
    v_mov_b32_dpp v81, v83 quad_perm:[0,1,2,3] row_mask:0xf bank_mask:0xa
    v_perm_b32 v58, v248, v80, v252
    v_perm_b32 v62, v248, v80, v253
    v_mfma_f32_16x16x32_bf16 v[224:227], v[48:51], v[24:27], v[224:227]
    v_perm_b32 v66, v249, v81, v252
    v_perm_b32 v70, v249, v81, v253
    v_mfma_f32_16x16x32_bf16 v[180:183], v[52:55], v[12:15], v[180:183]
    v_mov_b32_dpp v250, v84 row_shl:4 row_mask:0xf bank_mask:0x5
    v_mov_b32_dpp v250, v86 row_shr:4 row_mask:0xf bank_mask:0xa
    v_mov_b32_dpp v251, v85 row_shl:4 row_mask:0xf bank_mask:0x5
    v_mfma_f32_16x16x32_bf16 v[196:199], v[52:55], v[16:19], v[196:199]
    v_mov_b32_dpp v251, v87 row_shr:4 row_mask:0xf bank_mask:0xa
    v_mov_b32_dpp v84, v86 quad_perm:[0,1,2,3] row_mask:0xf bank_mask:0xa
    v_mfma_f32_16x16x32_bf16 v[212:215], v[52:55], v[20:23], v[212:215]
    v_mov_b32_dpp v85, v87 quad_perm:[0,1,2,3] row_mask:0xf bank_mask:0xa
    v_perm_b32 v59, v250, v84, v252
    v_perm_b32 v63, v250, v84, v253
    v_mfma_f32_16x16x32_bf16 v[228:231], v[52:55], v[24:27], v[228:231]
    v_perm_b32 v67, v251, v85, v252
    v_perm_b32 v71, v251, v85, v253
    buffer_load_dwordx4 v[40:43], v4, s[8:11], s20 offen
    buffer_load_dwordx4 v[44:47], v4, s[8:11], s21 offen
    buffer_load_dwordx4 v[48:51], v4, s[8:11], s22 offen
    buffer_load_dwordx4 v[52:55], v4, s[8:11], s23 offen
    s_add_u32 s20, s20, 30720
    s_add_u32 s21, s21, 30720
    s_add_u32 s22, s22, 30720
    s_add_u32 s23, s23, 30720
    s_waitcnt lgkmcnt(0)
    ds_read_b128 v[12:15], v11 offset:48
    ds_read_b128 v[16:19], v11 offset:5424
    ds_read_b128 v[20:23], v11 offset:10800
    ds_read_b128 v[24:27], v11 offset:16176
    v_mfma_f32_16x16x32_bf16 v[168:171], v[56:59], v[232:235], v[168:171]
    s_waitcnt vmcnt(20)
    v_mov_b32_dpp v248, v88 row_shl:4 row_mask:0xf bank_mask:0x5
    v_mov_b32_dpp v248, v90 row_shr:4 row_mask:0xf bank_mask:0xa
    v_mfma_f32_16x16x32_bf16 v[184:187], v[56:59], v[236:239], v[184:187]
    v_mov_b32_dpp v249, v89 row_shl:4 row_mask:0xf bank_mask:0x5
    v_mov_b32_dpp v249, v91 row_shr:4 row_mask:0xf bank_mask:0xa
    v_mov_b32_dpp v88, v90 quad_perm:[0,1,2,3] row_mask:0xf bank_mask:0xa
    v_mfma_f32_16x16x32_bf16 v[200:203], v[56:59], v[240:243], v[200:203]
    v_mov_b32_dpp v89, v91 quad_perm:[0,1,2,3] row_mask:0xf bank_mask:0xa
    v_perm_b32 v72, v248, v88, v252
    v_mfma_f32_16x16x32_bf16 v[216:219], v[56:59], v[244:247], v[216:219]
    v_perm_b32 v76, v248, v88, v253
    v_perm_b32 v80, v249, v89, v252
    v_perm_b32 v84, v249, v89, v253
    v_mfma_f32_16x16x32_bf16 v[172:175], v[60:63], v[232:235], v[172:175]
    v_mov_b32_dpp v250, v92 row_shl:4 row_mask:0xf bank_mask:0x5
    v_mov_b32_dpp v250, v94 row_shr:4 row_mask:0xf bank_mask:0xa
    v_mfma_f32_16x16x32_bf16 v[188:191], v[60:63], v[236:239], v[188:191]
    v_mov_b32_dpp v251, v93 row_shl:4 row_mask:0xf bank_mask:0x5
    v_mov_b32_dpp v251, v95 row_shr:4 row_mask:0xf bank_mask:0xa
    v_mov_b32_dpp v92, v94 quad_perm:[0,1,2,3] row_mask:0xf bank_mask:0xa
    v_mfma_f32_16x16x32_bf16 v[204:207], v[60:63], v[240:243], v[204:207]
    v_mov_b32_dpp v93, v95 quad_perm:[0,1,2,3] row_mask:0xf bank_mask:0xa
    v_perm_b32 v73, v250, v92, v252
    v_mfma_f32_16x16x32_bf16 v[220:223], v[60:63], v[244:247], v[220:223]
    v_perm_b32 v77, v250, v92, v253
    v_perm_b32 v81, v251, v93, v252
    v_perm_b32 v85, v251, v93, v253
    v_mfma_f32_16x16x32_bf16 v[176:179], v[64:67], v[232:235], v[176:179]
    v_mov_b32_dpp v248, v96 row_shl:4 row_mask:0xf bank_mask:0x5
    v_mov_b32_dpp v248, v98 row_shr:4 row_mask:0xf bank_mask:0xa
    v_mov_b32_dpp v249, v97 row_shl:4 row_mask:0xf bank_mask:0x5
    v_mfma_f32_16x16x32_bf16 v[192:195], v[64:67], v[236:239], v[192:195]
    v_mov_b32_dpp v249, v99 row_shr:4 row_mask:0xf bank_mask:0xa
    v_mov_b32_dpp v96, v98 quad_perm:[0,1,2,3] row_mask:0xf bank_mask:0xa
    v_mfma_f32_16x16x32_bf16 v[208:211], v[64:67], v[240:243], v[208:211]
    v_mov_b32_dpp v97, v99 quad_perm:[0,1,2,3] row_mask:0xf bank_mask:0xa
    v_perm_b32 v74, v248, v96, v252
    v_perm_b32 v78, v248, v96, v253
    v_mfma_f32_16x16x32_bf16 v[224:227], v[64:67], v[244:247], v[224:227]
    v_perm_b32 v82, v249, v97, v252
    v_perm_b32 v86, v249, v97, v253
    v_mfma_f32_16x16x32_bf16 v[180:183], v[68:71], v[232:235], v[180:183]
    v_mov_b32_dpp v250, v100 row_shl:4 row_mask:0xf bank_mask:0x5
    v_mov_b32_dpp v250, v102 row_shr:4 row_mask:0xf bank_mask:0xa
    v_mov_b32_dpp v251, v101 row_shl:4 row_mask:0xf bank_mask:0x5
    v_mfma_f32_16x16x32_bf16 v[196:199], v[68:71], v[236:239], v[196:199]
    v_mov_b32_dpp v251, v103 row_shr:4 row_mask:0xf bank_mask:0xa
    v_mov_b32_dpp v100, v102 quad_perm:[0,1,2,3] row_mask:0xf bank_mask:0xa
    v_mfma_f32_16x16x32_bf16 v[212:215], v[68:71], v[240:243], v[212:215]
    v_mov_b32_dpp v101, v103 quad_perm:[0,1,2,3] row_mask:0xf bank_mask:0xa
    v_perm_b32 v75, v250, v100, v252
    v_perm_b32 v79, v250, v100, v253
    v_mfma_f32_16x16x32_bf16 v[228:231], v[68:71], v[244:247], v[228:231]
    v_perm_b32 v83, v251, v101, v252
    v_perm_b32 v87, v251, v101, v253
    buffer_load_dwordx4 v[56:59], v4, s[8:11], s20 offen
    buffer_load_dwordx4 v[60:63], v4, s[8:11], s21 offen
    buffer_load_dwordx4 v[64:67], v4, s[8:11], s22 offen
    buffer_load_dwordx4 v[68:71], v4, s[8:11], s23 offen
    s_add_u32 s20, s20, 30720
    s_add_u32 s21, s21, 30720
    s_add_u32 s22, s22, 30720
    s_add_u32 s23, s23, 30720
    s_waitcnt lgkmcnt(0)
    ds_read_b128 v[232:235], v11 offset:64
    ds_read_b128 v[236:239], v11 offset:5440
    ds_read_b128 v[240:243], v11 offset:10816
    ds_read_b128 v[244:247], v11 offset:16192
    v_mfma_f32_16x16x32_bf16 v[168:171], v[72:75], v[12:15], v[168:171]
    s_waitcnt vmcnt(20)
    v_mov_b32_dpp v248, v104 row_shl:4 row_mask:0xf bank_mask:0x5
    v_mov_b32_dpp v248, v106 row_shr:4 row_mask:0xf bank_mask:0xa
    v_mfma_f32_16x16x32_bf16 v[184:187], v[72:75], v[16:19], v[184:187]
    v_mov_b32_dpp v249, v105 row_shl:4 row_mask:0xf bank_mask:0x5
    v_mov_b32_dpp v249, v107 row_shr:4 row_mask:0xf bank_mask:0xa
    v_mov_b32_dpp v104, v106 quad_perm:[0,1,2,3] row_mask:0xf bank_mask:0xa
    v_mfma_f32_16x16x32_bf16 v[200:203], v[72:75], v[20:23], v[200:203]
    v_mov_b32_dpp v105, v107 quad_perm:[0,1,2,3] row_mask:0xf bank_mask:0xa
    v_perm_b32 v88, v248, v104, v252
    v_mfma_f32_16x16x32_bf16 v[216:219], v[72:75], v[24:27], v[216:219]
    v_perm_b32 v92, v248, v104, v253
    v_perm_b32 v96, v249, v105, v252
    v_perm_b32 v100, v249, v105, v253
    v_mfma_f32_16x16x32_bf16 v[172:175], v[76:79], v[12:15], v[172:175]
    v_mov_b32_dpp v250, v108 row_shl:4 row_mask:0xf bank_mask:0x5
    v_mov_b32_dpp v250, v110 row_shr:4 row_mask:0xf bank_mask:0xa
    v_mfma_f32_16x16x32_bf16 v[188:191], v[76:79], v[16:19], v[188:191]
    v_mov_b32_dpp v251, v109 row_shl:4 row_mask:0xf bank_mask:0x5
    v_mov_b32_dpp v251, v111 row_shr:4 row_mask:0xf bank_mask:0xa
    v_mov_b32_dpp v108, v110 quad_perm:[0,1,2,3] row_mask:0xf bank_mask:0xa
    v_mfma_f32_16x16x32_bf16 v[204:207], v[76:79], v[20:23], v[204:207]
    v_mov_b32_dpp v109, v111 quad_perm:[0,1,2,3] row_mask:0xf bank_mask:0xa
    v_perm_b32 v89, v250, v108, v252
    v_mfma_f32_16x16x32_bf16 v[220:223], v[76:79], v[24:27], v[220:223]
    v_perm_b32 v93, v250, v108, v253
    v_perm_b32 v97, v251, v109, v252
    v_perm_b32 v101, v251, v109, v253
    v_mfma_f32_16x16x32_bf16 v[176:179], v[80:83], v[12:15], v[176:179]
    v_mov_b32_dpp v248, v112 row_shl:4 row_mask:0xf bank_mask:0x5
    v_mov_b32_dpp v248, v114 row_shr:4 row_mask:0xf bank_mask:0xa
    v_mov_b32_dpp v249, v113 row_shl:4 row_mask:0xf bank_mask:0x5
    v_mfma_f32_16x16x32_bf16 v[192:195], v[80:83], v[16:19], v[192:195]
    v_mov_b32_dpp v249, v115 row_shr:4 row_mask:0xf bank_mask:0xa
    v_mov_b32_dpp v112, v114 quad_perm:[0,1,2,3] row_mask:0xf bank_mask:0xa
    v_mfma_f32_16x16x32_bf16 v[208:211], v[80:83], v[20:23], v[208:211]
    v_mov_b32_dpp v113, v115 quad_perm:[0,1,2,3] row_mask:0xf bank_mask:0xa
    v_perm_b32 v90, v248, v112, v252
    v_perm_b32 v94, v248, v112, v253
    v_mfma_f32_16x16x32_bf16 v[224:227], v[80:83], v[24:27], v[224:227]
    v_perm_b32 v98, v249, v113, v252
    v_perm_b32 v102, v249, v113, v253
    v_mfma_f32_16x16x32_bf16 v[180:183], v[84:87], v[12:15], v[180:183]
    v_mov_b32_dpp v250, v116 row_shl:4 row_mask:0xf bank_mask:0x5
    v_mov_b32_dpp v250, v118 row_shr:4 row_mask:0xf bank_mask:0xa
    v_mov_b32_dpp v251, v117 row_shl:4 row_mask:0xf bank_mask:0x5
    v_mfma_f32_16x16x32_bf16 v[196:199], v[84:87], v[16:19], v[196:199]
    v_mov_b32_dpp v251, v119 row_shr:4 row_mask:0xf bank_mask:0xa
    v_mov_b32_dpp v116, v118 quad_perm:[0,1,2,3] row_mask:0xf bank_mask:0xa
    v_mfma_f32_16x16x32_bf16 v[212:215], v[84:87], v[20:23], v[212:215]
    v_mov_b32_dpp v117, v119 quad_perm:[0,1,2,3] row_mask:0xf bank_mask:0xa
    v_perm_b32 v91, v250, v116, v252
    v_perm_b32 v95, v250, v116, v253
    v_mfma_f32_16x16x32_bf16 v[228:231], v[84:87], v[24:27], v[228:231]
    v_perm_b32 v99, v251, v117, v252
    v_perm_b32 v103, v251, v117, v253
    s_waitcnt lgkmcnt(0)
    ds_read_b128 v[12:15], v11 offset:80
    ds_read_b128 v[16:19], v11 offset:5456
    ds_read_b128 v[20:23], v11 offset:10832
    ds_read_b128 v[24:27], v11 offset:16208
    v_mfma_f32_16x16x32_bf16 v[168:171], v[88:91], v[232:235], v[168:171]
    s_waitcnt vmcnt(16)
    v_mov_b32_dpp v248, v120 row_shl:4 row_mask:0xf bank_mask:0x5
    v_mov_b32_dpp v248, v122 row_shr:4 row_mask:0xf bank_mask:0xa
    v_mfma_f32_16x16x32_bf16 v[184:187], v[88:91], v[236:239], v[184:187]
    v_mov_b32_dpp v249, v121 row_shl:4 row_mask:0xf bank_mask:0x5
    v_mov_b32_dpp v249, v123 row_shr:4 row_mask:0xf bank_mask:0xa
    v_mov_b32_dpp v120, v122 quad_perm:[0,1,2,3] row_mask:0xf bank_mask:0xa
    v_mfma_f32_16x16x32_bf16 v[200:203], v[88:91], v[240:243], v[200:203]
    v_mov_b32_dpp v121, v123 quad_perm:[0,1,2,3] row_mask:0xf bank_mask:0xa
    v_perm_b32 v104, v248, v120, v252
    v_mfma_f32_16x16x32_bf16 v[216:219], v[88:91], v[244:247], v[216:219]
    v_perm_b32 v108, v248, v120, v253
    v_perm_b32 v112, v249, v121, v252
    v_perm_b32 v116, v249, v121, v253
    v_mfma_f32_16x16x32_bf16 v[172:175], v[92:95], v[232:235], v[172:175]
    v_mov_b32_dpp v250, v124 row_shl:4 row_mask:0xf bank_mask:0x5
    v_mov_b32_dpp v250, v126 row_shr:4 row_mask:0xf bank_mask:0xa
    v_mfma_f32_16x16x32_bf16 v[188:191], v[92:95], v[236:239], v[188:191]
    v_mov_b32_dpp v251, v125 row_shl:4 row_mask:0xf bank_mask:0x5
    v_mov_b32_dpp v251, v127 row_shr:4 row_mask:0xf bank_mask:0xa
    v_mov_b32_dpp v124, v126 quad_perm:[0,1,2,3] row_mask:0xf bank_mask:0xa
    v_mfma_f32_16x16x32_bf16 v[204:207], v[92:95], v[240:243], v[204:207]
    v_mov_b32_dpp v125, v127 quad_perm:[0,1,2,3] row_mask:0xf bank_mask:0xa
    v_perm_b32 v105, v250, v124, v252
    v_mfma_f32_16x16x32_bf16 v[220:223], v[92:95], v[244:247], v[220:223]
    v_perm_b32 v109, v250, v124, v253
    v_perm_b32 v113, v251, v125, v252
    v_perm_b32 v117, v251, v125, v253
    v_mfma_f32_16x16x32_bf16 v[176:179], v[96:99], v[232:235], v[176:179]
    v_mov_b32_dpp v248, v128 row_shl:4 row_mask:0xf bank_mask:0x5
    v_mov_b32_dpp v248, v130 row_shr:4 row_mask:0xf bank_mask:0xa
    v_mov_b32_dpp v249, v129 row_shl:4 row_mask:0xf bank_mask:0x5
    v_mfma_f32_16x16x32_bf16 v[192:195], v[96:99], v[236:239], v[192:195]
    v_mov_b32_dpp v249, v131 row_shr:4 row_mask:0xf bank_mask:0xa
    v_mov_b32_dpp v128, v130 quad_perm:[0,1,2,3] row_mask:0xf bank_mask:0xa
    v_mfma_f32_16x16x32_bf16 v[208:211], v[96:99], v[240:243], v[208:211]
    v_mov_b32_dpp v129, v131 quad_perm:[0,1,2,3] row_mask:0xf bank_mask:0xa
    v_perm_b32 v106, v248, v128, v252
    v_perm_b32 v110, v248, v128, v253
    v_mfma_f32_16x16x32_bf16 v[224:227], v[96:99], v[244:247], v[224:227]
    v_perm_b32 v114, v249, v129, v252
    v_perm_b32 v118, v249, v129, v253
    v_mfma_f32_16x16x32_bf16 v[180:183], v[100:103], v[232:235], v[180:183]
    v_mov_b32_dpp v250, v132 row_shl:4 row_mask:0xf bank_mask:0x5
    v_mov_b32_dpp v250, v134 row_shr:4 row_mask:0xf bank_mask:0xa
    v_mov_b32_dpp v251, v133 row_shl:4 row_mask:0xf bank_mask:0x5
    v_mfma_f32_16x16x32_bf16 v[196:199], v[100:103], v[236:239], v[196:199]
    v_mov_b32_dpp v251, v135 row_shr:4 row_mask:0xf bank_mask:0xa
    v_mov_b32_dpp v132, v134 quad_perm:[0,1,2,3] row_mask:0xf bank_mask:0xa
    v_mfma_f32_16x16x32_bf16 v[212:215], v[100:103], v[240:243], v[212:215]
    v_mov_b32_dpp v133, v135 quad_perm:[0,1,2,3] row_mask:0xf bank_mask:0xa
    v_perm_b32 v107, v250, v132, v252
    v_perm_b32 v111, v250, v132, v253
    v_mfma_f32_16x16x32_bf16 v[228:231], v[100:103], v[244:247], v[228:231]
    v_perm_b32 v115, v251, v133, v252
    v_perm_b32 v119, v251, v133, v253
    s_waitcnt lgkmcnt(0)
    ds_read_b128 v[232:235], v11 offset:96
    ds_read_b128 v[236:239], v11 offset:5472
    ds_read_b128 v[240:243], v11 offset:10848
    ds_read_b128 v[244:247], v11 offset:16224
    v_mfma_f32_16x16x32_bf16 v[168:171], v[104:107], v[12:15], v[168:171]
    s_waitcnt vmcnt(12)
    v_mov_b32_dpp v248, v136 row_shl:4 row_mask:0xf bank_mask:0x5
    v_mov_b32_dpp v248, v138 row_shr:4 row_mask:0xf bank_mask:0xa
    v_mfma_f32_16x16x32_bf16 v[184:187], v[104:107], v[16:19], v[184:187]
    v_mov_b32_dpp v249, v137 row_shl:4 row_mask:0xf bank_mask:0x5
    v_mov_b32_dpp v249, v139 row_shr:4 row_mask:0xf bank_mask:0xa
    v_mov_b32_dpp v136, v138 quad_perm:[0,1,2,3] row_mask:0xf bank_mask:0xa
    v_mfma_f32_16x16x32_bf16 v[200:203], v[104:107], v[20:23], v[200:203]
    v_mov_b32_dpp v137, v139 quad_perm:[0,1,2,3] row_mask:0xf bank_mask:0xa
    v_perm_b32 v120, v248, v136, v252
    v_mfma_f32_16x16x32_bf16 v[216:219], v[104:107], v[24:27], v[216:219]
    v_perm_b32 v124, v248, v136, v253
    v_perm_b32 v128, v249, v137, v252
    v_perm_b32 v132, v249, v137, v253
    v_mfma_f32_16x16x32_bf16 v[172:175], v[108:111], v[12:15], v[172:175]
    v_mov_b32_dpp v250, v140 row_shl:4 row_mask:0xf bank_mask:0x5
    v_mov_b32_dpp v250, v142 row_shr:4 row_mask:0xf bank_mask:0xa
    v_mfma_f32_16x16x32_bf16 v[188:191], v[108:111], v[16:19], v[188:191]
    v_mov_b32_dpp v251, v141 row_shl:4 row_mask:0xf bank_mask:0x5
    v_mov_b32_dpp v251, v143 row_shr:4 row_mask:0xf bank_mask:0xa
    v_mov_b32_dpp v140, v142 quad_perm:[0,1,2,3] row_mask:0xf bank_mask:0xa
    v_mfma_f32_16x16x32_bf16 v[204:207], v[108:111], v[20:23], v[204:207]
    v_mov_b32_dpp v141, v143 quad_perm:[0,1,2,3] row_mask:0xf bank_mask:0xa
    v_perm_b32 v121, v250, v140, v252
    v_mfma_f32_16x16x32_bf16 v[220:223], v[108:111], v[24:27], v[220:223]
    v_perm_b32 v125, v250, v140, v253
    v_perm_b32 v129, v251, v141, v252
    v_perm_b32 v133, v251, v141, v253
    v_mfma_f32_16x16x32_bf16 v[176:179], v[112:115], v[12:15], v[176:179]
    v_mov_b32_dpp v248, v144 row_shl:4 row_mask:0xf bank_mask:0x5
    v_mov_b32_dpp v248, v146 row_shr:4 row_mask:0xf bank_mask:0xa
    v_mov_b32_dpp v249, v145 row_shl:4 row_mask:0xf bank_mask:0x5
    v_mfma_f32_16x16x32_bf16 v[192:195], v[112:115], v[16:19], v[192:195]
    v_mov_b32_dpp v249, v147 row_shr:4 row_mask:0xf bank_mask:0xa
    v_mov_b32_dpp v144, v146 quad_perm:[0,1,2,3] row_mask:0xf bank_mask:0xa
    v_mfma_f32_16x16x32_bf16 v[208:211], v[112:115], v[20:23], v[208:211]
    v_mov_b32_dpp v145, v147 quad_perm:[0,1,2,3] row_mask:0xf bank_mask:0xa
    v_perm_b32 v122, v248, v144, v252
    v_perm_b32 v126, v248, v144, v253
    v_mfma_f32_16x16x32_bf16 v[224:227], v[112:115], v[24:27], v[224:227]
    v_perm_b32 v130, v249, v145, v252
    v_perm_b32 v134, v249, v145, v253
    v_mfma_f32_16x16x32_bf16 v[180:183], v[116:119], v[12:15], v[180:183]
    v_mov_b32_dpp v250, v148 row_shl:4 row_mask:0xf bank_mask:0x5
    v_mov_b32_dpp v250, v150 row_shr:4 row_mask:0xf bank_mask:0xa
    v_mov_b32_dpp v251, v149 row_shl:4 row_mask:0xf bank_mask:0x5
    v_mfma_f32_16x16x32_bf16 v[196:199], v[116:119], v[16:19], v[196:199]
    v_mov_b32_dpp v251, v151 row_shr:4 row_mask:0xf bank_mask:0xa
    v_mov_b32_dpp v148, v150 quad_perm:[0,1,2,3] row_mask:0xf bank_mask:0xa
    v_mfma_f32_16x16x32_bf16 v[212:215], v[116:119], v[20:23], v[212:215]
    v_mov_b32_dpp v149, v151 quad_perm:[0,1,2,3] row_mask:0xf bank_mask:0xa
    v_perm_b32 v123, v250, v148, v252
    v_perm_b32 v127, v250, v148, v253
    v_mfma_f32_16x16x32_bf16 v[228:231], v[116:119], v[24:27], v[228:231]
    v_perm_b32 v131, v251, v149, v252
    v_perm_b32 v135, v251, v149, v253
    s_waitcnt lgkmcnt(0)
    ds_read_b128 v[12:15], v11 offset:112
    ds_read_b128 v[16:19], v11 offset:5488
    ds_read_b128 v[20:23], v11 offset:10864
    ds_read_b128 v[24:27], v11 offset:16240
    v_mfma_f32_16x16x32_bf16 v[168:171], v[120:123], v[232:235], v[168:171]
    s_waitcnt vmcnt(8)
    v_mov_b32_dpp v248, v152 row_shl:4 row_mask:0xf bank_mask:0x5
    v_mov_b32_dpp v248, v154 row_shr:4 row_mask:0xf bank_mask:0xa
    v_mfma_f32_16x16x32_bf16 v[184:187], v[120:123], v[236:239], v[184:187]
    v_mov_b32_dpp v249, v153 row_shl:4 row_mask:0xf bank_mask:0x5
    v_mov_b32_dpp v249, v155 row_shr:4 row_mask:0xf bank_mask:0xa
    v_mov_b32_dpp v152, v154 quad_perm:[0,1,2,3] row_mask:0xf bank_mask:0xa
    v_mfma_f32_16x16x32_bf16 v[200:203], v[120:123], v[240:243], v[200:203]
    v_mov_b32_dpp v153, v155 quad_perm:[0,1,2,3] row_mask:0xf bank_mask:0xa
    v_perm_b32 v136, v248, v152, v252
    v_mfma_f32_16x16x32_bf16 v[216:219], v[120:123], v[244:247], v[216:219]
    v_perm_b32 v140, v248, v152, v253
    v_perm_b32 v144, v249, v153, v252
    v_perm_b32 v148, v249, v153, v253
    v_mfma_f32_16x16x32_bf16 v[172:175], v[124:127], v[232:235], v[172:175]
    v_mov_b32_dpp v250, v156 row_shl:4 row_mask:0xf bank_mask:0x5
    v_mov_b32_dpp v250, v158 row_shr:4 row_mask:0xf bank_mask:0xa
    v_mfma_f32_16x16x32_bf16 v[188:191], v[124:127], v[236:239], v[188:191]
    v_mov_b32_dpp v251, v157 row_shl:4 row_mask:0xf bank_mask:0x5
    v_mov_b32_dpp v251, v159 row_shr:4 row_mask:0xf bank_mask:0xa
    v_mov_b32_dpp v156, v158 quad_perm:[0,1,2,3] row_mask:0xf bank_mask:0xa
    v_mfma_f32_16x16x32_bf16 v[204:207], v[124:127], v[240:243], v[204:207]
    v_mov_b32_dpp v157, v159 quad_perm:[0,1,2,3] row_mask:0xf bank_mask:0xa
    v_perm_b32 v137, v250, v156, v252
    v_mfma_f32_16x16x32_bf16 v[220:223], v[124:127], v[244:247], v[220:223]
    v_perm_b32 v141, v250, v156, v253
    v_perm_b32 v145, v251, v157, v252
    v_perm_b32 v149, v251, v157, v253
    v_mfma_f32_16x16x32_bf16 v[176:179], v[128:131], v[232:235], v[176:179]
    v_mov_b32_dpp v248, v160 row_shl:4 row_mask:0xf bank_mask:0x5
    v_mov_b32_dpp v248, v162 row_shr:4 row_mask:0xf bank_mask:0xa
    v_mov_b32_dpp v249, v161 row_shl:4 row_mask:0xf bank_mask:0x5
    v_mfma_f32_16x16x32_bf16 v[192:195], v[128:131], v[236:239], v[192:195]
    v_mov_b32_dpp v249, v163 row_shr:4 row_mask:0xf bank_mask:0xa
    v_mov_b32_dpp v160, v162 quad_perm:[0,1,2,3] row_mask:0xf bank_mask:0xa
    v_mfma_f32_16x16x32_bf16 v[208:211], v[128:131], v[240:243], v[208:211]
    v_mov_b32_dpp v161, v163 quad_perm:[0,1,2,3] row_mask:0xf bank_mask:0xa
    v_perm_b32 v138, v248, v160, v252
    v_perm_b32 v142, v248, v160, v253
    v_mfma_f32_16x16x32_bf16 v[224:227], v[128:131], v[244:247], v[224:227]
    v_perm_b32 v146, v249, v161, v252
    v_perm_b32 v150, v249, v161, v253
    v_mfma_f32_16x16x32_bf16 v[180:183], v[132:135], v[232:235], v[180:183]
    v_mov_b32_dpp v250, v164 row_shl:4 row_mask:0xf bank_mask:0x5
    v_mov_b32_dpp v250, v166 row_shr:4 row_mask:0xf bank_mask:0xa
    v_mov_b32_dpp v251, v165 row_shl:4 row_mask:0xf bank_mask:0x5
    v_mfma_f32_16x16x32_bf16 v[196:199], v[132:135], v[236:239], v[196:199]
    v_mov_b32_dpp v251, v167 row_shr:4 row_mask:0xf bank_mask:0xa
    v_mov_b32_dpp v164, v166 quad_perm:[0,1,2,3] row_mask:0xf bank_mask:0xa
    v_mfma_f32_16x16x32_bf16 v[212:215], v[132:135], v[240:243], v[212:215]
    v_mov_b32_dpp v165, v167 quad_perm:[0,1,2,3] row_mask:0xf bank_mask:0xa
    v_perm_b32 v139, v250, v164, v252
    v_perm_b32 v143, v250, v164, v253
    v_mfma_f32_16x16x32_bf16 v[228:231], v[132:135], v[244:247], v[228:231]
    v_perm_b32 v147, v251, v165, v252
    v_perm_b32 v151, v251, v165, v253
    s_waitcnt lgkmcnt(0)
    ds_read_b128 v[232:235], v11 offset:128
    ds_read_b128 v[236:239], v11 offset:5504
    ds_read_b128 v[240:243], v11 offset:10880
    ds_read_b128 v[244:247], v11 offset:16256
    v_mfma_f32_16x16x32_bf16 v[168:171], v[136:139], v[12:15], v[168:171]
    s_waitcnt vmcnt(4)
    v_mov_b32_dpp v248, v40 row_shl:4 row_mask:0xf bank_mask:0x5
    v_mov_b32_dpp v248, v42 row_shr:4 row_mask:0xf bank_mask:0xa
    v_mfma_f32_16x16x32_bf16 v[184:187], v[136:139], v[16:19], v[184:187]
    v_mov_b32_dpp v249, v41 row_shl:4 row_mask:0xf bank_mask:0x5
    v_mov_b32_dpp v249, v43 row_shr:4 row_mask:0xf bank_mask:0xa
    v_mov_b32_dpp v40, v42 quad_perm:[0,1,2,3] row_mask:0xf bank_mask:0xa
    v_mfma_f32_16x16x32_bf16 v[200:203], v[136:139], v[20:23], v[200:203]
    v_mov_b32_dpp v41, v43 quad_perm:[0,1,2,3] row_mask:0xf bank_mask:0xa
    v_perm_b32 v152, v248, v40, v252
    v_mfma_f32_16x16x32_bf16 v[216:219], v[136:139], v[24:27], v[216:219]
    v_perm_b32 v156, v248, v40, v253
    v_perm_b32 v160, v249, v41, v252
    v_perm_b32 v164, v249, v41, v253
    v_mfma_f32_16x16x32_bf16 v[172:175], v[140:143], v[12:15], v[172:175]
    v_mov_b32_dpp v250, v44 row_shl:4 row_mask:0xf bank_mask:0x5
    v_mov_b32_dpp v250, v46 row_shr:4 row_mask:0xf bank_mask:0xa
    v_mfma_f32_16x16x32_bf16 v[188:191], v[140:143], v[16:19], v[188:191]
    v_mov_b32_dpp v251, v45 row_shl:4 row_mask:0xf bank_mask:0x5
    v_mov_b32_dpp v251, v47 row_shr:4 row_mask:0xf bank_mask:0xa
    v_mov_b32_dpp v44, v46 quad_perm:[0,1,2,3] row_mask:0xf bank_mask:0xa
    v_mfma_f32_16x16x32_bf16 v[204:207], v[140:143], v[20:23], v[204:207]
    v_mov_b32_dpp v45, v47 quad_perm:[0,1,2,3] row_mask:0xf bank_mask:0xa
    v_perm_b32 v153, v250, v44, v252
    v_mfma_f32_16x16x32_bf16 v[220:223], v[140:143], v[24:27], v[220:223]
    v_perm_b32 v157, v250, v44, v253
    v_perm_b32 v161, v251, v45, v252
    v_perm_b32 v165, v251, v45, v253
    v_mfma_f32_16x16x32_bf16 v[176:179], v[144:147], v[12:15], v[176:179]
    v_mov_b32_dpp v248, v48 row_shl:4 row_mask:0xf bank_mask:0x5
    v_mov_b32_dpp v248, v50 row_shr:4 row_mask:0xf bank_mask:0xa
    v_mov_b32_dpp v249, v49 row_shl:4 row_mask:0xf bank_mask:0x5
    v_mfma_f32_16x16x32_bf16 v[192:195], v[144:147], v[16:19], v[192:195]
    v_mov_b32_dpp v249, v51 row_shr:4 row_mask:0xf bank_mask:0xa
    v_mov_b32_dpp v48, v50 quad_perm:[0,1,2,3] row_mask:0xf bank_mask:0xa
    v_mfma_f32_16x16x32_bf16 v[208:211], v[144:147], v[20:23], v[208:211]
    v_mov_b32_dpp v49, v51 quad_perm:[0,1,2,3] row_mask:0xf bank_mask:0xa
    v_perm_b32 v154, v248, v48, v252
    v_perm_b32 v158, v248, v48, v253
    v_mfma_f32_16x16x32_bf16 v[224:227], v[144:147], v[24:27], v[224:227]
    v_perm_b32 v162, v249, v49, v252
    v_perm_b32 v166, v249, v49, v253
    v_mfma_f32_16x16x32_bf16 v[180:183], v[148:151], v[12:15], v[180:183]
    v_mov_b32_dpp v250, v52 row_shl:4 row_mask:0xf bank_mask:0x5
    v_mov_b32_dpp v250, v54 row_shr:4 row_mask:0xf bank_mask:0xa
    v_mov_b32_dpp v251, v53 row_shl:4 row_mask:0xf bank_mask:0x5
    v_mfma_f32_16x16x32_bf16 v[196:199], v[148:151], v[16:19], v[196:199]
    v_mov_b32_dpp v251, v55 row_shr:4 row_mask:0xf bank_mask:0xa
    v_mov_b32_dpp v52, v54 quad_perm:[0,1,2,3] row_mask:0xf bank_mask:0xa
    v_mfma_f32_16x16x32_bf16 v[212:215], v[148:151], v[20:23], v[212:215]
    v_mov_b32_dpp v53, v55 quad_perm:[0,1,2,3] row_mask:0xf bank_mask:0xa
    v_perm_b32 v155, v250, v52, v252
    v_perm_b32 v159, v250, v52, v253
    v_mfma_f32_16x16x32_bf16 v[228:231], v[148:151], v[24:27], v[228:231]
    v_perm_b32 v163, v251, v53, v252
    v_perm_b32 v167, v251, v53, v253
    s_waitcnt lgkmcnt(0)
    ds_read_b128 v[12:15], v11 offset:144
    ds_read_b128 v[16:19], v11 offset:5520
    ds_read_b128 v[20:23], v11 offset:10896
    ds_read_b128 v[24:27], v11 offset:16272
    v_mfma_f32_16x16x32_bf16 v[168:171], v[152:155], v[232:235], v[168:171]
    s_waitcnt vmcnt(0)
    v_mov_b32_dpp v248, v56 row_shl:4 row_mask:0xf bank_mask:0x5
    v_mov_b32_dpp v248, v58 row_shr:4 row_mask:0xf bank_mask:0xa
    v_mfma_f32_16x16x32_bf16 v[184:187], v[152:155], v[236:239], v[184:187]
    v_mov_b32_dpp v249, v57 row_shl:4 row_mask:0xf bank_mask:0x5
    v_mov_b32_dpp v249, v59 row_shr:4 row_mask:0xf bank_mask:0xa
    v_mov_b32_dpp v56, v58 quad_perm:[0,1,2,3] row_mask:0xf bank_mask:0xa
    v_mfma_f32_16x16x32_bf16 v[200:203], v[152:155], v[240:243], v[200:203]
    v_mov_b32_dpp v57, v59 quad_perm:[0,1,2,3] row_mask:0xf bank_mask:0xa
    v_perm_b32 v40, v248, v56, v252
    v_mfma_f32_16x16x32_bf16 v[216:219], v[152:155], v[244:247], v[216:219]
    v_perm_b32 v44, v248, v56, v253
    v_perm_b32 v48, v249, v57, v252
    v_perm_b32 v52, v249, v57, v253
    v_mfma_f32_16x16x32_bf16 v[172:175], v[156:159], v[232:235], v[172:175]
    v_mov_b32_dpp v250, v60 row_shl:4 row_mask:0xf bank_mask:0x5
    v_mov_b32_dpp v250, v62 row_shr:4 row_mask:0xf bank_mask:0xa
    v_mfma_f32_16x16x32_bf16 v[188:191], v[156:159], v[236:239], v[188:191]
    v_mov_b32_dpp v251, v61 row_shl:4 row_mask:0xf bank_mask:0x5
    v_mov_b32_dpp v251, v63 row_shr:4 row_mask:0xf bank_mask:0xa
    v_mov_b32_dpp v60, v62 quad_perm:[0,1,2,3] row_mask:0xf bank_mask:0xa
    v_mfma_f32_16x16x32_bf16 v[204:207], v[156:159], v[240:243], v[204:207]
    v_mov_b32_dpp v61, v63 quad_perm:[0,1,2,3] row_mask:0xf bank_mask:0xa
    v_perm_b32 v41, v250, v60, v252
    v_mfma_f32_16x16x32_bf16 v[220:223], v[156:159], v[244:247], v[220:223]
    v_perm_b32 v45, v250, v60, v253
    v_perm_b32 v49, v251, v61, v252
    v_perm_b32 v53, v251, v61, v253
    v_mfma_f32_16x16x32_bf16 v[176:179], v[160:163], v[232:235], v[176:179]
    v_mov_b32_dpp v248, v64 row_shl:4 row_mask:0xf bank_mask:0x5
    v_mov_b32_dpp v248, v66 row_shr:4 row_mask:0xf bank_mask:0xa
    v_mov_b32_dpp v249, v65 row_shl:4 row_mask:0xf bank_mask:0x5
    v_mfma_f32_16x16x32_bf16 v[192:195], v[160:163], v[236:239], v[192:195]
    v_mov_b32_dpp v249, v67 row_shr:4 row_mask:0xf bank_mask:0xa
    v_mov_b32_dpp v64, v66 quad_perm:[0,1,2,3] row_mask:0xf bank_mask:0xa
    v_mfma_f32_16x16x32_bf16 v[208:211], v[160:163], v[240:243], v[208:211]
    v_mov_b32_dpp v65, v67 quad_perm:[0,1,2,3] row_mask:0xf bank_mask:0xa
    v_perm_b32 v42, v248, v64, v252
    v_perm_b32 v46, v248, v64, v253
    v_mfma_f32_16x16x32_bf16 v[224:227], v[160:163], v[244:247], v[224:227]
    v_perm_b32 v50, v249, v65, v252
    v_perm_b32 v54, v249, v65, v253
    v_mfma_f32_16x16x32_bf16 v[180:183], v[164:167], v[232:235], v[180:183]
    v_mov_b32_dpp v250, v68 row_shl:4 row_mask:0xf bank_mask:0x5
    v_mov_b32_dpp v250, v70 row_shr:4 row_mask:0xf bank_mask:0xa
    v_mov_b32_dpp v251, v69 row_shl:4 row_mask:0xf bank_mask:0x5
    v_mfma_f32_16x16x32_bf16 v[196:199], v[164:167], v[236:239], v[196:199]
    v_mov_b32_dpp v251, v71 row_shr:4 row_mask:0xf bank_mask:0xa
    v_mov_b32_dpp v68, v70 quad_perm:[0,1,2,3] row_mask:0xf bank_mask:0xa
    v_mfma_f32_16x16x32_bf16 v[212:215], v[164:167], v[240:243], v[212:215]
    v_mov_b32_dpp v69, v71 quad_perm:[0,1,2,3] row_mask:0xf bank_mask:0xa
    v_perm_b32 v43, v250, v68, v252
    v_perm_b32 v47, v250, v68, v253
    v_mfma_f32_16x16x32_bf16 v[228:231], v[164:167], v[244:247], v[228:231]
    v_perm_b32 v51, v251, v69, v252
    v_perm_b32 v55, v251, v69, v253
    s_waitcnt lgkmcnt(0)
    v_mfma_f32_16x16x32_bf16 v[168:171], v[40:43], v[12:15], v[168:171]
    v_mfma_f32_16x16x32_bf16 v[184:187], v[40:43], v[16:19], v[184:187]
    v_mfma_f32_16x16x32_bf16 v[200:203], v[40:43], v[20:23], v[200:203]
    v_mfma_f32_16x16x32_bf16 v[216:219], v[40:43], v[24:27], v[216:219]
    v_mfma_f32_16x16x32_bf16 v[172:175], v[44:47], v[12:15], v[172:175]
    v_mfma_f32_16x16x32_bf16 v[188:191], v[44:47], v[16:19], v[188:191]
    v_mfma_f32_16x16x32_bf16 v[204:207], v[44:47], v[20:23], v[204:207]
    v_mfma_f32_16x16x32_bf16 v[220:223], v[44:47], v[24:27], v[220:223]
    v_mfma_f32_16x16x32_bf16 v[176:179], v[48:51], v[12:15], v[176:179]
    v_mfma_f32_16x16x32_bf16 v[192:195], v[48:51], v[16:19], v[192:195]
    v_mfma_f32_16x16x32_bf16 v[208:211], v[48:51], v[20:23], v[208:211]
    v_mfma_f32_16x16x32_bf16 v[224:227], v[48:51], v[24:27], v[224:227]
    v_mfma_f32_16x16x32_bf16 v[180:183], v[52:55], v[12:15], v[180:183]
    v_mfma_f32_16x16x32_bf16 v[196:199], v[52:55], v[16:19], v[196:199]
    v_mfma_f32_16x16x32_bf16 v[212:215], v[52:55], v[20:23], v[212:215]
    v_mfma_f32_16x16x32_bf16 v[228:231], v[52:55], v[24:27], v[228:231]
LK1_g2Q:
    s_lshl_b32 s28, s18, 13
    s_add_u32 s28, s28, 86528
    s_xor_b32 s29, s18, 4
    s_lshl_b32 s29, s29, 13
    s_add_u32 s29, s29, 86528
    v_lshl_add_u32 v28, v1, 4, s28
    v_lshl_add_u32 v29, v1, 4, s29
    s_nop 7
    s_cmp_eq_u32 s41, 0
    s_cbranch_scc0 LK1_upQ
    ds_write_b128 v28, v[200:203] offset:0
    ds_write_b128 v28, v[204:207] offset:1024
    ds_write_b128 v28, v[208:211] offset:2048
    ds_write_b128 v28, v[212:215] offset:3072
    ds_write_b128 v28, v[216:219] offset:4096
    ds_write_b128 v28, v[220:223] offset:5120
    ds_write_b128 v28, v[224:227] offset:6144
    ds_write_b128 v28, v[228:231] offset:7168
    s_branch LK1_xQ
LK1_upQ:
    ds_write_b128 v28, v[168:171] offset:0
    ds_write_b128 v28, v[172:175] offset:1024
    ds_write_b128 v28, v[176:179] offset:2048
    ds_write_b128 v28, v[180:183] offset:3072
    ds_write_b128 v28, v[184:187] offset:4096
    ds_write_b128 v28, v[188:191] offset:5120
    ds_write_b128 v28, v[192:195] offset:6144
    ds_write_b128 v28, v[196:199] offset:7168
    s_waitcnt lgkmcnt(0)
    v_mov_b32 v168, v200
    v_mov_b32 v169, v201
    v_mov_b32 v170, v202
    v_mov_b32 v171, v203
    v_mov_b32 v172, v204
    v_mov_b32 v173, v205
    v_mov_b32 v174, v206
    v_mov_b32 v175, v207
    v_mov_b32 v176, v208
    v_mov_b32 v177, v209
    v_mov_b32 v178, v210
    v_mov_b32 v179, v211
    v_mov_b32 v180, v212
    v_mov_b32 v181, v213
    v_mov_b32 v182, v214
    v_mov_b32 v183, v215
    v_mov_b32 v184, v216
    v_mov_b32 v185, v217
    v_mov_b32 v186, v218
    v_mov_b32 v187, v219
    v_mov_b32 v188, v220
    v_mov_b32 v189, v221
    v_mov_b32 v190, v222
    v_mov_b32 v191, v223
    v_mov_b32 v192, v224
    v_mov_b32 v193, v225
    v_mov_b32 v194, v226
    v_mov_b32 v195, v227
    v_mov_b32 v196, v228
    v_mov_b32 v197, v229
    v_mov_b32 v198, v230
    v_mov_b32 v199, v231
LK1_xQ:
    s_waitcnt lgkmcnt(0)
    s_barrier
    ds_read_b128 v[200:203], v29 offset:0
    ds_read_b128 v[204:207], v29 offset:1024
    ds_read_b128 v[208:211], v29 offset:2048
    ds_read_b128 v[212:215], v29 offset:3072
    ds_read_b128 v[216:219], v29 offset:4096
    ds_read_b128 v[220:223], v29 offset:5120
    ds_read_b128 v[224:227], v29 offset:6144
    ds_read_b128 v[228:231], v29 offset:7168
    s_lshl_b32 s28, s41, 7
    v_lshl_add_u32 v28, v2, 2, s28
    ds_read_b32 v32, v28 offset:0
    ds_read_b32 v33, v28 offset:64
    s_cmp_ge_u32 s19, 10
    s_cselect_b32 s28, 10, 0
    s_cselect_b32 s26, 2, 1
    s_cselect_b32 s27, 0, 5242880
    s_cselect_b32 s25, 1.0, 0x3ea52b5c
    s_mul_i32 s29, s26, 81920
    s_mul_i32 s26, s26, 1280
    s_sub_u32 s28, s19, s28
    s_lshl_b32 s28, s28, 4
    v_lshrrev_b32 v28, 1, v3
    v_lshl_add_u32 v28, v28, 3, s28
    v_and_b32 v29, 1, v3
    v_add_u32 v28, v28, v29
    v_add_u32 v29, 0, v28
    v_mul_u32_u24 v30, 205, v29
    v_lshrrev_b32 v30, 10, v30
    v_mul_u32_u24 v31, 5, v30
    v_sub_u32 v31, v29, v31
    v_mul_lo_u32 v30, v30, s29
    v_lshrrev_b32 v36, 1, v31
    v_lshlrev_b32 v36, 9, v36
    v_and_b32 v37, 1, v31
    v_lshl_add_u32 v36, v37, 3, v36
    v_add_u32 v30, v30, v36
    v_cmp_eq_u32 vcc, 4, v31
    v_mov_b32 v37, 16
    s_nop 0
    v_cndmask_b32 v37, v37, 8, vcc
    v_mul_u32_u24 v36, v37, v2
    v_add_u32 v56, v30, v36
    v_lshl_add_u32 v57, v37, 4, v56
    v_add_u32 v29, 2, v28
    v_mul_u32_u24 v30, 205, v29
    v_lshrrev_b32 v30, 10, v30
    v_mul_u32_u24 v31, 5, v30
    v_sub_u32 v31, v29, v31
    v_mul_lo_u32 v30, v30, s29
    v_lshrrev_b32 v36, 1, v31
    v_lshlrev_b32 v36, 9, v36
    v_and_b32 v37, 1, v31
    v_lshl_add_u32 v36, v37, 3, v36
    v_add_u32 v30, v30, v36
    v_cmp_eq_u32 vcc, 4, v31
    v_mov_b32 v37, 16
    s_nop 0
    v_cndmask_b32 v37, v37, 8, vcc
    v_mul_u32_u24 v36, v37, v2
    v_add_u32 v58, v30, v36
    v_lshl_add_u32 v59, v37, 4, v58
    v_add_u32 v29, 4, v28
    v_mul_u32_u24 v30, 205, v29
    v_lshrrev_b32 v30, 10, v30
    v_mul_u32_u24 v31, 5, v30
    v_sub_u32 v31, v29, v31
    v_mul_lo_u32 v30, v30, s29
    v_lshrrev_b32 v36, 1, v31
    v_lshlrev_b32 v36, 9, v36
    v_and_b32 v37, 1, v31
    v_lshl_add_u32 v36, v37, 3, v36
    v_add_u32 v30, v30, v36
    v_cmp_eq_u32 vcc, 4, v31
    v_mov_b32 v37, 16
    s_nop 0
    v_cndmask_b32 v37, v37, 8, vcc
    v_mul_u32_u24 v36, v37, v2
    v_add_u32 v60, v30, v36
    v_lshl_add_u32 v61, v37, 4, v60
    v_add_u32 v29, 6, v28
    v_mul_u32_u24 v30, 205, v29
    v_lshrrev_b32 v30, 10, v30
    v_mul_u32_u24 v31, 5, v30
    v_sub_u32 v31, v29, v31
    v_mul_lo_u32 v30, v30, s29
    v_lshrrev_b32 v36, 1, v31
    v_lshlrev_b32 v36, 9, v36
    v_and_b32 v37, 1, v31
    v_lshl_add_u32 v36, v37, 3, v36
    v_add_u32 v30, v30, v36
    v_cmp_eq_u32 vcc, 4, v31
    v_mov_b32 v37, 16
    s_nop 0
    v_cndmask_b32 v37, v37, 8, vcc
    v_mul_u32_u24 v36, v37, v2
    v_add_u32 v62, v30, v36
    v_lshl_add_u32 v63, v37, 4, v62
    s_lshl_b32 s28, s16, 1
    s_add_u32 s28, s28, s41
    s_mul_i32 s28, s28, s26
    s_add_u32 s28, s28, s27
    s_waitcnt lgkmcnt(0)
    v_add_f32 v168, v168, v200
    v_add_f32 v169, v169, v201
    v_add_f32 v170, v170, v202
    v_add_f32 v171, v171, v203
    v_add_f32 v172, v172, v204
    v_add_f32 v173, v173, v205
    v_add_f32 v174, v174, v206
    v_add_f32 v175, v175, v207
    v_add_f32 v176, v176, v208
    v_add_f32 v177, v177, v209
    v_add_f32 v178, v178, v210
    v_add_f32 v179, v179, v211
    v_add_f32 v180, v180, v212
    v_add_f32 v181, v181, v213
    v_add_f32 v182, v182, v214
    v_add_f32 v183, v183, v215
    v_add_f32 v184, v184, v216
    v_add_f32 v185, v185, v217
    v_add_f32 v186, v186, v218
    v_add_f32 v187, v187, v219
    v_add_f32 v188, v188, v220
    v_add_f32 v189, v189, v221
    v_add_f32 v190, v190, v222
    v_add_f32 v191, v191, v223
    v_add_f32 v192, v192, v224
    v_add_f32 v193, v193, v225
    v_add_f32 v194, v194, v226
    v_add_f32 v195, v195, v227
    v_add_f32 v196, v196, v228
    v_add_f32 v197, v197, v229
    v_add_f32 v198, v198, v230
    v_add_f32 v199, v199, v231
    v_mul_f32 v32, s25, v32
    v_mul_f32 v33, s25, v33
    v_mul_f32 v168, v168, v32
    v_mul_f32 v169, v169, v32
    v_mul_f32 v170, v170, v32
    v_mul_f32 v171, v171, v32
    v_mul_f32 v172, v172, v32
    v_mul_f32 v173, v173, v32
    v_mul_f32 v174, v174, v32
    v_mul_f32 v175, v175, v32
    v_mul_f32 v176, v176, v32
    v_mul_f32 v177, v177, v32
    v_mul_f32 v178, v178, v32
    v_mul_f32 v179, v179, v32
    v_mul_f32 v180, v180, v32
    v_mul_f32 v181, v181, v32
    v_mul_f32 v182, v182, v32
    v_mul_f32 v183, v183, v32
    v_cvt_pk_bf16_f32 v40, v168, v172
    v_cvt_pk_bf16_f32 v41, v176, v180
    v_cvt_pk_bf16_f32 v42, v169, v173
    v_cvt_pk_bf16_f32 v43, v177, v181
    v_cvt_pk_bf16_f32 v44, v170, v174
    v_cvt_pk_bf16_f32 v45, v178, v182
    v_cvt_pk_bf16_f32 v46, v171, v175
    v_cvt_pk_bf16_f32 v47, v179, v183
    buffer_store_dwordx2 v[40:41], v56, s[12:15], s28 offen
    buffer_store_dwordx2 v[42:43], v58, s[12:15], s28 offen
    buffer_store_dwordx2 v[44:45], v60, s[12:15], s28 offen
    buffer_store_dwordx2 v[46:47], v62, s[12:15], s28 offen
    v_mul_f32 v184, v184, v33
    v_mul_f32 v185, v185, v33
    v_mul_f32 v186, v186, v33
    v_mul_f32 v187, v187, v33
    v_mul_f32 v188, v188, v33
    v_mul_f32 v189, v189, v33
    v_mul_f32 v190, v190, v33
    v_mul_f32 v191, v191, v33
    v_mul_f32 v192, v192, v33
    v_mul_f32 v193, v193, v33
    v_mul_f32 v194, v194, v33
    v_mul_f32 v195, v195, v33
    v_mul_f32 v196, v196, v33
    v_mul_f32 v197, v197, v33
    v_mul_f32 v198, v198, v33
    v_mul_f32 v199, v199, v33
    v_cvt_pk_bf16_f32 v48, v184, v188
    v_cvt_pk_bf16_f32 v49, v192, v196
    v_cvt_pk_bf16_f32 v50, v185, v189
    v_cvt_pk_bf16_f32 v51, v193, v197
    v_cvt_pk_bf16_f32 v52, v186, v190
    v_cvt_pk_bf16_f32 v53, v194, v198
    v_cvt_pk_bf16_f32 v54, v187, v191
    v_cvt_pk_bf16_f32 v55, v195, v199
    buffer_store_dwordx2 v[48:49], v57, s[12:15], s28 offen
    buffer_store_dwordx2 v[50:51], v59, s[12:15], s28 offen
    buffer_store_dwordx2 v[52:53], v61, s[12:15], s28 offen
    buffer_store_dwordx2 v[54:55], v63, s[12:15], s28 offen
    s_endpgm
LK1_gemmV:
    s_cmp_lg_u32 s41, 0
    s_cbranch_scc1 LK1_g1V
    ds_read_b128 v[232:235], v11 offset:0
    ds_read_b128 v[236:239], v11 offset:5376
    ds_read_b128 v[240:243], v11 offset:10752
    ds_read_b128 v[244:247], v11 offset:16128
    buffer_load_dwordx4 v[88:91], v4, s[8:11], s20 offen
    buffer_load_dwordx4 v[92:95], v4, s[8:11], s21 offen
    buffer_load_dwordx4 v[96:99], v4, s[8:11], s22 offen
    buffer_load_dwordx4 v[100:103], v4, s[8:11], s23 offen
    s_add_u32 s20, s20, 30720
    s_add_u32 s21, s21, 30720
    s_add_u32 s22, s22, 30720
    s_add_u32 s23, s23, 30720
    buffer_load_dwordx4 v[104:107], v4, s[8:11], s20 offen
    buffer_load_dwordx4 v[108:111], v4, s[8:11], s21 offen
    buffer_load_dwordx4 v[112:115], v4, s[8:11], s22 offen
    buffer_load_dwordx4 v[116:119], v4, s[8:11], s23 offen
    s_add_u32 s20, s20, 30720
    s_add_u32 s21, s21, 30720
    s_add_u32 s22, s22, 30720
    s_add_u32 s23, s23, 30720
    buffer_load_dwordx4 v[120:123], v4, s[8:11], s20 offen
    buffer_load_dwordx4 v[124:127], v4, s[8:11], s21 offen
    buffer_load_dwordx4 v[128:131], v4, s[8:11], s22 offen
    buffer_load_dwordx4 v[132:135], v4, s[8:11], s23 offen
    s_add_u32 s20, s20, 30720
    s_add_u32 s21, s21, 30720
    s_add_u32 s22, s22, 30720
    s_add_u32 s23, s23, 30720
    buffer_load_dwordx4 v[136:139], v4, s[8:11], s20 offen
    buffer_load_dwordx4 v[140:143], v4, s[8:11], s21 offen
    buffer_load_dwordx4 v[144:147], v4, s[8:11], s22 offen
    buffer_load_dwordx4 v[148:151], v4, s[8:11], s23 offen
    s_add_u32 s20, s20, 30720
    s_add_u32 s21, s21, 30720
    s_add_u32 s22, s22, 30720
    s_add_u32 s23, s23, 30720
    s_waitcnt vmcnt(24)
    v_mov_b32_dpp v248, v40 row_shl:4 row_mask:0xf bank_mask:0x5
    v_mov_b32_dpp v248, v42 row_shr:4 row_mask:0xf bank_mask:0xa
    v_mov_b32_dpp v249, v41 row_shl:4 row_mask:0xf bank_mask:0x5
    v_mov_b32_dpp v249, v43 row_shr:4 row_mask:0xf bank_mask:0xa
    v_mov_b32_dpp v40, v42 quad_perm:[0,1,2,3] row_mask:0xf bank_mask:0xa
    v_mov_b32_dpp v41, v43 quad_perm:[0,1,2,3] row_mask:0xf bank_mask:0xa
    v_perm_b32 v152, v248, v40, v252
    v_perm_b32 v156, v248, v40, v253
    v_perm_b32 v160, v249, v41, v252
    v_perm_b32 v164, v249, v41, v253
    v_mov_b32_dpp v250, v44 row_shl:4 row_mask:0xf bank_mask:0x5
    v_mov_b32_dpp v250, v46 row_shr:4 row_mask:0xf bank_mask:0xa
    v_mov_b32_dpp v251, v45 row_shl:4 row_mask:0xf bank_mask:0x5
    v_mov_b32_dpp v251, v47 row_shr:4 row_mask:0xf bank_mask:0xa
    v_mov_b32_dpp v44, v46 quad_perm:[0,1,2,3] row_mask:0xf bank_mask:0xa
    v_mov_b32_dpp v45, v47 quad_perm:[0,1,2,3] row_mask:0xf bank_mask:0xa
    v_perm_b32 v153, v250, v44, v252
    v_perm_b32 v157, v250, v44, v253
    v_perm_b32 v161, v251, v45, v252
    v_perm_b32 v165, v251, v45, v253
    v_mov_b32_dpp v248, v48 row_shl:4 row_mask:0xf bank_mask:0x5
    v_mov_b32_dpp v248, v50 row_shr:4 row_mask:0xf bank_mask:0xa
    v_mov_b32_dpp v249, v49 row_shl:4 row_mask:0xf bank_mask:0x5
    v_mov_b32_dpp v249, v51 row_shr:4 row_mask:0xf bank_mask:0xa
    v_mov_b32_dpp v48, v50 quad_perm:[0,1,2,3] row_mask:0xf bank_mask:0xa
    v_mov_b32_dpp v49, v51 quad_perm:[0,1,2,3] row_mask:0xf bank_mask:0xa
    v_perm_b32 v154, v248, v48, v252
    v_perm_b32 v158, v248, v48, v253
    v_perm_b32 v162, v249, v49, v252
    v_perm_b32 v166, v249, v49, v253
    v_mov_b32_dpp v250, v52 row_shl:4 row_mask:0xf bank_mask:0x5
    v_mov_b32_dpp v250, v54 row_shr:4 row_mask:0xf bank_mask:0xa
    v_mov_b32_dpp v251, v53 row_shl:4 row_mask:0xf bank_mask:0x5
    v_mov_b32_dpp v251, v55 row_shr:4 row_mask:0xf bank_mask:0xa
    v_mov_b32_dpp v52, v54 quad_perm:[0,1,2,3] row_mask:0xf bank_mask:0xa
    v_mov_b32_dpp v53, v55 quad_perm:[0,1,2,3] row_mask:0xf bank_mask:0xa
    v_perm_b32 v155, v250, v52, v252
    v_perm_b32 v159, v250, v52, v253
    v_perm_b32 v163, v251, v53, v252
    v_perm_b32 v167, v251, v53, v253
    s_waitcnt lgkmcnt(0)
    ds_read_b128 v[12:15], v11 offset:16
    ds_read_b128 v[16:19], v11 offset:5392
    ds_read_b128 v[20:23], v11 offset:10768
    ds_read_b128 v[24:27], v11 offset:16144
    v_mfma_f32_16x16x32_bf16 v[168:171], v[232:235], v[152:155], 0
    s_waitcnt vmcnt(20)
    v_mov_b32_dpp v248, v56 row_shl:4 row_mask:0xf bank_mask:0x5
    v_mov_b32_dpp v248, v58 row_shr:4 row_mask:0xf bank_mask:0xa
    v_mfma_f32_16x16x32_bf16 v[184:187], v[236:239], v[152:155], 0
    v_mov_b32_dpp v249, v57 row_shl:4 row_mask:0xf bank_mask:0x5
    v_mov_b32_dpp v249, v59 row_shr:4 row_mask:0xf bank_mask:0xa
    v_mov_b32_dpp v56, v58 quad_perm:[0,1,2,3] row_mask:0xf bank_mask:0xa
    v_mfma_f32_16x16x32_bf16 v[200:203], v[240:243], v[152:155], 0
    v_mov_b32_dpp v57, v59 quad_perm:[0,1,2,3] row_mask:0xf bank_mask:0xa
    v_perm_b32 v40, v248, v56, v252
    v_mfma_f32_16x16x32_bf16 v[216:219], v[244:247], v[152:155], 0
    v_perm_b32 v44, v248, v56, v253
    v_perm_b32 v48, v249, v57, v252
    v_perm_b32 v52, v249, v57, v253
    v_mfma_f32_16x16x32_bf16 v[172:175], v[232:235], v[156:159], 0
    v_mov_b32_dpp v250, v60 row_shl:4 row_mask:0xf bank_mask:0x5
    v_mov_b32_dpp v250, v62 row_shr:4 row_mask:0xf bank_mask:0xa
    v_mfma_f32_16x16x32_bf16 v[188:191], v[236:239], v[156:159], 0
    v_mov_b32_dpp v251, v61 row_shl:4 row_mask:0xf bank_mask:0x5
    v_mov_b32_dpp v251, v63 row_shr:4 row_mask:0xf bank_mask:0xa
    v_mov_b32_dpp v60, v62 quad_perm:[0,1,2,3] row_mask:0xf bank_mask:0xa
    v_mfma_f32_16x16x32_bf16 v[204:207], v[240:243], v[156:159], 0
    v_mov_b32_dpp v61, v63 quad_perm:[0,1,2,3] row_mask:0xf bank_mask:0xa
    v_perm_b32 v41, v250, v60, v252
    v_mfma_f32_16x16x32_bf16 v[220:223], v[244:247], v[156:159], 0
    v_perm_b32 v45, v250, v60, v253
    v_perm_b32 v49, v251, v61, v252
    v_perm_b32 v53, v251, v61, v253
    v_mfma_f32_16x16x32_bf16 v[176:179], v[232:235], v[160:163], 0
    v_mov_b32_dpp v248, v64 row_shl:4 row_mask:0xf bank_mask:0x5
    v_mov_b32_dpp v248, v66 row_shr:4 row_mask:0xf bank_mask:0xa
    v_mov_b32_dpp v249, v65 row_shl:4 row_mask:0xf bank_mask:0x5
    v_mfma_f32_16x16x32_bf16 v[192:195], v[236:239], v[160:163], 0
    v_mov_b32_dpp v249, v67 row_shr:4 row_mask:0xf bank_mask:0xa
    v_mov_b32_dpp v64, v66 quad_perm:[0,1,2,3] row_mask:0xf bank_mask:0xa
    v_mfma_f32_16x16x32_bf16 v[208:211], v[240:243], v[160:163], 0
    v_mov_b32_dpp v65, v67 quad_perm:[0,1,2,3] row_mask:0xf bank_mask:0xa
    v_perm_b32 v42, v248, v64, v252
    v_perm_b32 v46, v248, v64, v253
    v_mfma_f32_16x16x32_bf16 v[224:227], v[244:247], v[160:163], 0
    v_perm_b32 v50, v249, v65, v252
    v_perm_b32 v54, v249, v65, v253
    v_mfma_f32_16x16x32_bf16 v[180:183], v[232:235], v[164:167], 0
    v_mov_b32_dpp v250, v68 row_shl:4 row_mask:0xf bank_mask:0x5
    v_mov_b32_dpp v250, v70 row_shr:4 row_mask:0xf bank_mask:0xa
    v_mov_b32_dpp v251, v69 row_shl:4 row_mask:0xf bank_mask:0x5
    v_mfma_f32_16x16x32_bf16 v[196:199], v[236:239], v[164:167], 0
    v_mov_b32_dpp v251, v71 row_shr:4 row_mask:0xf bank_mask:0xa
    v_mov_b32_dpp v68, v70 quad_perm:[0,1,2,3] row_mask:0xf bank_mask:0xa
    v_mfma_f32_16x16x32_bf16 v[212:215], v[240:243], v[164:167], 0
    v_mov_b32_dpp v69, v71 quad_perm:[0,1,2,3] row_mask:0xf bank_mask:0xa
    v_perm_b32 v43, v250, v68, v252
    v_perm_b32 v47, v250, v68, v253
    v_mfma_f32_16x16x32_bf16 v[228:231], v[244:247], v[164:167], 0
    v_perm_b32 v51, v251, v69, v252
    v_perm_b32 v55, v251, v69, v253
    buffer_load_dwordx4 v[152:155], v4, s[8:11], s20 offen
    buffer_load_dwordx4 v[156:159], v4, s[8:11], s21 offen
    buffer_load_dwordx4 v[160:163], v4, s[8:11], s22 offen
    buffer_load_dwordx4 v[164:167], v4, s[8:11], s23 offen
    s_add_u32 s20, s20, 30720
    s_add_u32 s21, s21, 30720
    s_add_u32 s22, s22, 30720
    s_add_u32 s23, s23, 30720
    s_waitcnt lgkmcnt(0)
    ds_read_b128 v[232:235], v11 offset:32
    ds_read_b128 v[236:239], v11 offset:5408
    ds_read_b128 v[240:243], v11 offset:10784
    ds_read_b128 v[244:247], v11 offset:16160
    v_mfma_f32_16x16x32_bf16 v[168:171], v[12:15], v[40:43], v[168:171]
    s_waitcnt vmcnt(20)
    v_mov_b32_dpp v248, v72 row_shl:4 row_mask:0xf bank_mask:0x5
    v_mov_b32_dpp v248, v74 row_shr:4 row_mask:0xf bank_mask:0xa
    v_mfma_f32_16x16x32_bf16 v[184:187], v[16:19], v[40:43], v[184:187]
    v_mov_b32_dpp v249, v73 row_shl:4 row_mask:0xf bank_mask:0x5
    v_mov_b32_dpp v249, v75 row_shr:4 row_mask:0xf bank_mask:0xa
    v_mov_b32_dpp v72, v74 quad_perm:[0,1,2,3] row_mask:0xf bank_mask:0xa
    v_mfma_f32_16x16x32_bf16 v[200:203], v[20:23], v[40:43], v[200:203]
    v_mov_b32_dpp v73, v75 quad_perm:[0,1,2,3] row_mask:0xf bank_mask:0xa
    v_perm_b32 v56, v248, v72, v252
    v_mfma_f32_16x16x32_bf16 v[216:219], v[24:27], v[40:43], v[216:219]
    v_perm_b32 v60, v248, v72, v253
    v_perm_b32 v64, v249, v73, v252
    v_perm_b32 v68, v249, v73, v253
    v_mfma_f32_16x16x32_bf16 v[172:175], v[12:15], v[44:47], v[172:175]
    v_mov_b32_dpp v250, v76 row_shl:4 row_mask:0xf bank_mask:0x5
    v_mov_b32_dpp v250, v78 row_shr:4 row_mask:0xf bank_mask:0xa
    v_mfma_f32_16x16x32_bf16 v[188:191], v[16:19], v[44:47], v[188:191]
    v_mov_b32_dpp v251, v77 row_shl:4 row_mask:0xf bank_mask:0x5
    v_mov_b32_dpp v251, v79 row_shr:4 row_mask:0xf bank_mask:0xa
    v_mov_b32_dpp v76, v78 quad_perm:[0,1,2,3] row_mask:0xf bank_mask:0xa
    v_mfma_f32_16x16x32_bf16 v[204:207], v[20:23], v[44:47], v[204:207]
    v_mov_b32_dpp v77, v79 quad_perm:[0,1,2,3] row_mask:0xf bank_mask:0xa
    v_perm_b32 v57, v250, v76, v252
    v_mfma_f32_16x16x32_bf16 v[220:223], v[24:27], v[44:47], v[220:223]
    v_perm_b32 v61, v250, v76, v253
    v_perm_b32 v65, v251, v77, v252
    v_perm_b32 v69, v251, v77, v253
    v_mfma_f32_16x16x32_bf16 v[176:179], v[12:15], v[48:51], v[176:179]
    v_mov_b32_dpp v248, v80 row_shl:4 row_mask:0xf bank_mask:0x5
    v_mov_b32_dpp v248, v82 row_shr:4 row_mask:0xf bank_mask:0xa
    v_mov_b32_dpp v249, v81 row_shl:4 row_mask:0xf bank_mask:0x5
    v_mfma_f32_16x16x32_bf16 v[192:195], v[16:19], v[48:51], v[192:195]
    v_mov_b32_dpp v249, v83 row_shr:4 row_mask:0xf bank_mask:0xa
    v_mov_b32_dpp v80, v82 quad_perm:[0,1,2,3] row_mask:0xf bank_mask:0xa
    v_mfma_f32_16x16x32_bf16 v[208:211], v[20:23], v[48:51], v[208:211]
    v_mov_b32_dpp v81, v83 quad_perm:[0,1,2,3] row_mask:0xf bank_mask:0xa
    v_perm_b32 v58, v248, v80, v252
    v_perm_b32 v62, v248, v80, v253
    v_mfma_f32_16x16x32_bf16 v[224:227], v[24:27], v[48:51], v[224:227]
    v_perm_b32 v66, v249, v81, v252
    v_perm_b32 v70, v249, v81, v253
    v_mfma_f32_16x16x32_bf16 v[180:183], v[12:15], v[52:55], v[180:183]
    v_mov_b32_dpp v250, v84 row_shl:4 row_mask:0xf bank_mask:0x5
    v_mov_b32_dpp v250, v86 row_shr:4 row_mask:0xf bank_mask:0xa
    v_mov_b32_dpp v251, v85 row_shl:4 row_mask:0xf bank_mask:0x5
    v_mfma_f32_16x16x32_bf16 v[196:199], v[16:19], v[52:55], v[196:199]
    v_mov_b32_dpp v251, v87 row_shr:4 row_mask:0xf bank_mask:0xa
    v_mov_b32_dpp v84, v86 quad_perm:[0,1,2,3] row_mask:0xf bank_mask:0xa
    v_mfma_f32_16x16x32_bf16 v[212:215], v[20:23], v[52:55], v[212:215]
    v_mov_b32_dpp v85, v87 quad_perm:[0,1,2,3] row_mask:0xf bank_mask:0xa
    v_perm_b32 v59, v250, v84, v252
    v_perm_b32 v63, v250, v84, v253
    v_mfma_f32_16x16x32_bf16 v[228:231], v[24:27], v[52:55], v[228:231]
    v_perm_b32 v67, v251, v85, v252
    v_perm_b32 v71, v251, v85, v253
    buffer_load_dwordx4 v[40:43], v4, s[8:11], s20 offen
    buffer_load_dwordx4 v[44:47], v4, s[8:11], s21 offen
    buffer_load_dwordx4 v[48:51], v4, s[8:11], s22 offen
    buffer_load_dwordx4 v[52:55], v4, s[8:11], s23 offen
    s_add_u32 s20, s20, 30720
    s_add_u32 s21, s21, 30720
    s_add_u32 s22, s22, 30720
    s_add_u32 s23, s23, 30720
    s_waitcnt lgkmcnt(0)
    ds_read_b128 v[12:15], v11 offset:48
    ds_read_b128 v[16:19], v11 offset:5424
    ds_read_b128 v[20:23], v11 offset:10800
    ds_read_b128 v[24:27], v11 offset:16176
    v_mfma_f32_16x16x32_bf16 v[168:171], v[232:235], v[56:59], v[168:171]
    s_waitcnt vmcnt(20)
    v_mov_b32_dpp v248, v88 row_shl:4 row_mask:0xf bank_mask:0x5
    v_mov_b32_dpp v248, v90 row_shr:4 row_mask:0xf bank_mask:0xa
    v_mfma_f32_16x16x32_bf16 v[184:187], v[236:239], v[56:59], v[184:187]
    v_mov_b32_dpp v249, v89 row_shl:4 row_mask:0xf bank_mask:0x5
    v_mov_b32_dpp v249, v91 row_shr:4 row_mask:0xf bank_mask:0xa
    v_mov_b32_dpp v88, v90 quad_perm:[0,1,2,3] row_mask:0xf bank_mask:0xa
    v_mfma_f32_16x16x32_bf16 v[200:203], v[240:243], v[56:59], v[200:203]
    v_mov_b32_dpp v89, v91 quad_perm:[0,1,2,3] row_mask:0xf bank_mask:0xa
    v_perm_b32 v72, v248, v88, v252
    v_mfma_f32_16x16x32_bf16 v[216:219], v[244:247], v[56:59], v[216:219]
    v_perm_b32 v76, v248, v88, v253
    v_perm_b32 v80, v249, v89, v252
    v_perm_b32 v84, v249, v89, v253
    v_mfma_f32_16x16x32_bf16 v[172:175], v[232:235], v[60:63], v[172:175]
    v_mov_b32_dpp v250, v92 row_shl:4 row_mask:0xf bank_mask:0x5
    v_mov_b32_dpp v250, v94 row_shr:4 row_mask:0xf bank_mask:0xa
    v_mfma_f32_16x16x32_bf16 v[188:191], v[236:239], v[60:63], v[188:191]
    v_mov_b32_dpp v251, v93 row_shl:4 row_mask:0xf bank_mask:0x5
    v_mov_b32_dpp v251, v95 row_shr:4 row_mask:0xf bank_mask:0xa
    v_mov_b32_dpp v92, v94 quad_perm:[0,1,2,3] row_mask:0xf bank_mask:0xa
    v_mfma_f32_16x16x32_bf16 v[204:207], v[240:243], v[60:63], v[204:207]
    v_mov_b32_dpp v93, v95 quad_perm:[0,1,2,3] row_mask:0xf bank_mask:0xa
    v_perm_b32 v73, v250, v92, v252
    v_mfma_f32_16x16x32_bf16 v[220:223], v[244:247], v[60:63], v[220:223]
    v_perm_b32 v77, v250, v92, v253
    v_perm_b32 v81, v251, v93, v252
    v_perm_b32 v85, v251, v93, v253
    v_mfma_f32_16x16x32_bf16 v[176:179], v[232:235], v[64:67], v[176:179]
    v_mov_b32_dpp v248, v96 row_shl:4 row_mask:0xf bank_mask:0x5
    v_mov_b32_dpp v248, v98 row_shr:4 row_mask:0xf bank_mask:0xa
    v_mov_b32_dpp v249, v97 row_shl:4 row_mask:0xf bank_mask:0x5
    v_mfma_f32_16x16x32_bf16 v[192:195], v[236:239], v[64:67], v[192:195]
    v_mov_b32_dpp v249, v99 row_shr:4 row_mask:0xf bank_mask:0xa
    v_mov_b32_dpp v96, v98 quad_perm:[0,1,2,3] row_mask:0xf bank_mask:0xa
    v_mfma_f32_16x16x32_bf16 v[208:211], v[240:243], v[64:67], v[208:211]
    v_mov_b32_dpp v97, v99 quad_perm:[0,1,2,3] row_mask:0xf bank_mask:0xa
    v_perm_b32 v74, v248, v96, v252
    v_perm_b32 v78, v248, v96, v253
    v_mfma_f32_16x16x32_bf16 v[224:227], v[244:247], v[64:67], v[224:227]
    v_perm_b32 v82, v249, v97, v252
    v_perm_b32 v86, v249, v97, v253
    v_mfma_f32_16x16x32_bf16 v[180:183], v[232:235], v[68:71], v[180:183]
    v_mov_b32_dpp v250, v100 row_shl:4 row_mask:0xf bank_mask:0x5
    v_mov_b32_dpp v250, v102 row_shr:4 row_mask:0xf bank_mask:0xa
    v_mov_b32_dpp v251, v101 row_shl:4 row_mask:0xf bank_mask:0x5
    v_mfma_f32_16x16x32_bf16 v[196:199], v[236:239], v[68:71], v[196:199]
    v_mov_b32_dpp v251, v103 row_shr:4 row_mask:0xf bank_mask:0xa
    v_mov_b32_dpp v100, v102 quad_perm:[0,1,2,3] row_mask:0xf bank_mask:0xa
    v_mfma_f32_16x16x32_bf16 v[212:215], v[240:243], v[68:71], v[212:215]
    v_mov_b32_dpp v101, v103 quad_perm:[0,1,2,3] row_mask:0xf bank_mask:0xa
    v_perm_b32 v75, v250, v100, v252
    v_perm_b32 v79, v250, v100, v253
    v_mfma_f32_16x16x32_bf16 v[228:231], v[244:247], v[68:71], v[228:231]
    v_perm_b32 v83, v251, v101, v252
    v_perm_b32 v87, v251, v101, v253
    buffer_load_dwordx4 v[56:59], v4, s[8:11], s20 offen
    buffer_load_dwordx4 v[60:63], v4, s[8:11], s21 offen
    buffer_load_dwordx4 v[64:67], v4, s[8:11], s22 offen
    buffer_load_dwordx4 v[68:71], v4, s[8:11], s23 offen
    s_add_u32 s20, s20, 30720
    s_add_u32 s21, s21, 30720
    s_add_u32 s22, s22, 30720
    s_add_u32 s23, s23, 30720
    s_waitcnt lgkmcnt(0)
    ds_read_b128 v[232:235], v11 offset:64
    ds_read_b128 v[236:239], v11 offset:5440
    ds_read_b128 v[240:243], v11 offset:10816
    ds_read_b128 v[244:247], v11 offset:16192
    v_mfma_f32_16x16x32_bf16 v[168:171], v[12:15], v[72:75], v[168:171]
    s_waitcnt vmcnt(20)
    v_mov_b32_dpp v248, v104 row_shl:4 row_mask:0xf bank_mask:0x5
    v_mov_b32_dpp v248, v106 row_shr:4 row_mask:0xf bank_mask:0xa
    v_mfma_f32_16x16x32_bf16 v[184:187], v[16:19], v[72:75], v[184:187]
    v_mov_b32_dpp v249, v105 row_shl:4 row_mask:0xf bank_mask:0x5
    v_mov_b32_dpp v249, v107 row_shr:4 row_mask:0xf bank_mask:0xa
    v_mov_b32_dpp v104, v106 quad_perm:[0,1,2,3] row_mask:0xf bank_mask:0xa
    v_mfma_f32_16x16x32_bf16 v[200:203], v[20:23], v[72:75], v[200:203]
    v_mov_b32_dpp v105, v107 quad_perm:[0,1,2,3] row_mask:0xf bank_mask:0xa
    v_perm_b32 v88, v248, v104, v252
    v_mfma_f32_16x16x32_bf16 v[216:219], v[24:27], v[72:75], v[216:219]
    v_perm_b32 v92, v248, v104, v253
    v_perm_b32 v96, v249, v105, v252
    v_perm_b32 v100, v249, v105, v253
    v_mfma_f32_16x16x32_bf16 v[172:175], v[12:15], v[76:79], v[172:175]
    v_mov_b32_dpp v250, v108 row_shl:4 row_mask:0xf bank_mask:0x5
    v_mov_b32_dpp v250, v110 row_shr:4 row_mask:0xf bank_mask:0xa
    v_mfma_f32_16x16x32_bf16 v[188:191], v[16:19], v[76:79], v[188:191]
    v_mov_b32_dpp v251, v109 row_shl:4 row_mask:0xf bank_mask:0x5
    v_mov_b32_dpp v251, v111 row_shr:4 row_mask:0xf bank_mask:0xa
    v_mov_b32_dpp v108, v110 quad_perm:[0,1,2,3] row_mask:0xf bank_mask:0xa
    v_mfma_f32_16x16x32_bf16 v[204:207], v[20:23], v[76:79], v[204:207]
    v_mov_b32_dpp v109, v111 quad_perm:[0,1,2,3] row_mask:0xf bank_mask:0xa
    v_perm_b32 v89, v250, v108, v252
    v_mfma_f32_16x16x32_bf16 v[220:223], v[24:27], v[76:79], v[220:223]
    v_perm_b32 v93, v250, v108, v253
    v_perm_b32 v97, v251, v109, v252
    v_perm_b32 v101, v251, v109, v253
    v_mfma_f32_16x16x32_bf16 v[176:179], v[12:15], v[80:83], v[176:179]
    v_mov_b32_dpp v248, v112 row_shl:4 row_mask:0xf bank_mask:0x5
    v_mov_b32_dpp v248, v114 row_shr:4 row_mask:0xf bank_mask:0xa
    v_mov_b32_dpp v249, v113 row_shl:4 row_mask:0xf bank_mask:0x5
    v_mfma_f32_16x16x32_bf16 v[192:195], v[16:19], v[80:83], v[192:195]
    v_mov_b32_dpp v249, v115 row_shr:4 row_mask:0xf bank_mask:0xa
    v_mov_b32_dpp v112, v114 quad_perm:[0,1,2,3] row_mask:0xf bank_mask:0xa
    v_mfma_f32_16x16x32_bf16 v[208:211], v[20:23], v[80:83], v[208:211]
    v_mov_b32_dpp v113, v115 quad_perm:[0,1,2,3] row_mask:0xf bank_mask:0xa
    v_perm_b32 v90, v248, v112, v252
    v_perm_b32 v94, v248, v112, v253
    v_mfma_f32_16x16x32_bf16 v[224:227], v[24:27], v[80:83], v[224:227]
    v_perm_b32 v98, v249, v113, v252
    v_perm_b32 v102, v249, v113, v253
    v_mfma_f32_16x16x32_bf16 v[180:183], v[12:15], v[84:87], v[180:183]
    v_mov_b32_dpp v250, v116 row_shl:4 row_mask:0xf bank_mask:0x5
    v_mov_b32_dpp v250, v118 row_shr:4 row_mask:0xf bank_mask:0xa
    v_mov_b32_dpp v251, v117 row_shl:4 row_mask:0xf bank_mask:0x5
    v_mfma_f32_16x16x32_bf16 v[196:199], v[16:19], v[84:87], v[196:199]
    v_mov_b32_dpp v251, v119 row_shr:4 row_mask:0xf bank_mask:0xa
    v_mov_b32_dpp v116, v118 quad_perm:[0,1,2,3] row_mask:0xf bank_mask:0xa
    v_mfma_f32_16x16x32_bf16 v[212:215], v[20:23], v[84:87], v[212:215]
    v_mov_b32_dpp v117, v119 quad_perm:[0,1,2,3] row_mask:0xf bank_mask:0xa
    v_perm_b32 v91, v250, v116, v252
    v_perm_b32 v95, v250, v116, v253
    v_mfma_f32_16x16x32_bf16 v[228:231], v[24:27], v[84:87], v[228:231]
    v_perm_b32 v99, v251, v117, v252
    v_perm_b32 v103, v251, v117, v253
    s_waitcnt lgkmcnt(0)
    ds_read_b128 v[12:15], v11 offset:80
    ds_read_b128 v[16:19], v11 offset:5456
    ds_read_b128 v[20:23], v11 offset:10832
    ds_read_b128 v[24:27], v11 offset:16208
    v_mfma_f32_16x16x32_bf16 v[168:171], v[232:235], v[88:91], v[168:171]
    s_waitcnt vmcnt(16)
    v_mov_b32_dpp v248, v120 row_shl:4 row_mask:0xf bank_mask:0x5
    v_mov_b32_dpp v248, v122 row_shr:4 row_mask:0xf bank_mask:0xa
    v_mfma_f32_16x16x32_bf16 v[184:187], v[236:239], v[88:91], v[184:187]
    v_mov_b32_dpp v249, v121 row_shl:4 row_mask:0xf bank_mask:0x5
    v_mov_b32_dpp v249, v123 row_shr:4 row_mask:0xf bank_mask:0xa
    v_mov_b32_dpp v120, v122 quad_perm:[0,1,2,3] row_mask:0xf bank_mask:0xa
    v_mfma_f32_16x16x32_bf16 v[200:203], v[240:243], v[88:91], v[200:203]
    v_mov_b32_dpp v121, v123 quad_perm:[0,1,2,3] row_mask:0xf bank_mask:0xa
    v_perm_b32 v104, v248, v120, v252
    v_mfma_f32_16x16x32_bf16 v[216:219], v[244:247], v[88:91], v[216:219]
    v_perm_b32 v108, v248, v120, v253
    v_perm_b32 v112, v249, v121, v252
    v_perm_b32 v116, v249, v121, v253
    v_mfma_f32_16x16x32_bf16 v[172:175], v[232:235], v[92:95], v[172:175]
    v_mov_b32_dpp v250, v124 row_shl:4 row_mask:0xf bank_mask:0x5
    v_mov_b32_dpp v250, v126 row_shr:4 row_mask:0xf bank_mask:0xa
    v_mfma_f32_16x16x32_bf16 v[188:191], v[236:239], v[92:95], v[188:191]
    v_mov_b32_dpp v251, v125 row_shl:4 row_mask:0xf bank_mask:0x5
    v_mov_b32_dpp v251, v127 row_shr:4 row_mask:0xf bank_mask:0xa
    v_mov_b32_dpp v124, v126 quad_perm:[0,1,2,3] row_mask:0xf bank_mask:0xa
    v_mfma_f32_16x16x32_bf16 v[204:207], v[240:243], v[92:95], v[204:207]
    v_mov_b32_dpp v125, v127 quad_perm:[0,1,2,3] row_mask:0xf bank_mask:0xa
    v_perm_b32 v105, v250, v124, v252
    v_mfma_f32_16x16x32_bf16 v[220:223], v[244:247], v[92:95], v[220:223]
    v_perm_b32 v109, v250, v124, v253
    v_perm_b32 v113, v251, v125, v252
    v_perm_b32 v117, v251, v125, v253
    v_mfma_f32_16x16x32_bf16 v[176:179], v[232:235], v[96:99], v[176:179]
    v_mov_b32_dpp v248, v128 row_shl:4 row_mask:0xf bank_mask:0x5
    v_mov_b32_dpp v248, v130 row_shr:4 row_mask:0xf bank_mask:0xa
    v_mov_b32_dpp v249, v129 row_shl:4 row_mask:0xf bank_mask:0x5
    v_mfma_f32_16x16x32_bf16 v[192:195], v[236:239], v[96:99], v[192:195]
    v_mov_b32_dpp v249, v131 row_shr:4 row_mask:0xf bank_mask:0xa
    v_mov_b32_dpp v128, v130 quad_perm:[0,1,2,3] row_mask:0xf bank_mask:0xa
    v_mfma_f32_16x16x32_bf16 v[208:211], v[240:243], v[96:99], v[208:211]
    v_mov_b32_dpp v129, v131 quad_perm:[0,1,2,3] row_mask:0xf bank_mask:0xa
    v_perm_b32 v106, v248, v128, v252
    v_perm_b32 v110, v248, v128, v253
    v_mfma_f32_16x16x32_bf16 v[224:227], v[244:247], v[96:99], v[224:227]
    v_perm_b32 v114, v249, v129, v252
    v_perm_b32 v118, v249, v129, v253
    v_mfma_f32_16x16x32_bf16 v[180:183], v[232:235], v[100:103], v[180:183]
    v_mov_b32_dpp v250, v132 row_shl:4 row_mask:0xf bank_mask:0x5
    v_mov_b32_dpp v250, v134 row_shr:4 row_mask:0xf bank_mask:0xa
    v_mov_b32_dpp v251, v133 row_shl:4 row_mask:0xf bank_mask:0x5
    v_mfma_f32_16x16x32_bf16 v[196:199], v[236:239], v[100:103], v[196:199]
    v_mov_b32_dpp v251, v135 row_shr:4 row_mask:0xf bank_mask:0xa
    v_mov_b32_dpp v132, v134 quad_perm:[0,1,2,3] row_mask:0xf bank_mask:0xa
    v_mfma_f32_16x16x32_bf16 v[212:215], v[240:243], v[100:103], v[212:215]
    v_mov_b32_dpp v133, v135 quad_perm:[0,1,2,3] row_mask:0xf bank_mask:0xa
    v_perm_b32 v107, v250, v132, v252
    v_perm_b32 v111, v250, v132, v253
    v_mfma_f32_16x16x32_bf16 v[228:231], v[244:247], v[100:103], v[228:231]
    v_perm_b32 v115, v251, v133, v252
    v_perm_b32 v119, v251, v133, v253
    s_waitcnt lgkmcnt(0)
    ds_read_b128 v[232:235], v11 offset:96
    ds_read_b128 v[236:239], v11 offset:5472
    ds_read_b128 v[240:243], v11 offset:10848
    ds_read_b128 v[244:247], v11 offset:16224
    v_mfma_f32_16x16x32_bf16 v[168:171], v[12:15], v[104:107], v[168:171]
    s_waitcnt vmcnt(12)
    v_mov_b32_dpp v248, v136 row_shl:4 row_mask:0xf bank_mask:0x5
    v_mov_b32_dpp v248, v138 row_shr:4 row_mask:0xf bank_mask:0xa
    v_mfma_f32_16x16x32_bf16 v[184:187], v[16:19], v[104:107], v[184:187]
    v_mov_b32_dpp v249, v137 row_shl:4 row_mask:0xf bank_mask:0x5
    v_mov_b32_dpp v249, v139 row_shr:4 row_mask:0xf bank_mask:0xa
    v_mov_b32_dpp v136, v138 quad_perm:[0,1,2,3] row_mask:0xf bank_mask:0xa
    v_mfma_f32_16x16x32_bf16 v[200:203], v[20:23], v[104:107], v[200:203]
    v_mov_b32_dpp v137, v139 quad_perm:[0,1,2,3] row_mask:0xf bank_mask:0xa
    v_perm_b32 v120, v248, v136, v252
    v_mfma_f32_16x16x32_bf16 v[216:219], v[24:27], v[104:107], v[216:219]
    v_perm_b32 v124, v248, v136, v253
    v_perm_b32 v128, v249, v137, v252
    v_perm_b32 v132, v249, v137, v253
    v_mfma_f32_16x16x32_bf16 v[172:175], v[12:15], v[108:111], v[172:175]
    v_mov_b32_dpp v250, v140 row_shl:4 row_mask:0xf bank_mask:0x5
    v_mov_b32_dpp v250, v142 row_shr:4 row_mask:0xf bank_mask:0xa
    v_mfma_f32_16x16x32_bf16 v[188:191], v[16:19], v[108:111], v[188:191]
    v_mov_b32_dpp v251, v141 row_shl:4 row_mask:0xf bank_mask:0x5
    v_mov_b32_dpp v251, v143 row_shr:4 row_mask:0xf bank_mask:0xa
    v_mov_b32_dpp v140, v142 quad_perm:[0,1,2,3] row_mask:0xf bank_mask:0xa
    v_mfma_f32_16x16x32_bf16 v[204:207], v[20:23], v[108:111], v[204:207]
    v_mov_b32_dpp v141, v143 quad_perm:[0,1,2,3] row_mask:0xf bank_mask:0xa
    v_perm_b32 v121, v250, v140, v252
    v_mfma_f32_16x16x32_bf16 v[220:223], v[24:27], v[108:111], v[220:223]
    v_perm_b32 v125, v250, v140, v253
    v_perm_b32 v129, v251, v141, v252
    v_perm_b32 v133, v251, v141, v253
    v_mfma_f32_16x16x32_bf16 v[176:179], v[12:15], v[112:115], v[176:179]
    v_mov_b32_dpp v248, v144 row_shl:4 row_mask:0xf bank_mask:0x5
    v_mov_b32_dpp v248, v146 row_shr:4 row_mask:0xf bank_mask:0xa
    v_mov_b32_dpp v249, v145 row_shl:4 row_mask:0xf bank_mask:0x5
    v_mfma_f32_16x16x32_bf16 v[192:195], v[16:19], v[112:115], v[192:195]
    v_mov_b32_dpp v249, v147 row_shr:4 row_mask:0xf bank_mask:0xa
    v_mov_b32_dpp v144, v146 quad_perm:[0,1,2,3] row_mask:0xf bank_mask:0xa
    v_mfma_f32_16x16x32_bf16 v[208:211], v[20:23], v[112:115], v[208:211]
    v_mov_b32_dpp v145, v147 quad_perm:[0,1,2,3] row_mask:0xf bank_mask:0xa
    v_perm_b32 v122, v248, v144, v252
    v_perm_b32 v126, v248, v144, v253
    v_mfma_f32_16x16x32_bf16 v[224:227], v[24:27], v[112:115], v[224:227]
    v_perm_b32 v130, v249, v145, v252
    v_perm_b32 v134, v249, v145, v253
    v_mfma_f32_16x16x32_bf16 v[180:183], v[12:15], v[116:119], v[180:183]
    v_mov_b32_dpp v250, v148 row_shl:4 row_mask:0xf bank_mask:0x5
    v_mov_b32_dpp v250, v150 row_shr:4 row_mask:0xf bank_mask:0xa
    v_mov_b32_dpp v251, v149 row_shl:4 row_mask:0xf bank_mask:0x5
    v_mfma_f32_16x16x32_bf16 v[196:199], v[16:19], v[116:119], v[196:199]
    v_mov_b32_dpp v251, v151 row_shr:4 row_mask:0xf bank_mask:0xa
    v_mov_b32_dpp v148, v150 quad_perm:[0,1,2,3] row_mask:0xf bank_mask:0xa
    v_mfma_f32_16x16x32_bf16 v[212:215], v[20:23], v[116:119], v[212:215]
    v_mov_b32_dpp v149, v151 quad_perm:[0,1,2,3] row_mask:0xf bank_mask:0xa
    v_perm_b32 v123, v250, v148, v252
    v_perm_b32 v127, v250, v148, v253
    v_mfma_f32_16x16x32_bf16 v[228:231], v[24:27], v[116:119], v[228:231]
    v_perm_b32 v131, v251, v149, v252
    v_perm_b32 v135, v251, v149, v253
    s_waitcnt lgkmcnt(0)
    ds_read_b128 v[12:15], v11 offset:112
    ds_read_b128 v[16:19], v11 offset:5488
    ds_read_b128 v[20:23], v11 offset:10864
    ds_read_b128 v[24:27], v11 offset:16240
    v_mfma_f32_16x16x32_bf16 v[168:171], v[232:235], v[120:123], v[168:171]
    s_waitcnt vmcnt(8)
    v_mov_b32_dpp v248, v152 row_shl:4 row_mask:0xf bank_mask:0x5
    v_mov_b32_dpp v248, v154 row_shr:4 row_mask:0xf bank_mask:0xa
    v_mfma_f32_16x16x32_bf16 v[184:187], v[236:239], v[120:123], v[184:187]
    v_mov_b32_dpp v249, v153 row_shl:4 row_mask:0xf bank_mask:0x5
    v_mov_b32_dpp v249, v155 row_shr:4 row_mask:0xf bank_mask:0xa
    v_mov_b32_dpp v152, v154 quad_perm:[0,1,2,3] row_mask:0xf bank_mask:0xa
    v_mfma_f32_16x16x32_bf16 v[200:203], v[240:243], v[120:123], v[200:203]
    v_mov_b32_dpp v153, v155 quad_perm:[0,1,2,3] row_mask:0xf bank_mask:0xa
    v_perm_b32 v136, v248, v152, v252
    v_mfma_f32_16x16x32_bf16 v[216:219], v[244:247], v[120:123], v[216:219]
    v_perm_b32 v140, v248, v152, v253
    v_perm_b32 v144, v249, v153, v252
    v_perm_b32 v148, v249, v153, v253
    v_mfma_f32_16x16x32_bf16 v[172:175], v[232:235], v[124:127], v[172:175]
    v_mov_b32_dpp v250, v156 row_shl:4 row_mask:0xf bank_mask:0x5
    v_mov_b32_dpp v250, v158 row_shr:4 row_mask:0xf bank_mask:0xa
    v_mfma_f32_16x16x32_bf16 v[188:191], v[236:239], v[124:127], v[188:191]
    v_mov_b32_dpp v251, v157 row_shl:4 row_mask:0xf bank_mask:0x5
    v_mov_b32_dpp v251, v159 row_shr:4 row_mask:0xf bank_mask:0xa
    v_mov_b32_dpp v156, v158 quad_perm:[0,1,2,3] row_mask:0xf bank_mask:0xa
    v_mfma_f32_16x16x32_bf16 v[204:207], v[240:243], v[124:127], v[204:207]
    v_mov_b32_dpp v157, v159 quad_perm:[0,1,2,3] row_mask:0xf bank_mask:0xa
    v_perm_b32 v137, v250, v156, v252
    v_mfma_f32_16x16x32_bf16 v[220:223], v[244:247], v[124:127], v[220:223]
    v_perm_b32 v141, v250, v156, v253
    v_perm_b32 v145, v251, v157, v252
    v_perm_b32 v149, v251, v157, v253
    v_mfma_f32_16x16x32_bf16 v[176:179], v[232:235], v[128:131], v[176:179]
    v_mov_b32_dpp v248, v160 row_shl:4 row_mask:0xf bank_mask:0x5
    v_mov_b32_dpp v248, v162 row_shr:4 row_mask:0xf bank_mask:0xa
    v_mov_b32_dpp v249, v161 row_shl:4 row_mask:0xf bank_mask:0x5
    v_mfma_f32_16x16x32_bf16 v[192:195], v[236:239], v[128:131], v[192:195]
    v_mov_b32_dpp v249, v163 row_shr:4 row_mask:0xf bank_mask:0xa
    v_mov_b32_dpp v160, v162 quad_perm:[0,1,2,3] row_mask:0xf bank_mask:0xa
    v_mfma_f32_16x16x32_bf16 v[208:211], v[240:243], v[128:131], v[208:211]
    v_mov_b32_dpp v161, v163 quad_perm:[0,1,2,3] row_mask:0xf bank_mask:0xa
    v_perm_b32 v138, v248, v160, v252
    v_perm_b32 v142, v248, v160, v253
    v_mfma_f32_16x16x32_bf16 v[224:227], v[244:247], v[128:131], v[224:227]
    v_perm_b32 v146, v249, v161, v252
    v_perm_b32 v150, v249, v161, v253
    v_mfma_f32_16x16x32_bf16 v[180:183], v[232:235], v[132:135], v[180:183]
    v_mov_b32_dpp v250, v164 row_shl:4 row_mask:0xf bank_mask:0x5
    v_mov_b32_dpp v250, v166 row_shr:4 row_mask:0xf bank_mask:0xa
    v_mov_b32_dpp v251, v165 row_shl:4 row_mask:0xf bank_mask:0x5
    v_mfma_f32_16x16x32_bf16 v[196:199], v[236:239], v[132:135], v[196:199]
    v_mov_b32_dpp v251, v167 row_shr:4 row_mask:0xf bank_mask:0xa
    v_mov_b32_dpp v164, v166 quad_perm:[0,1,2,3] row_mask:0xf bank_mask:0xa
    v_mfma_f32_16x16x32_bf16 v[212:215], v[240:243], v[132:135], v[212:215]
    v_mov_b32_dpp v165, v167 quad_perm:[0,1,2,3] row_mask:0xf bank_mask:0xa
    v_perm_b32 v139, v250, v164, v252
    v_perm_b32 v143, v250, v164, v253
    v_mfma_f32_16x16x32_bf16 v[228:231], v[244:247], v[132:135], v[228:231]
    v_perm_b32 v147, v251, v165, v252
    v_perm_b32 v151, v251, v165, v253
    s_waitcnt lgkmcnt(0)
    ds_read_b128 v[232:235], v11 offset:128
    ds_read_b128 v[236:239], v11 offset:5504
    ds_read_b128 v[240:243], v11 offset:10880
    ds_read_b128 v[244:247], v11 offset:16256
    v_mfma_f32_16x16x32_bf16 v[168:171], v[12:15], v[136:139], v[168:171]
    s_waitcnt vmcnt(4)
    v_mov_b32_dpp v248, v40 row_shl:4 row_mask:0xf bank_mask:0x5
    v_mov_b32_dpp v248, v42 row_shr:4 row_mask:0xf bank_mask:0xa
    v_mfma_f32_16x16x32_bf16 v[184:187], v[16:19], v[136:139], v[184:187]
    v_mov_b32_dpp v249, v41 row_shl:4 row_mask:0xf bank_mask:0x5
    v_mov_b32_dpp v249, v43 row_shr:4 row_mask:0xf bank_mask:0xa
    v_mov_b32_dpp v40, v42 quad_perm:[0,1,2,3] row_mask:0xf bank_mask:0xa
    v_mfma_f32_16x16x32_bf16 v[200:203], v[20:23], v[136:139], v[200:203]
    v_mov_b32_dpp v41, v43 quad_perm:[0,1,2,3] row_mask:0xf bank_mask:0xa
    v_perm_b32 v152, v248, v40, v252
    v_mfma_f32_16x16x32_bf16 v[216:219], v[24:27], v[136:139], v[216:219]
    v_perm_b32 v156, v248, v40, v253
    v_perm_b32 v160, v249, v41, v252
    v_perm_b32 v164, v249, v41, v253
    v_mfma_f32_16x16x32_bf16 v[172:175], v[12:15], v[140:143], v[172:175]
    v_mov_b32_dpp v250, v44 row_shl:4 row_mask:0xf bank_mask:0x5
    v_mov_b32_dpp v250, v46 row_shr:4 row_mask:0xf bank_mask:0xa
    v_mfma_f32_16x16x32_bf16 v[188:191], v[16:19], v[140:143], v[188:191]
    v_mov_b32_dpp v251, v45 row_shl:4 row_mask:0xf bank_mask:0x5
    v_mov_b32_dpp v251, v47 row_shr:4 row_mask:0xf bank_mask:0xa
    v_mov_b32_dpp v44, v46 quad_perm:[0,1,2,3] row_mask:0xf bank_mask:0xa
    v_mfma_f32_16x16x32_bf16 v[204:207], v[20:23], v[140:143], v[204:207]
    v_mov_b32_dpp v45, v47 quad_perm:[0,1,2,3] row_mask:0xf bank_mask:0xa
    v_perm_b32 v153, v250, v44, v252
    v_mfma_f32_16x16x32_bf16 v[220:223], v[24:27], v[140:143], v[220:223]
    v_perm_b32 v157, v250, v44, v253
    v_perm_b32 v161, v251, v45, v252
    v_perm_b32 v165, v251, v45, v253
    v_mfma_f32_16x16x32_bf16 v[176:179], v[12:15], v[144:147], v[176:179]
    v_mov_b32_dpp v248, v48 row_shl:4 row_mask:0xf bank_mask:0x5
    v_mov_b32_dpp v248, v50 row_shr:4 row_mask:0xf bank_mask:0xa
    v_mov_b32_dpp v249, v49 row_shl:4 row_mask:0xf bank_mask:0x5
    v_mfma_f32_16x16x32_bf16 v[192:195], v[16:19], v[144:147], v[192:195]
    v_mov_b32_dpp v249, v51 row_shr:4 row_mask:0xf bank_mask:0xa
    v_mov_b32_dpp v48, v50 quad_perm:[0,1,2,3] row_mask:0xf bank_mask:0xa
    v_mfma_f32_16x16x32_bf16 v[208:211], v[20:23], v[144:147], v[208:211]
    v_mov_b32_dpp v49, v51 quad_perm:[0,1,2,3] row_mask:0xf bank_mask:0xa
    v_perm_b32 v154, v248, v48, v252
    v_perm_b32 v158, v248, v48, v253
    v_mfma_f32_16x16x32_bf16 v[224:227], v[24:27], v[144:147], v[224:227]
    v_perm_b32 v162, v249, v49, v252
    v_perm_b32 v166, v249, v49, v253
    v_mfma_f32_16x16x32_bf16 v[180:183], v[12:15], v[148:151], v[180:183]
    v_mov_b32_dpp v250, v52 row_shl:4 row_mask:0xf bank_mask:0x5
    v_mov_b32_dpp v250, v54 row_shr:4 row_mask:0xf bank_mask:0xa
    v_mov_b32_dpp v251, v53 row_shl:4 row_mask:0xf bank_mask:0x5
    v_mfma_f32_16x16x32_bf16 v[196:199], v[16:19], v[148:151], v[196:199]
    v_mov_b32_dpp v251, v55 row_shr:4 row_mask:0xf bank_mask:0xa
    v_mov_b32_dpp v52, v54 quad_perm:[0,1,2,3] row_mask:0xf bank_mask:0xa
    v_mfma_f32_16x16x32_bf16 v[212:215], v[20:23], v[148:151], v[212:215]
    v_mov_b32_dpp v53, v55 quad_perm:[0,1,2,3] row_mask:0xf bank_mask:0xa
    v_perm_b32 v155, v250, v52, v252
    v_perm_b32 v159, v250, v52, v253
    v_mfma_f32_16x16x32_bf16 v[228:231], v[24:27], v[148:151], v[228:231]
    v_perm_b32 v163, v251, v53, v252
    v_perm_b32 v167, v251, v53, v253
    s_waitcnt lgkmcnt(0)
    ds_read_b128 v[12:15], v11 offset:144
    ds_read_b128 v[16:19], v11 offset:5520
    ds_read_b128 v[20:23], v11 offset:10896
    ds_read_b128 v[24:27], v11 offset:16272
    v_mfma_f32_16x16x32_bf16 v[168:171], v[232:235], v[152:155], v[168:171]
    s_waitcnt vmcnt(0)
    v_mov_b32_dpp v248, v56 row_shl:4 row_mask:0xf bank_mask:0x5
    v_mov_b32_dpp v248, v58 row_shr:4 row_mask:0xf bank_mask:0xa
    v_mfma_f32_16x16x32_bf16 v[184:187], v[236:239], v[152:155], v[184:187]
    v_mov_b32_dpp v249, v57 row_shl:4 row_mask:0xf bank_mask:0x5
    v_mov_b32_dpp v249, v59 row_shr:4 row_mask:0xf bank_mask:0xa
    v_mov_b32_dpp v56, v58 quad_perm:[0,1,2,3] row_mask:0xf bank_mask:0xa
    v_mfma_f32_16x16x32_bf16 v[200:203], v[240:243], v[152:155], v[200:203]
    v_mov_b32_dpp v57, v59 quad_perm:[0,1,2,3] row_mask:0xf bank_mask:0xa
    v_perm_b32 v40, v248, v56, v252
    v_mfma_f32_16x16x32_bf16 v[216:219], v[244:247], v[152:155], v[216:219]
    v_perm_b32 v44, v248, v56, v253
    v_perm_b32 v48, v249, v57, v252
    v_perm_b32 v52, v249, v57, v253
    v_mfma_f32_16x16x32_bf16 v[172:175], v[232:235], v[156:159], v[172:175]
    v_mov_b32_dpp v250, v60 row_shl:4 row_mask:0xf bank_mask:0x5
    v_mov_b32_dpp v250, v62 row_shr:4 row_mask:0xf bank_mask:0xa
    v_mfma_f32_16x16x32_bf16 v[188:191], v[236:239], v[156:159], v[188:191]
    v_mov_b32_dpp v251, v61 row_shl:4 row_mask:0xf bank_mask:0x5
    v_mov_b32_dpp v251, v63 row_shr:4 row_mask:0xf bank_mask:0xa
    v_mov_b32_dpp v60, v62 quad_perm:[0,1,2,3] row_mask:0xf bank_mask:0xa
    v_mfma_f32_16x16x32_bf16 v[204:207], v[240:243], v[156:159], v[204:207]
    v_mov_b32_dpp v61, v63 quad_perm:[0,1,2,3] row_mask:0xf bank_mask:0xa
    v_perm_b32 v41, v250, v60, v252
    v_mfma_f32_16x16x32_bf16 v[220:223], v[244:247], v[156:159], v[220:223]
    v_perm_b32 v45, v250, v60, v253
    v_perm_b32 v49, v251, v61, v252
    v_perm_b32 v53, v251, v61, v253
    v_mfma_f32_16x16x32_bf16 v[176:179], v[232:235], v[160:163], v[176:179]
    v_mov_b32_dpp v248, v64 row_shl:4 row_mask:0xf bank_mask:0x5
    v_mov_b32_dpp v248, v66 row_shr:4 row_mask:0xf bank_mask:0xa
    v_mov_b32_dpp v249, v65 row_shl:4 row_mask:0xf bank_mask:0x5
    v_mfma_f32_16x16x32_bf16 v[192:195], v[236:239], v[160:163], v[192:195]
    v_mov_b32_dpp v249, v67 row_shr:4 row_mask:0xf bank_mask:0xa
    v_mov_b32_dpp v64, v66 quad_perm:[0,1,2,3] row_mask:0xf bank_mask:0xa
    v_mfma_f32_16x16x32_bf16 v[208:211], v[240:243], v[160:163], v[208:211]
    v_mov_b32_dpp v65, v67 quad_perm:[0,1,2,3] row_mask:0xf bank_mask:0xa
    v_perm_b32 v42, v248, v64, v252
    v_perm_b32 v46, v248, v64, v253
    v_mfma_f32_16x16x32_bf16 v[224:227], v[244:247], v[160:163], v[224:227]
    v_perm_b32 v50, v249, v65, v252
    v_perm_b32 v54, v249, v65, v253
    v_mfma_f32_16x16x32_bf16 v[180:183], v[232:235], v[164:167], v[180:183]
    v_mov_b32_dpp v250, v68 row_shl:4 row_mask:0xf bank_mask:0x5
    v_mov_b32_dpp v250, v70 row_shr:4 row_mask:0xf bank_mask:0xa
    v_mov_b32_dpp v251, v69 row_shl:4 row_mask:0xf bank_mask:0x5
    v_mfma_f32_16x16x32_bf16 v[196:199], v[236:239], v[164:167], v[196:199]
    v_mov_b32_dpp v251, v71 row_shr:4 row_mask:0xf bank_mask:0xa
    v_mov_b32_dpp v68, v70 quad_perm:[0,1,2,3] row_mask:0xf bank_mask:0xa
    v_mfma_f32_16x16x32_bf16 v[212:215], v[240:243], v[164:167], v[212:215]
    v_mov_b32_dpp v69, v71 quad_perm:[0,1,2,3] row_mask:0xf bank_mask:0xa
    v_perm_b32 v43, v250, v68, v252
    v_perm_b32 v47, v250, v68, v253
    v_mfma_f32_16x16x32_bf16 v[228:231], v[244:247], v[164:167], v[228:231]
    v_perm_b32 v51, v251, v69, v252
    v_perm_b32 v55, v251, v69, v253
    s_waitcnt lgkmcnt(0)
    v_mfma_f32_16x16x32_bf16 v[168:171], v[12:15], v[40:43], v[168:171]
    v_mfma_f32_16x16x32_bf16 v[184:187], v[16:19], v[40:43], v[184:187]
    v_mfma_f32_16x16x32_bf16 v[200:203], v[20:23], v[40:43], v[200:203]
    v_mfma_f32_16x16x32_bf16 v[216:219], v[24:27], v[40:43], v[216:219]
    v_mfma_f32_16x16x32_bf16 v[172:175], v[12:15], v[44:47], v[172:175]
    v_mfma_f32_16x16x32_bf16 v[188:191], v[16:19], v[44:47], v[188:191]
    v_mfma_f32_16x16x32_bf16 v[204:207], v[20:23], v[44:47], v[204:207]
    v_mfma_f32_16x16x32_bf16 v[220:223], v[24:27], v[44:47], v[220:223]
    v_mfma_f32_16x16x32_bf16 v[176:179], v[12:15], v[48:51], v[176:179]
    v_mfma_f32_16x16x32_bf16 v[192:195], v[16:19], v[48:51], v[192:195]
    v_mfma_f32_16x16x32_bf16 v[208:211], v[20:23], v[48:51], v[208:211]
    v_mfma_f32_16x16x32_bf16 v[224:227], v[24:27], v[48:51], v[224:227]
    v_mfma_f32_16x16x32_bf16 v[180:183], v[12:15], v[52:55], v[180:183]
    v_mfma_f32_16x16x32_bf16 v[196:199], v[16:19], v[52:55], v[196:199]
    v_mfma_f32_16x16x32_bf16 v[212:215], v[20:23], v[52:55], v[212:215]
    v_mfma_f32_16x16x32_bf16 v[228:231], v[24:27], v[52:55], v[228:231]
    s_branch LK1_g2V
LK1_g1V:
    ds_read_b128 v[232:235], v11 offset:0
    ds_read_b128 v[236:239], v11 offset:5376
    ds_read_b128 v[240:243], v11 offset:10752
    ds_read_b128 v[244:247], v11 offset:16128
    s_waitcnt lgkmcnt(0)
    ds_read_b128 v[12:15], v11 offset:16
    ds_read_b128 v[16:19], v11 offset:5392
    ds_read_b128 v[20:23], v11 offset:10768
    ds_read_b128 v[24:27], v11 offset:16144
    v_mfma_f32_16x16x32_bf16 v[168:171], v[232:235], v[152:155], 0
    v_mfma_f32_16x16x32_bf16 v[184:187], v[236:239], v[152:155], 0
    v_mfma_f32_16x16x32_bf16 v[200:203], v[240:243], v[152:155], 0
    v_mfma_f32_16x16x32_bf16 v[216:219], v[244:247], v[152:155], 0
    v_mfma_f32_16x16x32_bf16 v[172:175], v[232:235], v[156:159], 0
    v_mfma_f32_16x16x32_bf16 v[188:191], v[236:239], v[156:159], 0
    v_mfma_f32_16x16x32_bf16 v[204:207], v[240:243], v[156:159], 0
    v_mfma_f32_16x16x32_bf16 v[220:223], v[244:247], v[156:159], 0
    v_mfma_f32_16x16x32_bf16 v[176:179], v[232:235], v[160:163], 0
    v_mfma_f32_16x16x32_bf16 v[192:195], v[236:239], v[160:163], 0
    v_mfma_f32_16x16x32_bf16 v[208:211], v[240:243], v[160:163], 0
    v_mfma_f32_16x16x32_bf16 v[224:227], v[244:247], v[160:163], 0
    v_mfma_f32_16x16x32_bf16 v[180:183], v[232:235], v[164:167], 0
    v_mfma_f32_16x16x32_bf16 v[196:199], v[236:239], v[164:167], 0
    v_mfma_f32_16x16x32_bf16 v[212:215], v[240:243], v[164:167], 0
    v_mfma_f32_16x16x32_bf16 v[228:231], v[244:247], v[164:167], 0
    buffer_load_dwordx4 v[152:155], v4, s[8:11], s20 offen
    buffer_load_dwordx4 v[156:159], v4, s[8:11], s21 offen
    buffer_load_dwordx4 v[160:163], v4, s[8:11], s22 offen
    buffer_load_dwordx4 v[164:167], v4, s[8:11], s23 offen
    s_add_u32 s20, s20, 30720
    s_add_u32 s21, s21, 30720
    s_add_u32 s22, s22, 30720
    s_add_u32 s23, s23, 30720
    s_waitcnt lgkmcnt(0)
    ds_read_b128 v[232:235], v11 offset:32
    ds_read_b128 v[236:239], v11 offset:5408
    ds_read_b128 v[240:243], v11 offset:10784
    ds_read_b128 v[244:247], v11 offset:16160
    v_mfma_f32_16x16x32_bf16 v[168:171], v[12:15], v[40:43], v[168:171]
    s_waitcnt vmcnt(20)
    v_mov_b32_dpp v248, v72 row_shl:4 row_mask:0xf bank_mask:0x5
    v_mov_b32_dpp v248, v74 row_shr:4 row_mask:0xf bank_mask:0xa
    v_mfma_f32_16x16x32_bf16 v[184:187], v[16:19], v[40:43], v[184:187]
    v_mov_b32_dpp v249, v73 row_shl:4 row_mask:0xf bank_mask:0x5
    v_mov_b32_dpp v249, v75 row_shr:4 row_mask:0xf bank_mask:0xa
    v_mov_b32_dpp v72, v74 quad_perm:[0,1,2,3] row_mask:0xf bank_mask:0xa
    v_mfma_f32_16x16x32_bf16 v[200:203], v[20:23], v[40:43], v[200:203]
    v_mov_b32_dpp v73, v75 quad_perm:[0,1,2,3] row_mask:0xf bank_mask:0xa
    v_perm_b32 v56, v248, v72, v252
    v_mfma_f32_16x16x32_bf16 v[216:219], v[24:27], v[40:43], v[216:219]
    v_perm_b32 v60, v248, v72, v253
    v_perm_b32 v64, v249, v73, v252
    v_perm_b32 v68, v249, v73, v253
    v_mfma_f32_16x16x32_bf16 v[172:175], v[12:15], v[44:47], v[172:175]
    v_mov_b32_dpp v250, v76 row_shl:4 row_mask:0xf bank_mask:0x5
    v_mov_b32_dpp v250, v78 row_shr:4 row_mask:0xf bank_mask:0xa
    v_mfma_f32_16x16x32_bf16 v[188:191], v[16:19], v[44:47], v[188:191]
    v_mov_b32_dpp v251, v77 row_shl:4 row_mask:0xf bank_mask:0x5
    v_mov_b32_dpp v251, v79 row_shr:4 row_mask:0xf bank_mask:0xa
    v_mov_b32_dpp v76, v78 quad_perm:[0,1,2,3] row_mask:0xf bank_mask:0xa
    v_mfma_f32_16x16x32_bf16 v[204:207], v[20:23], v[44:47], v[204:207]
    v_mov_b32_dpp v77, v79 quad_perm:[0,1,2,3] row_mask:0xf bank_mask:0xa
    v_perm_b32 v57, v250, v76, v252
    v_mfma_f32_16x16x32_bf16 v[220:223], v[24:27], v[44:47], v[220:223]
    v_perm_b32 v61, v250, v76, v253
    v_perm_b32 v65, v251, v77, v252
    v_perm_b32 v69, v251, v77, v253
    v_mfma_f32_16x16x32_bf16 v[176:179], v[12:15], v[48:51], v[176:179]
    v_mov_b32_dpp v248, v80 row_shl:4 row_mask:0xf bank_mask:0x5
    v_mov_b32_dpp v248, v82 row_shr:4 row_mask:0xf bank_mask:0xa
    v_mov_b32_dpp v249, v81 row_shl:4 row_mask:0xf bank_mask:0x5
    v_mfma_f32_16x16x32_bf16 v[192:195], v[16:19], v[48:51], v[192:195]
    v_mov_b32_dpp v249, v83 row_shr:4 row_mask:0xf bank_mask:0xa
    v_mov_b32_dpp v80, v82 quad_perm:[0,1,2,3] row_mask:0xf bank_mask:0xa
    v_mfma_f32_16x16x32_bf16 v[208:211], v[20:23], v[48:51], v[208:211]
    v_mov_b32_dpp v81, v83 quad_perm:[0,1,2,3] row_mask:0xf bank_mask:0xa
    v_perm_b32 v58, v248, v80, v252
    v_perm_b32 v62, v248, v80, v253
    v_mfma_f32_16x16x32_bf16 v[224:227], v[24:27], v[48:51], v[224:227]
    v_perm_b32 v66, v249, v81, v252
    v_perm_b32 v70, v249, v81, v253
    v_mfma_f32_16x16x32_bf16 v[180:183], v[12:15], v[52:55], v[180:183]
    v_mov_b32_dpp v250, v84 row_shl:4 row_mask:0xf bank_mask:0x5
    v_mov_b32_dpp v250, v86 row_shr:4 row_mask:0xf bank_mask:0xa
    v_mov_b32_dpp v251, v85 row_shl:4 row_mask:0xf bank_mask:0x5
    v_mfma_f32_16x16x32_bf16 v[196:199], v[16:19], v[52:55], v[196:199]
    v_mov_b32_dpp v251, v87 row_shr:4 row_mask:0xf bank_mask:0xa
    v_mov_b32_dpp v84, v86 quad_perm:[0,1,2,3] row_mask:0xf bank_mask:0xa
    v_mfma_f32_16x16x32_bf16 v[212:215], v[20:23], v[52:55], v[212:215]
    v_mov_b32_dpp v85, v87 quad_perm:[0,1,2,3] row_mask:0xf bank_mask:0xa
    v_perm_b32 v59, v250, v84, v252
    v_perm_b32 v63, v250, v84, v253
    v_mfma_f32_16x16x32_bf16 v[228:231], v[24:27], v[52:55], v[228:231]
    v_perm_b32 v67, v251, v85, v252
    v_perm_b32 v71, v251, v85, v253
    buffer_load_dwordx4 v[40:43], v4, s[8:11], s20 offen
    buffer_load_dwordx4 v[44:47], v4, s[8:11], s21 offen
    buffer_load_dwordx4 v[48:51], v4, s[8:11], s22 offen
    buffer_load_dwordx4 v[52:55], v4, s[8:11], s23 offen
    s_add_u32 s20, s20, 30720
    s_add_u32 s21, s21, 30720
    s_add_u32 s22, s22, 30720
    s_add_u32 s23, s23, 30720
    s_waitcnt lgkmcnt(0)
    ds_read_b128 v[12:15], v11 offset:48
    ds_read_b128 v[16:19], v11 offset:5424
    ds_read_b128 v[20:23], v11 offset:10800
    ds_read_b128 v[24:27], v11 offset:16176
    v_mfma_f32_16x16x32_bf16 v[168:171], v[232:235], v[56:59], v[168:171]
    s_waitcnt vmcnt(20)
    v_mov_b32_dpp v248, v88 row_shl:4 row_mask:0xf bank_mask:0x5
    v_mov_b32_dpp v248, v90 row_shr:4 row_mask:0xf bank_mask:0xa
    v_mfma_f32_16x16x32_bf16 v[184:187], v[236:239], v[56:59], v[184:187]
    v_mov_b32_dpp v249, v89 row_shl:4 row_mask:0xf bank_mask:0x5
    v_mov_b32_dpp v249, v91 row_shr:4 row_mask:0xf bank_mask:0xa
    v_mov_b32_dpp v88, v90 quad_perm:[0,1,2,3] row_mask:0xf bank_mask:0xa
    v_mfma_f32_16x16x32_bf16 v[200:203], v[240:243], v[56:59], v[200:203]
    v_mov_b32_dpp v89, v91 quad_perm:[0,1,2,3] row_mask:0xf bank_mask:0xa
    v_perm_b32 v72, v248, v88, v252
    v_mfma_f32_16x16x32_bf16 v[216:219], v[244:247], v[56:59], v[216:219]
    v_perm_b32 v76, v248, v88, v253
    v_perm_b32 v80, v249, v89, v252
    v_perm_b32 v84, v249, v89, v253
    v_mfma_f32_16x16x32_bf16 v[172:175], v[232:235], v[60:63], v[172:175]
    v_mov_b32_dpp v250, v92 row_shl:4 row_mask:0xf bank_mask:0x5
    v_mov_b32_dpp v250, v94 row_shr:4 row_mask:0xf bank_mask:0xa
    v_mfma_f32_16x16x32_bf16 v[188:191], v[236:239], v[60:63], v[188:191]
    v_mov_b32_dpp v251, v93 row_shl:4 row_mask:0xf bank_mask:0x5
    v_mov_b32_dpp v251, v95 row_shr:4 row_mask:0xf bank_mask:0xa
    v_mov_b32_dpp v92, v94 quad_perm:[0,1,2,3] row_mask:0xf bank_mask:0xa
    v_mfma_f32_16x16x32_bf16 v[204:207], v[240:243], v[60:63], v[204:207]
    v_mov_b32_dpp v93, v95 quad_perm:[0,1,2,3] row_mask:0xf bank_mask:0xa
    v_perm_b32 v73, v250, v92, v252
    v_mfma_f32_16x16x32_bf16 v[220:223], v[244:247], v[60:63], v[220:223]
    v_perm_b32 v77, v250, v92, v253
    v_perm_b32 v81, v251, v93, v252
    v_perm_b32 v85, v251, v93, v253
    v_mfma_f32_16x16x32_bf16 v[176:179], v[232:235], v[64:67], v[176:179]
    v_mov_b32_dpp v248, v96 row_shl:4 row_mask:0xf bank_mask:0x5
    v_mov_b32_dpp v248, v98 row_shr:4 row_mask:0xf bank_mask:0xa
    v_mov_b32_dpp v249, v97 row_shl:4 row_mask:0xf bank_mask:0x5
    v_mfma_f32_16x16x32_bf16 v[192:195], v[236:239], v[64:67], v[192:195]
    v_mov_b32_dpp v249, v99 row_shr:4 row_mask:0xf bank_mask:0xa
    v_mov_b32_dpp v96, v98 quad_perm:[0,1,2,3] row_mask:0xf bank_mask:0xa
    v_mfma_f32_16x16x32_bf16 v[208:211], v[240:243], v[64:67], v[208:211]
    v_mov_b32_dpp v97, v99 quad_perm:[0,1,2,3] row_mask:0xf bank_mask:0xa
    v_perm_b32 v74, v248, v96, v252
    v_perm_b32 v78, v248, v96, v253
    v_mfma_f32_16x16x32_bf16 v[224:227], v[244:247], v[64:67], v[224:227]
    v_perm_b32 v82, v249, v97, v252
    v_perm_b32 v86, v249, v97, v253
    v_mfma_f32_16x16x32_bf16 v[180:183], v[232:235], v[68:71], v[180:183]
    v_mov_b32_dpp v250, v100 row_shl:4 row_mask:0xf bank_mask:0x5
    v_mov_b32_dpp v250, v102 row_shr:4 row_mask:0xf bank_mask:0xa
    v_mov_b32_dpp v251, v101 row_shl:4 row_mask:0xf bank_mask:0x5
    v_mfma_f32_16x16x32_bf16 v[196:199], v[236:239], v[68:71], v[196:199]
    v_mov_b32_dpp v251, v103 row_shr:4 row_mask:0xf bank_mask:0xa
    v_mov_b32_dpp v100, v102 quad_perm:[0,1,2,3] row_mask:0xf bank_mask:0xa
    v_mfma_f32_16x16x32_bf16 v[212:215], v[240:243], v[68:71], v[212:215]
    v_mov_b32_dpp v101, v103 quad_perm:[0,1,2,3] row_mask:0xf bank_mask:0xa
    v_perm_b32 v75, v250, v100, v252
    v_perm_b32 v79, v250, v100, v253
    v_mfma_f32_16x16x32_bf16 v[228:231], v[244:247], v[68:71], v[228:231]
    v_perm_b32 v83, v251, v101, v252
    v_perm_b32 v87, v251, v101, v253
    buffer_load_dwordx4 v[56:59], v4, s[8:11], s20 offen
    buffer_load_dwordx4 v[60:63], v4, s[8:11], s21 offen
    buffer_load_dwordx4 v[64:67], v4, s[8:11], s22 offen
    buffer_load_dwordx4 v[68:71], v4, s[8:11], s23 offen
    s_add_u32 s20, s20, 30720
    s_add_u32 s21, s21, 30720
    s_add_u32 s22, s22, 30720
    s_add_u32 s23, s23, 30720
    s_waitcnt lgkmcnt(0)
    ds_read_b128 v[232:235], v11 offset:64
    ds_read_b128 v[236:239], v11 offset:5440
    ds_read_b128 v[240:243], v11 offset:10816
    ds_read_b128 v[244:247], v11 offset:16192
    v_mfma_f32_16x16x32_bf16 v[168:171], v[12:15], v[72:75], v[168:171]
    s_waitcnt vmcnt(20)
    v_mov_b32_dpp v248, v104 row_shl:4 row_mask:0xf bank_mask:0x5
    v_mov_b32_dpp v248, v106 row_shr:4 row_mask:0xf bank_mask:0xa
    v_mfma_f32_16x16x32_bf16 v[184:187], v[16:19], v[72:75], v[184:187]
    v_mov_b32_dpp v249, v105 row_shl:4 row_mask:0xf bank_mask:0x5
    v_mov_b32_dpp v249, v107 row_shr:4 row_mask:0xf bank_mask:0xa
    v_mov_b32_dpp v104, v106 quad_perm:[0,1,2,3] row_mask:0xf bank_mask:0xa
    v_mfma_f32_16x16x32_bf16 v[200:203], v[20:23], v[72:75], v[200:203]
    v_mov_b32_dpp v105, v107 quad_perm:[0,1,2,3] row_mask:0xf bank_mask:0xa
    v_perm_b32 v88, v248, v104, v252
    v_mfma_f32_16x16x32_bf16 v[216:219], v[24:27], v[72:75], v[216:219]
    v_perm_b32 v92, v248, v104, v253
    v_perm_b32 v96, v249, v105, v252
    v_perm_b32 v100, v249, v105, v253
    v_mfma_f32_16x16x32_bf16 v[172:175], v[12:15], v[76:79], v[172:175]
    v_mov_b32_dpp v250, v108 row_shl:4 row_mask:0xf bank_mask:0x5
    v_mov_b32_dpp v250, v110 row_shr:4 row_mask:0xf bank_mask:0xa
    v_mfma_f32_16x16x32_bf16 v[188:191], v[16:19], v[76:79], v[188:191]
    v_mov_b32_dpp v251, v109 row_shl:4 row_mask:0xf bank_mask:0x5
    v_mov_b32_dpp v251, v111 row_shr:4 row_mask:0xf bank_mask:0xa
    v_mov_b32_dpp v108, v110 quad_perm:[0,1,2,3] row_mask:0xf bank_mask:0xa
    v_mfma_f32_16x16x32_bf16 v[204:207], v[20:23], v[76:79], v[204:207]
    v_mov_b32_dpp v109, v111 quad_perm:[0,1,2,3] row_mask:0xf bank_mask:0xa
    v_perm_b32 v89, v250, v108, v252
    v_mfma_f32_16x16x32_bf16 v[220:223], v[24:27], v[76:79], v[220:223]
    v_perm_b32 v93, v250, v108, v253
    v_perm_b32 v97, v251, v109, v252
    v_perm_b32 v101, v251, v109, v253
    v_mfma_f32_16x16x32_bf16 v[176:179], v[12:15], v[80:83], v[176:179]
    v_mov_b32_dpp v248, v112 row_shl:4 row_mask:0xf bank_mask:0x5
    v_mov_b32_dpp v248, v114 row_shr:4 row_mask:0xf bank_mask:0xa
    v_mov_b32_dpp v249, v113 row_shl:4 row_mask:0xf bank_mask:0x5
    v_mfma_f32_16x16x32_bf16 v[192:195], v[16:19], v[80:83], v[192:195]
    v_mov_b32_dpp v249, v115 row_shr:4 row_mask:0xf bank_mask:0xa
    v_mov_b32_dpp v112, v114 quad_perm:[0,1,2,3] row_mask:0xf bank_mask:0xa
    v_mfma_f32_16x16x32_bf16 v[208:211], v[20:23], v[80:83], v[208:211]
    v_mov_b32_dpp v113, v115 quad_perm:[0,1,2,3] row_mask:0xf bank_mask:0xa
    v_perm_b32 v90, v248, v112, v252
    v_perm_b32 v94, v248, v112, v253
    v_mfma_f32_16x16x32_bf16 v[224:227], v[24:27], v[80:83], v[224:227]
    v_perm_b32 v98, v249, v113, v252
    v_perm_b32 v102, v249, v113, v253
    v_mfma_f32_16x16x32_bf16 v[180:183], v[12:15], v[84:87], v[180:183]
    v_mov_b32_dpp v250, v116 row_shl:4 row_mask:0xf bank_mask:0x5
    v_mov_b32_dpp v250, v118 row_shr:4 row_mask:0xf bank_mask:0xa
    v_mov_b32_dpp v251, v117 row_shl:4 row_mask:0xf bank_mask:0x5
    v_mfma_f32_16x16x32_bf16 v[196:199], v[16:19], v[84:87], v[196:199]
    v_mov_b32_dpp v251, v119 row_shr:4 row_mask:0xf bank_mask:0xa
    v_mov_b32_dpp v116, v118 quad_perm:[0,1,2,3] row_mask:0xf bank_mask:0xa
    v_mfma_f32_16x16x32_bf16 v[212:215], v[20:23], v[84:87], v[212:215]
    v_mov_b32_dpp v117, v119 quad_perm:[0,1,2,3] row_mask:0xf bank_mask:0xa
    v_perm_b32 v91, v250, v116, v252
    v_perm_b32 v95, v250, v116, v253
    v_mfma_f32_16x16x32_bf16 v[228:231], v[24:27], v[84:87], v[228:231]
    v_perm_b32 v99, v251, v117, v252
    v_perm_b32 v103, v251, v117, v253
    s_waitcnt lgkmcnt(0)
    ds_read_b128 v[12:15], v11 offset:80
    ds_read_b128 v[16:19], v11 offset:5456
    ds_read_b128 v[20:23], v11 offset:10832
    ds_read_b128 v[24:27], v11 offset:16208
    v_mfma_f32_16x16x32_bf16 v[168:171], v[232:235], v[88:91], v[168:171]
    s_waitcnt vmcnt(16)
    v_mov_b32_dpp v248, v120 row_shl:4 row_mask:0xf bank_mask:0x5
    v_mov_b32_dpp v248, v122 row_shr:4 row_mask:0xf bank_mask:0xa
    v_mfma_f32_16x16x32_bf16 v[184:187], v[236:239], v[88:91], v[184:187]
    v_mov_b32_dpp v249, v121 row_shl:4 row_mask:0xf bank_mask:0x5
    v_mov_b32_dpp v249, v123 row_shr:4 row_mask:0xf bank_mask:0xa
    v_mov_b32_dpp v120, v122 quad_perm:[0,1,2,3] row_mask:0xf bank_mask:0xa
    v_mfma_f32_16x16x32_bf16 v[200:203], v[240:243], v[88:91], v[200:203]
    v_mov_b32_dpp v121, v123 quad_perm:[0,1,2,3] row_mask:0xf bank_mask:0xa
    v_perm_b32 v104, v248, v120, v252
    v_mfma_f32_16x16x32_bf16 v[216:219], v[244:247], v[88:91], v[216:219]
    v_perm_b32 v108, v248, v120, v253
    v_perm_b32 v112, v249, v121, v252
    v_perm_b32 v116, v249, v121, v253
    v_mfma_f32_16x16x32_bf16 v[172:175], v[232:235], v[92:95], v[172:175]
    v_mov_b32_dpp v250, v124 row_shl:4 row_mask:0xf bank_mask:0x5
    v_mov_b32_dpp v250, v126 row_shr:4 row_mask:0xf bank_mask:0xa
    v_mfma_f32_16x16x32_bf16 v[188:191], v[236:239], v[92:95], v[188:191]
    v_mov_b32_dpp v251, v125 row_shl:4 row_mask:0xf bank_mask:0x5
    v_mov_b32_dpp v251, v127 row_shr:4 row_mask:0xf bank_mask:0xa
    v_mov_b32_dpp v124, v126 quad_perm:[0,1,2,3] row_mask:0xf bank_mask:0xa
    v_mfma_f32_16x16x32_bf16 v[204:207], v[240:243], v[92:95], v[204:207]
    v_mov_b32_dpp v125, v127 quad_perm:[0,1,2,3] row_mask:0xf bank_mask:0xa
    v_perm_b32 v105, v250, v124, v252
    v_mfma_f32_16x16x32_bf16 v[220:223], v[244:247], v[92:95], v[220:223]
    v_perm_b32 v109, v250, v124, v253
    v_perm_b32 v113, v251, v125, v252
    v_perm_b32 v117, v251, v125, v253
    v_mfma_f32_16x16x32_bf16 v[176:179], v[232:235], v[96:99], v[176:179]
    v_mov_b32_dpp v248, v128 row_shl:4 row_mask:0xf bank_mask:0x5
    v_mov_b32_dpp v248, v130 row_shr:4 row_mask:0xf bank_mask:0xa
    v_mov_b32_dpp v249, v129 row_shl:4 row_mask:0xf bank_mask:0x5
    v_mfma_f32_16x16x32_bf16 v[192:195], v[236:239], v[96:99], v[192:195]
    v_mov_b32_dpp v249, v131 row_shr:4 row_mask:0xf bank_mask:0xa
    v_mov_b32_dpp v128, v130 quad_perm:[0,1,2,3] row_mask:0xf bank_mask:0xa
    v_mfma_f32_16x16x32_bf16 v[208:211], v[240:243], v[96:99], v[208:211]
    v_mov_b32_dpp v129, v131 quad_perm:[0,1,2,3] row_mask:0xf bank_mask:0xa
    v_perm_b32 v106, v248, v128, v252
    v_perm_b32 v110, v248, v128, v253
    v_mfma_f32_16x16x32_bf16 v[224:227], v[244:247], v[96:99], v[224:227]
    v_perm_b32 v114, v249, v129, v252
    v_perm_b32 v118, v249, v129, v253
    v_mfma_f32_16x16x32_bf16 v[180:183], v[232:235], v[100:103], v[180:183]
    v_mov_b32_dpp v250, v132 row_shl:4 row_mask:0xf bank_mask:0x5
    v_mov_b32_dpp v250, v134 row_shr:4 row_mask:0xf bank_mask:0xa
    v_mov_b32_dpp v251, v133 row_shl:4 row_mask:0xf bank_mask:0x5
    v_mfma_f32_16x16x32_bf16 v[196:199], v[236:239], v[100:103], v[196:199]
    v_mov_b32_dpp v251, v135 row_shr:4 row_mask:0xf bank_mask:0xa
    v_mov_b32_dpp v132, v134 quad_perm:[0,1,2,3] row_mask:0xf bank_mask:0xa
    v_mfma_f32_16x16x32_bf16 v[212:215], v[240:243], v[100:103], v[212:215]
    v_mov_b32_dpp v133, v135 quad_perm:[0,1,2,3] row_mask:0xf bank_mask:0xa
    v_perm_b32 v107, v250, v132, v252
    v_perm_b32 v111, v250, v132, v253
    v_mfma_f32_16x16x32_bf16 v[228:231], v[244:247], v[100:103], v[228:231]
    v_perm_b32 v115, v251, v133, v252
    v_perm_b32 v119, v251, v133, v253
    s_waitcnt lgkmcnt(0)
    ds_read_b128 v[232:235], v11 offset:96
    ds_read_b128 v[236:239], v11 offset:5472
    ds_read_b128 v[240:243], v11 offset:10848
    ds_read_b128 v[244:247], v11 offset:16224
    v_mfma_f32_16x16x32_bf16 v[168:171], v[12:15], v[104:107], v[168:171]
    s_waitcnt vmcnt(12)
    v_mov_b32_dpp v248, v136 row_shl:4 row_mask:0xf bank_mask:0x5
    v_mov_b32_dpp v248, v138 row_shr:4 row_mask:0xf bank_mask:0xa
    v_mfma_f32_16x16x32_bf16 v[184:187], v[16:19], v[104:107], v[184:187]
    v_mov_b32_dpp v249, v137 row_shl:4 row_mask:0xf bank_mask:0x5
    v_mov_b32_dpp v249, v139 row_shr:4 row_mask:0xf bank_mask:0xa
    v_mov_b32_dpp v136, v138 quad_perm:[0,1,2,3] row_mask:0xf bank_mask:0xa
    v_mfma_f32_16x16x32_bf16 v[200:203], v[20:23], v[104:107], v[200:203]
    v_mov_b32_dpp v137, v139 quad_perm:[0,1,2,3] row_mask:0xf bank_mask:0xa
    v_perm_b32 v120, v248, v136, v252
    v_mfma_f32_16x16x32_bf16 v[216:219], v[24:27], v[104:107], v[216:219]
    v_perm_b32 v124, v248, v136, v253
    v_perm_b32 v128, v249, v137, v252
    v_perm_b32 v132, v249, v137, v253
    v_mfma_f32_16x16x32_bf16 v[172:175], v[12:15], v[108:111], v[172:175]
    v_mov_b32_dpp v250, v140 row_shl:4 row_mask:0xf bank_mask:0x5
    v_mov_b32_dpp v250, v142 row_shr:4 row_mask:0xf bank_mask:0xa
    v_mfma_f32_16x16x32_bf16 v[188:191], v[16:19], v[108:111], v[188:191]
    v_mov_b32_dpp v251, v141 row_shl:4 row_mask:0xf bank_mask:0x5
    v_mov_b32_dpp v251, v143 row_shr:4 row_mask:0xf bank_mask:0xa
    v_mov_b32_dpp v140, v142 quad_perm:[0,1,2,3] row_mask:0xf bank_mask:0xa
    v_mfma_f32_16x16x32_bf16 v[204:207], v[20:23], v[108:111], v[204:207]
    v_mov_b32_dpp v141, v143 quad_perm:[0,1,2,3] row_mask:0xf bank_mask:0xa
    v_perm_b32 v121, v250, v140, v252
    v_mfma_f32_16x16x32_bf16 v[220:223], v[24:27], v[108:111], v[220:223]
    v_perm_b32 v125, v250, v140, v253
    v_perm_b32 v129, v251, v141, v252
    v_perm_b32 v133, v251, v141, v253
    v_mfma_f32_16x16x32_bf16 v[176:179], v[12:15], v[112:115], v[176:179]
    v_mov_b32_dpp v248, v144 row_shl:4 row_mask:0xf bank_mask:0x5
    v_mov_b32_dpp v248, v146 row_shr:4 row_mask:0xf bank_mask:0xa
    v_mov_b32_dpp v249, v145 row_shl:4 row_mask:0xf bank_mask:0x5
    v_mfma_f32_16x16x32_bf16 v[192:195], v[16:19], v[112:115], v[192:195]
    v_mov_b32_dpp v249, v147 row_shr:4 row_mask:0xf bank_mask:0xa
    v_mov_b32_dpp v144, v146 quad_perm:[0,1,2,3] row_mask:0xf bank_mask:0xa
    v_mfma_f32_16x16x32_bf16 v[208:211], v[20:23], v[112:115], v[208:211]
    v_mov_b32_dpp v145, v147 quad_perm:[0,1,2,3] row_mask:0xf bank_mask:0xa
    v_perm_b32 v122, v248, v144, v252
    v_perm_b32 v126, v248, v144, v253
    v_mfma_f32_16x16x32_bf16 v[224:227], v[24:27], v[112:115], v[224:227]
    v_perm_b32 v130, v249, v145, v252
    v_perm_b32 v134, v249, v145, v253
    v_mfma_f32_16x16x32_bf16 v[180:183], v[12:15], v[116:119], v[180:183]
    v_mov_b32_dpp v250, v148 row_shl:4 row_mask:0xf bank_mask:0x5
    v_mov_b32_dpp v250, v150 row_shr:4 row_mask:0xf bank_mask:0xa
    v_mov_b32_dpp v251, v149 row_shl:4 row_mask:0xf bank_mask:0x5
    v_mfma_f32_16x16x32_bf16 v[196:199], v[16:19], v[116:119], v[196:199]
    v_mov_b32_dpp v251, v151 row_shr:4 row_mask:0xf bank_mask:0xa
    v_mov_b32_dpp v148, v150 quad_perm:[0,1,2,3] row_mask:0xf bank_mask:0xa
    v_mfma_f32_16x16x32_bf16 v[212:215], v[20:23], v[116:119], v[212:215]
    v_mov_b32_dpp v149, v151 quad_perm:[0,1,2,3] row_mask:0xf bank_mask:0xa
    v_perm_b32 v123, v250, v148, v252
    v_perm_b32 v127, v250, v148, v253
    v_mfma_f32_16x16x32_bf16 v[228:231], v[24:27], v[116:119], v[228:231]
    v_perm_b32 v131, v251, v149, v252
    v_perm_b32 v135, v251, v149, v253
    s_waitcnt lgkmcnt(0)
    ds_read_b128 v[12:15], v11 offset:112
    ds_read_b128 v[16:19], v11 offset:5488
    ds_read_b128 v[20:23], v11 offset:10864
    ds_read_b128 v[24:27], v11 offset:16240
    v_mfma_f32_16x16x32_bf16 v[168:171], v[232:235], v[120:123], v[168:171]
    s_waitcnt vmcnt(8)
    v_mov_b32_dpp v248, v152 row_shl:4 row_mask:0xf bank_mask:0x5
    v_mov_b32_dpp v248, v154 row_shr:4 row_mask:0xf bank_mask:0xa
    v_mfma_f32_16x16x32_bf16 v[184:187], v[236:239], v[120:123], v[184:187]
    v_mov_b32_dpp v249, v153 row_shl:4 row_mask:0xf bank_mask:0x5
    v_mov_b32_dpp v249, v155 row_shr:4 row_mask:0xf bank_mask:0xa
    v_mov_b32_dpp v152, v154 quad_perm:[0,1,2,3] row_mask:0xf bank_mask:0xa
    v_mfma_f32_16x16x32_bf16 v[200:203], v[240:243], v[120:123], v[200:203]
    v_mov_b32_dpp v153, v155 quad_perm:[0,1,2,3] row_mask:0xf bank_mask:0xa
    v_perm_b32 v136, v248, v152, v252
    v_mfma_f32_16x16x32_bf16 v[216:219], v[244:247], v[120:123], v[216:219]
    v_perm_b32 v140, v248, v152, v253
    v_perm_b32 v144, v249, v153, v252
    v_perm_b32 v148, v249, v153, v253
    v_mfma_f32_16x16x32_bf16 v[172:175], v[232:235], v[124:127], v[172:175]
    v_mov_b32_dpp v250, v156 row_shl:4 row_mask:0xf bank_mask:0x5
    v_mov_b32_dpp v250, v158 row_shr:4 row_mask:0xf bank_mask:0xa
    v_mfma_f32_16x16x32_bf16 v[188:191], v[236:239], v[124:127], v[188:191]
    v_mov_b32_dpp v251, v157 row_shl:4 row_mask:0xf bank_mask:0x5
    v_mov_b32_dpp v251, v159 row_shr:4 row_mask:0xf bank_mask:0xa
    v_mov_b32_dpp v156, v158 quad_perm:[0,1,2,3] row_mask:0xf bank_mask:0xa
    v_mfma_f32_16x16x32_bf16 v[204:207], v[240:243], v[124:127], v[204:207]
    v_mov_b32_dpp v157, v159 quad_perm:[0,1,2,3] row_mask:0xf bank_mask:0xa
    v_perm_b32 v137, v250, v156, v252
    v_mfma_f32_16x16x32_bf16 v[220:223], v[244:247], v[124:127], v[220:223]
    v_perm_b32 v141, v250, v156, v253
    v_perm_b32 v145, v251, v157, v252
    v_perm_b32 v149, v251, v157, v253
    v_mfma_f32_16x16x32_bf16 v[176:179], v[232:235], v[128:131], v[176:179]
    v_mov_b32_dpp v248, v160 row_shl:4 row_mask:0xf bank_mask:0x5
    v_mov_b32_dpp v248, v162 row_shr:4 row_mask:0xf bank_mask:0xa
    v_mov_b32_dpp v249, v161 row_shl:4 row_mask:0xf bank_mask:0x5
    v_mfma_f32_16x16x32_bf16 v[192:195], v[236:239], v[128:131], v[192:195]
    v_mov_b32_dpp v249, v163 row_shr:4 row_mask:0xf bank_mask:0xa
    v_mov_b32_dpp v160, v162 quad_perm:[0,1,2,3] row_mask:0xf bank_mask:0xa
    v_mfma_f32_16x16x32_bf16 v[208:211], v[240:243], v[128:131], v[208:211]
    v_mov_b32_dpp v161, v163 quad_perm:[0,1,2,3] row_mask:0xf bank_mask:0xa
    v_perm_b32 v138, v248, v160, v252
    v_perm_b32 v142, v248, v160, v253
    v_mfma_f32_16x16x32_bf16 v[224:227], v[244:247], v[128:131], v[224:227]
    v_perm_b32 v146, v249, v161, v252
    v_perm_b32 v150, v249, v161, v253
    v_mfma_f32_16x16x32_bf16 v[180:183], v[232:235], v[132:135], v[180:183]
    v_mov_b32_dpp v250, v164 row_shl:4 row_mask:0xf bank_mask:0x5
    v_mov_b32_dpp v250, v166 row_shr:4 row_mask:0xf bank_mask:0xa
    v_mov_b32_dpp v251, v165 row_shl:4 row_mask:0xf bank_mask:0x5
    v_mfma_f32_16x16x32_bf16 v[196:199], v[236:239], v[132:135], v[196:199]
    v_mov_b32_dpp v251, v167 row_shr:4 row_mask:0xf bank_mask:0xa
    v_mov_b32_dpp v164, v166 quad_perm:[0,1,2,3] row_mask:0xf bank_mask:0xa
    v_mfma_f32_16x16x32_bf16 v[212:215], v[240:243], v[132:135], v[212:215]
    v_mov_b32_dpp v165, v167 quad_perm:[0,1,2,3] row_mask:0xf bank_mask:0xa
    v_perm_b32 v139, v250, v164, v252
    v_perm_b32 v143, v250, v164, v253
    v_mfma_f32_16x16x32_bf16 v[228:231], v[244:247], v[132:135], v[228:231]
    v_perm_b32 v147, v251, v165, v252
    v_perm_b32 v151, v251, v165, v253
    s_waitcnt lgkmcnt(0)
    ds_read_b128 v[232:235], v11 offset:128
    ds_read_b128 v[236:239], v11 offset:5504
    ds_read_b128 v[240:243], v11 offset:10880
    ds_read_b128 v[244:247], v11 offset:16256
    v_mfma_f32_16x16x32_bf16 v[168:171], v[12:15], v[136:139], v[168:171]
    s_waitcnt vmcnt(4)
    v_mov_b32_dpp v248, v40 row_shl:4 row_mask:0xf bank_mask:0x5
    v_mov_b32_dpp v248, v42 row_shr:4 row_mask:0xf bank_mask:0xa
    v_mfma_f32_16x16x32_bf16 v[184:187], v[16:19], v[136:139], v[184:187]
    v_mov_b32_dpp v249, v41 row_shl:4 row_mask:0xf bank_mask:0x5
    v_mov_b32_dpp v249, v43 row_shr:4 row_mask:0xf bank_mask:0xa
    v_mov_b32_dpp v40, v42 quad_perm:[0,1,2,3] row_mask:0xf bank_mask:0xa
    v_mfma_f32_16x16x32_bf16 v[200:203], v[20:23], v[136:139], v[200:203]
    v_mov_b32_dpp v41, v43 quad_perm:[0,1,2,3] row_mask:0xf bank_mask:0xa
    v_perm_b32 v152, v248, v40, v252
    v_mfma_f32_16x16x32_bf16 v[216:219], v[24:27], v[136:139], v[216:219]
    v_perm_b32 v156, v248, v40, v253
    v_perm_b32 v160, v249, v41, v252
    v_perm_b32 v164, v249, v41, v253
    v_mfma_f32_16x16x32_bf16 v[172:175], v[12:15], v[140:143], v[172:175]
    v_mov_b32_dpp v250, v44 row_shl:4 row_mask:0xf bank_mask:0x5
    v_mov_b32_dpp v250, v46 row_shr:4 row_mask:0xf bank_mask:0xa
    v_mfma_f32_16x16x32_bf16 v[188:191], v[16:19], v[140:143], v[188:191]
    v_mov_b32_dpp v251, v45 row_shl:4 row_mask:0xf bank_mask:0x5
    v_mov_b32_dpp v251, v47 row_shr:4 row_mask:0xf bank_mask:0xa
    v_mov_b32_dpp v44, v46 quad_perm:[0,1,2,3] row_mask:0xf bank_mask:0xa
    v_mfma_f32_16x16x32_bf16 v[204:207], v[20:23], v[140:143], v[204:207]
    v_mov_b32_dpp v45, v47 quad_perm:[0,1,2,3] row_mask:0xf bank_mask:0xa
    v_perm_b32 v153, v250, v44, v252
    v_mfma_f32_16x16x32_bf16 v[220:223], v[24:27], v[140:143], v[220:223]
    v_perm_b32 v157, v250, v44, v253
    v_perm_b32 v161, v251, v45, v252
    v_perm_b32 v165, v251, v45, v253
    v_mfma_f32_16x16x32_bf16 v[176:179], v[12:15], v[144:147], v[176:179]
    v_mov_b32_dpp v248, v48 row_shl:4 row_mask:0xf bank_mask:0x5
    v_mov_b32_dpp v248, v50 row_shr:4 row_mask:0xf bank_mask:0xa
    v_mov_b32_dpp v249, v49 row_shl:4 row_mask:0xf bank_mask:0x5
    v_mfma_f32_16x16x32_bf16 v[192:195], v[16:19], v[144:147], v[192:195]
    v_mov_b32_dpp v249, v51 row_shr:4 row_mask:0xf bank_mask:0xa
    v_mov_b32_dpp v48, v50 quad_perm:[0,1,2,3] row_mask:0xf bank_mask:0xa
    v_mfma_f32_16x16x32_bf16 v[208:211], v[20:23], v[144:147], v[208:211]
    v_mov_b32_dpp v49, v51 quad_perm:[0,1,2,3] row_mask:0xf bank_mask:0xa
    v_perm_b32 v154, v248, v48, v252
    v_perm_b32 v158, v248, v48, v253
    v_mfma_f32_16x16x32_bf16 v[224:227], v[24:27], v[144:147], v[224:227]
    v_perm_b32 v162, v249, v49, v252
    v_perm_b32 v166, v249, v49, v253
    v_mfma_f32_16x16x32_bf16 v[180:183], v[12:15], v[148:151], v[180:183]
    v_mov_b32_dpp v250, v52 row_shl:4 row_mask:0xf bank_mask:0x5
    v_mov_b32_dpp v250, v54 row_shr:4 row_mask:0xf bank_mask:0xa
    v_mov_b32_dpp v251, v53 row_shl:4 row_mask:0xf bank_mask:0x5
    v_mfma_f32_16x16x32_bf16 v[196:199], v[16:19], v[148:151], v[196:199]
    v_mov_b32_dpp v251, v55 row_shr:4 row_mask:0xf bank_mask:0xa
    v_mov_b32_dpp v52, v54 quad_perm:[0,1,2,3] row_mask:0xf bank_mask:0xa
    v_mfma_f32_16x16x32_bf16 v[212:215], v[20:23], v[148:151], v[212:215]
    v_mov_b32_dpp v53, v55 quad_perm:[0,1,2,3] row_mask:0xf bank_mask:0xa
    v_perm_b32 v155, v250, v52, v252
    v_perm_b32 v159, v250, v52, v253
    v_mfma_f32_16x16x32_bf16 v[228:231], v[24:27], v[148:151], v[228:231]
    v_perm_b32 v163, v251, v53, v252
    v_perm_b32 v167, v251, v53, v253
    s_waitcnt lgkmcnt(0)
    ds_read_b128 v[12:15], v11 offset:144
    ds_read_b128 v[16:19], v11 offset:5520
    ds_read_b128 v[20:23], v11 offset:10896
    ds_read_b128 v[24:27], v11 offset:16272
    v_mfma_f32_16x16x32_bf16 v[168:171], v[232:235], v[152:155], v[168:171]
    s_waitcnt vmcnt(0)
    v_mov_b32_dpp v248, v56 row_shl:4 row_mask:0xf bank_mask:0x5
    v_mov_b32_dpp v248, v58 row_shr:4 row_mask:0xf bank_mask:0xa
    v_mfma_f32_16x16x32_bf16 v[184:187], v[236:239], v[152:155], v[184:187]
    v_mov_b32_dpp v249, v57 row_shl:4 row_mask:0xf bank_mask:0x5
    v_mov_b32_dpp v249, v59 row_shr:4 row_mask:0xf bank_mask:0xa
    v_mov_b32_dpp v56, v58 quad_perm:[0,1,2,3] row_mask:0xf bank_mask:0xa
    v_mfma_f32_16x16x32_bf16 v[200:203], v[240:243], v[152:155], v[200:203]
    v_mov_b32_dpp v57, v59 quad_perm:[0,1,2,3] row_mask:0xf bank_mask:0xa
    v_perm_b32 v40, v248, v56, v252
    v_mfma_f32_16x16x32_bf16 v[216:219], v[244:247], v[152:155], v[216:219]
    v_perm_b32 v44, v248, v56, v253
    v_perm_b32 v48, v249, v57, v252
    v_perm_b32 v52, v249, v57, v253
    v_mfma_f32_16x16x32_bf16 v[172:175], v[232:235], v[156:159], v[172:175]
    v_mov_b32_dpp v250, v60 row_shl:4 row_mask:0xf bank_mask:0x5
    v_mov_b32_dpp v250, v62 row_shr:4 row_mask:0xf bank_mask:0xa
    v_mfma_f32_16x16x32_bf16 v[188:191], v[236:239], v[156:159], v[188:191]
    v_mov_b32_dpp v251, v61 row_shl:4 row_mask:0xf bank_mask:0x5
    v_mov_b32_dpp v251, v63 row_shr:4 row_mask:0xf bank_mask:0xa
    v_mov_b32_dpp v60, v62 quad_perm:[0,1,2,3] row_mask:0xf bank_mask:0xa
    v_mfma_f32_16x16x32_bf16 v[204:207], v[240:243], v[156:159], v[204:207]
    v_mov_b32_dpp v61, v63 quad_perm:[0,1,2,3] row_mask:0xf bank_mask:0xa
    v_perm_b32 v41, v250, v60, v252
    v_mfma_f32_16x16x32_bf16 v[220:223], v[244:247], v[156:159], v[220:223]
    v_perm_b32 v45, v250, v60, v253
    v_perm_b32 v49, v251, v61, v252
    v_perm_b32 v53, v251, v61, v253
    v_mfma_f32_16x16x32_bf16 v[176:179], v[232:235], v[160:163], v[176:179]
    v_mov_b32_dpp v248, v64 row_shl:4 row_mask:0xf bank_mask:0x5
    v_mov_b32_dpp v248, v66 row_shr:4 row_mask:0xf bank_mask:0xa
    v_mov_b32_dpp v249, v65 row_shl:4 row_mask:0xf bank_mask:0x5
    v_mfma_f32_16x16x32_bf16 v[192:195], v[236:239], v[160:163], v[192:195]
    v_mov_b32_dpp v249, v67 row_shr:4 row_mask:0xf bank_mask:0xa
    v_mov_b32_dpp v64, v66 quad_perm:[0,1,2,3] row_mask:0xf bank_mask:0xa
    v_mfma_f32_16x16x32_bf16 v[208:211], v[240:243], v[160:163], v[208:211]
    v_mov_b32_dpp v65, v67 quad_perm:[0,1,2,3] row_mask:0xf bank_mask:0xa
    v_perm_b32 v42, v248, v64, v252
    v_perm_b32 v46, v248, v64, v253
    v_mfma_f32_16x16x32_bf16 v[224:227], v[244:247], v[160:163], v[224:227]
    v_perm_b32 v50, v249, v65, v252
    v_perm_b32 v54, v249, v65, v253
    v_mfma_f32_16x16x32_bf16 v[180:183], v[232:235], v[164:167], v[180:183]
    v_mov_b32_dpp v250, v68 row_shl:4 row_mask:0xf bank_mask:0x5
    v_mov_b32_dpp v250, v70 row_shr:4 row_mask:0xf bank_mask:0xa
    v_mov_b32_dpp v251, v69 row_shl:4 row_mask:0xf bank_mask:0x5
    v_mfma_f32_16x16x32_bf16 v[196:199], v[236:239], v[164:167], v[196:199]
    v_mov_b32_dpp v251, v71 row_shr:4 row_mask:0xf bank_mask:0xa
    v_mov_b32_dpp v68, v70 quad_perm:[0,1,2,3] row_mask:0xf bank_mask:0xa
    v_mfma_f32_16x16x32_bf16 v[212:215], v[240:243], v[164:167], v[212:215]
    v_mov_b32_dpp v69, v71 quad_perm:[0,1,2,3] row_mask:0xf bank_mask:0xa
    v_perm_b32 v43, v250, v68, v252
    v_perm_b32 v47, v250, v68, v253
    v_mfma_f32_16x16x32_bf16 v[228:231], v[244:247], v[164:167], v[228:231]
    v_perm_b32 v51, v251, v69, v252
    v_perm_b32 v55, v251, v69, v253
    s_waitcnt lgkmcnt(0)
    v_mfma_f32_16x16x32_bf16 v[168:171], v[12:15], v[40:43], v[168:171]
    v_mfma_f32_16x16x32_bf16 v[184:187], v[16:19], v[40:43], v[184:187]
    v_mfma_f32_16x16x32_bf16 v[200:203], v[20:23], v[40:43], v[200:203]
    v_mfma_f32_16x16x32_bf16 v[216:219], v[24:27], v[40:43], v[216:219]
    v_mfma_f32_16x16x32_bf16 v[172:175], v[12:15], v[44:47], v[172:175]
    v_mfma_f32_16x16x32_bf16 v[188:191], v[16:19], v[44:47], v[188:191]
    v_mfma_f32_16x16x32_bf16 v[204:207], v[20:23], v[44:47], v[204:207]
    v_mfma_f32_16x16x32_bf16 v[220:223], v[24:27], v[44:47], v[220:223]
    v_mfma_f32_16x16x32_bf16 v[176:179], v[12:15], v[48:51], v[176:179]
    v_mfma_f32_16x16x32_bf16 v[192:195], v[16:19], v[48:51], v[192:195]
    v_mfma_f32_16x16x32_bf16 v[208:211], v[20:23], v[48:51], v[208:211]
    v_mfma_f32_16x16x32_bf16 v[224:227], v[24:27], v[48:51], v[224:227]
    v_mfma_f32_16x16x32_bf16 v[180:183], v[12:15], v[52:55], v[180:183]
    v_mfma_f32_16x16x32_bf16 v[196:199], v[16:19], v[52:55], v[196:199]
    v_mfma_f32_16x16x32_bf16 v[212:215], v[20:23], v[52:55], v[212:215]
    v_mfma_f32_16x16x32_bf16 v[228:231], v[24:27], v[52:55], v[228:231]
LK1_g2V:
    s_lshl_b32 s28, s18, 13
    s_add_u32 s28, s28, 86528
    s_xor_b32 s29, s18, 4
    s_lshl_b32 s29, s29, 13
    s_add_u32 s29, s29, 86528
    v_lshl_add_u32 v28, v1, 4, s28
    v_lshl_add_u32 v29, v1, 4, s29
    s_nop 7
    s_cmp_eq_u32 s41, 0
    s_cbranch_scc0 LK1_upV
    ds_write_b128 v28, v[200:203] offset:0
    ds_write_b128 v28, v[204:207] offset:1024
    ds_write_b128 v28, v[208:211] offset:2048
    ds_write_b128 v28, v[212:215] offset:3072
    ds_write_b128 v28, v[216:219] offset:4096
    ds_write_b128 v28, v[220:223] offset:5120
    ds_write_b128 v28, v[224:227] offset:6144
    ds_write_b128 v28, v[228:231] offset:7168
    s_branch LK1_xV
LK1_upV:
    ds_write_b128 v28, v[168:171] offset:0
    ds_write_b128 v28, v[172:175] offset:1024
    ds_write_b128 v28, v[176:179] offset:2048
    ds_write_b128 v28, v[180:183] offset:3072
    ds_write_b128 v28, v[184:187] offset:4096
    ds_write_b128 v28, v[188:191] offset:5120
    ds_write_b128 v28, v[192:195] offset:6144
    ds_write_b128 v28, v[196:199] offset:7168
    s_waitcnt lgkmcnt(0)
    v_mov_b32 v168, v200
    v_mov_b32 v169, v201
    v_mov_b32 v170, v202
    v_mov_b32 v171, v203
    v_mov_b32 v172, v204
    v_mov_b32 v173, v205
    v_mov_b32 v174, v206
    v_mov_b32 v175, v207
    v_mov_b32 v176, v208
    v_mov_b32 v177, v209
    v_mov_b32 v178, v210
    v_mov_b32 v179, v211
    v_mov_b32 v180, v212
    v_mov_b32 v181, v213
    v_mov_b32 v182, v214
    v_mov_b32 v183, v215
    v_mov_b32 v184, v216
    v_mov_b32 v185, v217
    v_mov_b32 v186, v218
    v_mov_b32 v187, v219
    v_mov_b32 v188, v220
    v_mov_b32 v189, v221
    v_mov_b32 v190, v222
    v_mov_b32 v191, v223
    v_mov_b32 v192, v224
    v_mov_b32 v193, v225
    v_mov_b32 v194, v226
    v_mov_b32 v195, v227
    v_mov_b32 v196, v228
    v_mov_b32 v197, v229
    v_mov_b32 v198, v230
    v_mov_b32 v199, v231
LK1_xV:
    s_waitcnt lgkmcnt(0)
    s_barrier
    ds_read_b128 v[200:203], v29 offset:0
    ds_read_b128 v[204:207], v29 offset:1024
    ds_read_b128 v[208:211], v29 offset:2048
    ds_read_b128 v[212:215], v29 offset:3072
    ds_read_b128 v[216:219], v29 offset:4096
    ds_read_b128 v[220:223], v29 offset:5120
    ds_read_b128 v[224:227], v29 offset:6144
    ds_read_b128 v[228:231], v29 offset:7168
    s_lshl_b32 s28, s41, 7
    v_lshl_add_u32 v28, v3, 4, s28
    ds_read_b128 v[56:59], v28 offset:0
    ds_read_b128 v[60:63], v28 offset:64
    s_sub_u32 s28, s19, 20
    s_lshl_b32 s28, s28, 4
    v_lshrrev_b32 v28, 3, v2
    v_lshl_add_u32 v28, v28, 3, s28
    v_and_b32 v29, 3, v2
    v_lshl_add_u32 v28, v29, 1, v28
    v_bfe_u32 v29, v2, 2, 1
    v_add_u32 v28, v28, v29
    v_mul_u32_u24 v30, 205, v28
    v_lshrrev_b32 v30, 10, v30
    v_mul_u32_u24 v31, 5, v30
    v_sub_u32 v31, v28, v31
    s_mov_b32 s29, 163840
    v_mul_lo_u32 v30, v30, s29
    v_lshl_add_u32 v30, v31, 6, v30
    v_and_b32 v32, 1, v3
    v_mul_u32_u24 v32, 320, v32
    v_add_u32 v30, v30, v32
    v_lshrrev_b32 v32, 1, v3
    v_lshl_add_u32 v30, v32, 4, v30
    s_lshl_b32 s28, s16, 1
    s_add_u32 s28, s28, s41
    s_mul_i32 s28, s28, 2560
    s_add_u32 s28, s28, 1280
    s_waitcnt lgkmcnt(0)
    v_add_f32 v168, v168, v200
    v_add_f32 v169, v169, v201
    v_add_f32 v170, v170, v202
    v_add_f32 v171, v171, v203
    v_add_f32 v172, v172, v204
    v_add_f32 v173, v173, v205
    v_add_f32 v174, v174, v206
    v_add_f32 v175, v175, v207
    v_add_f32 v176, v176, v208
    v_add_f32 v177, v177, v209
    v_add_f32 v178, v178, v210
    v_add_f32 v179, v179, v211
    v_add_f32 v180, v180, v212
    v_add_f32 v181, v181, v213
    v_add_f32 v182, v182, v214
    v_add_f32 v183, v183, v215
    v_add_f32 v184, v184, v216
    v_add_f32 v185, v185, v217
    v_add_f32 v186, v186, v218
    v_add_f32 v187, v187, v219
    v_add_f32 v188, v188, v220
    v_add_f32 v189, v189, v221
    v_add_f32 v190, v190, v222
    v_add_f32 v191, v191, v223
    v_add_f32 v192, v192, v224
    v_add_f32 v193, v193, v225
    v_add_f32 v194, v194, v226
    v_add_f32 v195, v195, v227
    v_add_f32 v196, v196, v228
    v_add_f32 v197, v197, v229
    v_add_f32 v198, v198, v230
    v_add_f32 v199, v199, v231
    v_mul_f32 v168, v168, v56
    v_mul_f32 v169, v169, v57
    v_mul_f32 v170, v170, v58
    v_mul_f32 v171, v171, v59
    v_cvt_pk_bf16_f32 v40, v168, v169
    v_cvt_pk_bf16_f32 v41, v170, v171
    v_mul_f32 v172, v172, v56
    v_mul_f32 v173, v173, v57
    v_mul_f32 v174, v174, v58
    v_mul_f32 v175, v175, v59
    v_cvt_pk_bf16_f32 v42, v172, v173
    v_cvt_pk_bf16_f32 v43, v174, v175
    v_mul_f32 v176, v176, v56
    v_mul_f32 v177, v177, v57
    v_mul_f32 v178, v178, v58
    v_mul_f32 v179, v179, v59
    v_cvt_pk_bf16_f32 v44, v176, v177
    v_cvt_pk_bf16_f32 v45, v178, v179
    v_mul_f32 v180, v180, v56
    v_mul_f32 v181, v181, v57
    v_mul_f32 v182, v182, v58
    v_mul_f32 v183, v183, v59
    v_cvt_pk_bf16_f32 v46, v180, v181
    v_cvt_pk_bf16_f32 v47, v182, v183
    v_permlane32_swap_b32 v40, v42
    v_permlane32_swap_b32 v41, v43
    buffer_store_dwordx4 v[40:43], v30, s[12:15], s28 offen offset:0
    v_permlane32_swap_b32 v44, v46
    v_permlane32_swap_b32 v45, v47
    buffer_store_dwordx4 v[44:47], v30, s[12:15], s28 offen offset:32
    v_mul_f32 v184, v184, v60
    v_mul_f32 v185, v185, v61
    v_mul_f32 v186, v186, v62
    v_mul_f32 v187, v187, v63
    v_cvt_pk_bf16_f32 v48, v184, v185
    v_cvt_pk_bf16_f32 v49, v186, v187
    v_mul_f32 v188, v188, v60
    v_mul_f32 v189, v189, v61
    v_mul_f32 v190, v190, v62
    v_mul_f32 v191, v191, v63
    v_cvt_pk_bf16_f32 v50, v188, v189
    v_cvt_pk_bf16_f32 v51, v190, v191
    v_mul_f32 v192, v192, v60
    v_mul_f32 v193, v193, v61
    v_mul_f32 v194, v194, v62
    v_mul_f32 v195, v195, v63
    v_cvt_pk_bf16_f32 v52, v192, v193
    v_cvt_pk_bf16_f32 v53, v194, v195
    v_mul_f32 v196, v196, v60
    v_mul_f32 v197, v197, v61
    v_mul_f32 v198, v198, v62
    v_mul_f32 v199, v199, v63
    v_cvt_pk_bf16_f32 v54, v196, v197
    v_cvt_pk_bf16_f32 v55, v198, v199
    v_permlane32_swap_b32 v48, v50
    v_permlane32_swap_b32 v49, v51
    buffer_store_dwordx4 v[48:51], v30, s[12:15], s28 offen offset:640
    v_permlane32_swap_b32 v52, v54
    v_permlane32_swap_b32 v53, v55
    buffer_store_dwordx4 v[52:55], v30, s[12:15], s28 offen offset:672
    s_endpgm
LK1_xn:
    s_waitcnt vmcnt(0)
    v_lshlrev_b32 v28, 4, v2
    buffer_load_dwordx4 v[60:63], v28, s[36:39], 0 offen offset:0
    buffer_load_dwordx4 v[64:67], v28, s[36:39], 0 offen offset:256
    buffer_load_dwordx4 v[68:71], v28, s[36:39], 0 offen offset:512
    buffer_load_dwordx4 v[72:75], v28, s[36:39], 0 offen offset:768
    buffer_load_dwordx4 v[76:79], v28, s[36:39], 0 offen offset:1024
    s_sub_u32 s28, s19, 30
    s_lshl_b32 s28, s28, 1
    s_add_u32 s28, s28, s41
    s_mov_b32 s60, s48
    s_mov_b32 s61, s49
    s_mov_b32 s62, 819200
    s_mov_b32 s63, 0x00020000
    s_lshl_b32 s43, s16, 2
    s_add_u32 s43, s43, s28
    v_mul_u32_u24 v128, 10240, v3
    v_lshl_add_u32 v128, v2, 1, v128
    v_lshlrev_b32 v129, 4, v1
    s_add_u32 s20, s43, 0
    s_min_u32 s20, s20, 799
    s_mul_i32 s21, s20, 52429
    s_lshr_b32 s21, s21, 18
    s_mul_i32 s22, s21, 5
    s_sub_u32 s22, s20, s22
    s_mul_i32 s23, s21, 52429
    s_lshr_b32 s23, s23, 18
    s_mul_i32 s42, s23, 5
    s_sub_u32 s21, s21, s42
    s_and_b32 s42, s23, 3
    s_lshr_b32 s23, s23, 2
    s_mul_i32 s42, s42, 204800
    s_mul_i32 s21, s21, 40960
    s_add_u32 s42, s42, s21
    s_mul_i32 s23, s23, 160
    s_add_u32 s42, s42, s23
    s_lshl_b32 s22, s22, 5
    s_add_u32 s42, s42, s22
    s_add_u32 s23, s42, 5120
    buffer_load_ushort v132, v128, s[60:63], s42 offen offset:0
    buffer_load_ushort v133, v128, s[60:63], s42 offen offset:1280
    buffer_load_ushort v134, v128, s[60:63], s42 offen offset:2560
    buffer_load_ushort v135, v128, s[60:63], s42 offen offset:3840
    buffer_load_ushort v136, v128, s[60:63], s23 offen offset:0
    buffer_load_ushort v137, v128, s[60:63], s23 offen offset:1280
    buffer_load_ushort v138, v128, s[60:63], s23 offen offset:2560
    buffer_load_ushort v139, v128, s[60:63], s23 offen offset:3840
    s_lshl_b32 s84, s20, 10
    s_add_u32 s84, s84, 13631488
    s_add_u32 s20, s43, 128
    s_min_u32 s20, s20, 799
    s_mul_i32 s21, s20, 52429
    s_lshr_b32 s21, s21, 18
    s_mul_i32 s22, s21, 5
    s_sub_u32 s22, s20, s22
    s_mul_i32 s23, s21, 52429
    s_lshr_b32 s23, s23, 18
    s_mul_i32 s42, s23, 5
    s_sub_u32 s21, s21, s42
    s_and_b32 s42, s23, 3
    s_lshr_b32 s23, s23, 2
    s_mul_i32 s42, s42, 204800
    s_mul_i32 s21, s21, 40960
    s_add_u32 s42, s42, s21
    s_mul_i32 s23, s23, 160
    s_add_u32 s42, s42, s23
    s_lshl_b32 s22, s22, 5
    s_add_u32 s42, s42, s22
    s_add_u32 s23, s42, 5120
    buffer_load_ushort v140, v128, s[60:63], s42 offen offset:0
    buffer_load_ushort v141, v128, s[60:63], s42 offen offset:1280
    buffer_load_ushort v142, v128, s[60:63], s42 offen offset:2560
    buffer_load_ushort v143, v128, s[60:63], s42 offen offset:3840
    buffer_load_ushort v144, v128, s[60:63], s23 offen offset:0
    buffer_load_ushort v145, v128, s[60:63], s23 offen offset:1280
    buffer_load_ushort v146, v128, s[60:63], s23 offen offset:2560
    buffer_load_ushort v147, v128, s[60:63], s23 offen offset:3840
    s_lshl_b32 s85, s20, 10
    s_add_u32 s85, s85, 13631488
    s_add_u32 s20, s43, 256
    s_min_u32 s20, s20, 799
    s_mul_i32 s21, s20, 52429
    s_lshr_b32 s21, s21, 18
    s_mul_i32 s22, s21, 5
    s_sub_u32 s22, s20, s22
    s_mul_i32 s23, s21, 52429
    s_lshr_b32 s23, s23, 18
    s_mul_i32 s42, s23, 5
    s_sub_u32 s21, s21, s42
    s_and_b32 s42, s23, 3
    s_lshr_b32 s23, s23, 2
    s_mul_i32 s42, s42, 204800
    s_mul_i32 s21, s21, 40960
    s_add_u32 s42, s42, s21
    s_mul_i32 s23, s23, 160
    s_add_u32 s42, s42, s23
    s_lshl_b32 s22, s22, 5
    s_add_u32 s42, s42, s22
    s_add_u32 s23, s42, 5120
    buffer_load_ushort v148, v128, s[60:63], s42 offen offset:0
    buffer_load_ushort v149, v128, s[60:63], s42 offen offset:1280
    buffer_load_ushort v150, v128, s[60:63], s42 offen offset:2560
    buffer_load_ushort v151, v128, s[60:63], s42 offen offset:3840
    buffer_load_ushort v152, v128, s[60:63], s23 offen offset:0
    buffer_load_ushort v153, v128, s[60:63], s23 offen offset:1280
    buffer_load_ushort v154, v128, s[60:63], s23 offen offset:2560
    buffer_load_ushort v155, v128, s[60:63], s23 offen offset:3840
    s_lshl_b32 s86, s20, 10
    s_add_u32 s86, s86, 13631488
    s_add_u32 s20, s43, 384
    s_min_u32 s20, s20, 799
    s_mul_i32 s21, s20, 52429
    s_lshr_b32 s21, s21, 18
    s_mul_i32 s22, s21, 5
    s_sub_u32 s22, s20, s22
    s_mul_i32 s23, s21, 52429
    s_lshr_b32 s23, s23, 18
    s_mul_i32 s42, s23, 5
    s_sub_u32 s21, s21, s42
    s_and_b32 s42, s23, 3
    s_lshr_b32 s23, s23, 2
    s_mul_i32 s42, s42, 204800
    s_mul_i32 s21, s21, 40960
    s_add_u32 s42, s42, s21
    s_mul_i32 s23, s23, 160
    s_add_u32 s42, s42, s23
    s_lshl_b32 s22, s22, 5
    s_add_u32 s42, s42, s22
    s_add_u32 s23, s42, 5120
    buffer_load_ushort v156, v128, s[60:63], s42 offen offset:0
    buffer_load_ushort v157, v128, s[60:63], s42 offen offset:1280
    buffer_load_ushort v158, v128, s[60:63], s42 offen offset:2560
    buffer_load_ushort v159, v128, s[60:63], s42 offen offset:3840
    buffer_load_ushort v160, v128, s[60:63], s23 offen offset:0
    buffer_load_ushort v161, v128, s[60:63], s23 offen offset:1280
    buffer_load_ushort v162, v128, s[60:63], s23 offen offset:2560
    buffer_load_ushort v163, v128, s[60:63], s23 offen offset:3840
    s_lshl_b32 s87, s20, 10
    s_add_u32 s87, s87, 13631488
    s_add_u32 s20, s43, 512
    s_min_u32 s20, s20, 799
    s_mul_i32 s21, s20, 52429
    s_lshr_b32 s21, s21, 18
    s_mul_i32 s22, s21, 5
    s_sub_u32 s22, s20, s22
    s_mul_i32 s23, s21, 52429
    s_lshr_b32 s23, s23, 18
    s_mul_i32 s42, s23, 5
    s_sub_u32 s21, s21, s42
    s_and_b32 s42, s23, 3
    s_lshr_b32 s23, s23, 2
    s_mul_i32 s42, s42, 204800
    s_mul_i32 s21, s21, 40960
    s_add_u32 s42, s42, s21
    s_mul_i32 s23, s23, 160
    s_add_u32 s42, s42, s23
    s_lshl_b32 s22, s22, 5
    s_add_u32 s42, s42, s22
    s_add_u32 s23, s42, 5120
    buffer_load_ushort v164, v128, s[60:63], s42 offen offset:0
    buffer_load_ushort v165, v128, s[60:63], s42 offen offset:1280
    buffer_load_ushort v166, v128, s[60:63], s42 offen offset:2560
    buffer_load_ushort v167, v128, s[60:63], s42 offen offset:3840
    buffer_load_ushort v168, v128, s[60:63], s23 offen offset:0
    buffer_load_ushort v169, v128, s[60:63], s23 offen offset:1280
    buffer_load_ushort v170, v128, s[60:63], s23 offen offset:2560
    buffer_load_ushort v171, v128, s[60:63], s23 offen offset:3840
    s_lshl_b32 s88, s20, 10
    s_add_u32 s88, s88, 13631488
    s_add_u32 s20, s43, 640
    s_min_u32 s20, s20, 799
    s_mul_i32 s21, s20, 52429
    s_lshr_b32 s21, s21, 18
    s_mul_i32 s22, s21, 5
    s_sub_u32 s22, s20, s22
    s_mul_i32 s23, s21, 52429
    s_lshr_b32 s23, s23, 18
    s_mul_i32 s42, s23, 5
    s_sub_u32 s21, s21, s42
    s_and_b32 s42, s23, 3
    s_lshr_b32 s23, s23, 2
    s_mul_i32 s42, s42, 204800
    s_mul_i32 s21, s21, 40960
    s_add_u32 s42, s42, s21
    s_mul_i32 s23, s23, 160
    s_add_u32 s42, s42, s23
    s_lshl_b32 s22, s22, 5
    s_add_u32 s42, s42, s22
    s_add_u32 s23, s42, 5120
    buffer_load_ushort v172, v128, s[60:63], s42 offen offset:0
    buffer_load_ushort v173, v128, s[60:63], s42 offen offset:1280
    buffer_load_ushort v174, v128, s[60:63], s42 offen offset:2560
    buffer_load_ushort v175, v128, s[60:63], s42 offen offset:3840
    buffer_load_ushort v176, v128, s[60:63], s23 offen offset:0
    buffer_load_ushort v177, v128, s[60:63], s23 offen offset:1280
    buffer_load_ushort v178, v128, s[60:63], s23 offen offset:2560
    buffer_load_ushort v179, v128, s[60:63], s23 offen offset:3840
    s_lshl_b32 s89, s20, 10
    s_add_u32 s89, s89, 13631488
    s_add_u32 s20, s43, 768
    s_min_u32 s20, s20, 799
    s_mul_i32 s21, s20, 52429
    s_lshr_b32 s21, s21, 18
    s_mul_i32 s22, s21, 5
    s_sub_u32 s22, s20, s22
    s_mul_i32 s23, s21, 52429
    s_lshr_b32 s23, s23, 18
    s_mul_i32 s42, s23, 5
    s_sub_u32 s21, s21, s42
    s_and_b32 s42, s23, 3
    s_lshr_b32 s23, s23, 2
    s_mul_i32 s42, s42, 204800
    s_mul_i32 s21, s21, 40960
    s_add_u32 s42, s42, s21
    s_mul_i32 s23, s23, 160
    s_add_u32 s42, s42, s23
    s_lshl_b32 s22, s22, 5
    s_add_u32 s42, s42, s22
    s_add_u32 s23, s42, 5120
    buffer_load_ushort v180, v128, s[60:63], s42 offen offset:0
    buffer_load_ushort v181, v128, s[60:63], s42 offen offset:1280
    buffer_load_ushort v182, v128, s[60:63], s42 offen offset:2560
    buffer_load_ushort v183, v128, s[60:63], s42 offen offset:3840
    buffer_load_ushort v184, v128, s[60:63], s23 offen offset:0
    buffer_load_ushort v185, v128, s[60:63], s23 offen offset:1280
    buffer_load_ushort v186, v128, s[60:63], s23 offen offset:2560
    buffer_load_ushort v187, v128, s[60:63], s23 offen offset:3840
    s_lshl_b32 s90, s20, 10
    s_add_u32 s90, s90, 13631488
    s_lshl_b32 s28, s28, 4
    s_sub_i32 s28, s28, s25
    s_mul_i32 s29, s28, 336
    v_add_u32 v6, s29, v6
    v_add_u32 v7, s29, v7
    v_add_u32 v8, s29, v8
    v_add_u32 v9, s29, v9
    v_add_u32 v10, s29, v10
    s_mul_i32 s29, s28, 1280
    v_add_u32 v5, s29, v5
    s_lshl_b32 s29, s28, 2
    v_add_u32 v39, s29, v39
    s_lshl_b32 s29, s16, 8
    s_add_u32 s29, s29, 13107200
    s_mov_b32 s28, 10485760
    s_mov_b32 s40, 4
    v_mov_b32 v126, 0
    v_mov_b32 v127, 0
    s_lshl_b32 s42, s16, 6
    s_sub_u32 s42, 2047, s42
LK1_xn_loop:
    ds_read_b32 v31, v39 offset:0
    ds_read_b128 v[40:43], v6
    ds_read_b128 v[44:47], v7
    ds_read_b128 v[48:51], v8
    ds_read_b128 v[52:55], v9
    ds_read_b128 v[56:59], v10
    s_waitcnt lgkmcnt(5)
    v_cvt_pk_bf16_f32 v32, 0, v31
    v_sub_f32 v31, v31, v32
    v_cvt_pk_bf16_f32 v33, 0, v31
    v_sub_f32 v31, v31, v33
    v_cvt_pk_bf16_f32 v34, 0, v31
    v_lshrrev_b32 v32, 16, v32
    v_lshlrev_b32 v32, v36, v32
    v_cndmask_b32 v120, 0, v32, s[54:55]
    v_cndmask_b32 v121, v32, 0, s[54:55]
    v_lshrrev_b32 v33, 16, v33
    v_lshlrev_b32 v33, v36, v33
    v_cndmask_b32 v122, 0, v33, s[54:55]
    v_cndmask_b32 v123, v33, 0, s[54:55]
    v_lshrrev_b32 v34, 16, v34
    v_lshlrev_b32 v34, v36, v34
    v_cndmask_b32 v124, 0, v34, s[54:55]
    v_cndmask_b32 v125, v34, 0, s[54:55]
    s_waitcnt lgkmcnt(0)
    v_mfma_f32_4x4x4_16b_bf16 v[100:103], v[120:121], v[40:41], 0
    s_nop 1
    v_mfma_f32_4x4x4_16b_bf16 v[100:103], v[122:123], v[40:41], v[100:103]
    s_nop 1
    v_mfma_f32_4x4x4_16b_bf16 v[100:103], v[124:125], v[40:41], v[100:103]
    v_mfma_f32_4x4x4_16b_bf16 v[104:107], v[120:121], v[42:43], 0
    s_nop 1
    v_mfma_f32_4x4x4_16b_bf16 v[104:107], v[122:123], v[42:43], v[104:107]
    s_nop 1
    v_mfma_f32_4x4x4_16b_bf16 v[104:107], v[124:125], v[42:43], v[104:107]
    v_mfma_f32_4x4x4_16b_bf16 v[108:111], v[120:121], v[44:45], 0
    v_cvt_pk_bf16_f32 v40, v100, v101
    s_nop 0
    v_mfma_f32_4x4x4_16b_bf16 v[108:111], v[122:123], v[44:45], v[108:111]
    v_cvt_pk_bf16_f32 v41, v102, v103
    s_nop 0
    v_mfma_f32_4x4x4_16b_bf16 v[108:111], v[124:125], v[44:45], v[108:111]
    v_mfma_f32_4x4x4_16b_bf16 v[112:115], v[120:121], v[46:47], 0
    v_cvt_pk_bf16_f32 v42, v104, v105
    s_nop 0
    v_mfma_f32_4x4x4_16b_bf16 v[112:115], v[122:123], v[46:47], v[112:115]
    v_cvt_pk_bf16_f32 v43, v106, v107
    s_nop 0
    v_mfma_f32_4x4x4_16b_bf16 v[112:115], v[124:125], v[46:47], v[112:115]
    v_mfma_f32_4x4x4_16b_bf16 v[100:103], v[120:121], v[48:49], 0
    v_cvt_pk_bf16_f32 v44, v108, v109
    s_nop 0
    v_mfma_f32_4x4x4_16b_bf16 v[100:103], v[122:123], v[48:49], v[100:103]
    v_cvt_pk_bf16_f32 v45, v110, v111
    s_nop 0
    v_mfma_f32_4x4x4_16b_bf16 v[100:103], v[124:125], v[48:49], v[100:103]
    v_mfma_f32_4x4x4_16b_bf16 v[104:107], v[120:121], v[50:51], 0
    v_cvt_pk_bf16_f32 v46, v112, v113
    s_nop 0
    v_mfma_f32_4x4x4_16b_bf16 v[104:107], v[122:123], v[50:51], v[104:107]
    v_cvt_pk_bf16_f32 v47, v114, v115
    s_nop 0
    v_mfma_f32_4x4x4_16b_bf16 v[104:107], v[124:125], v[50:51], v[104:107]
    v_mfma_f32_4x4x4_16b_bf16 v[108:111], v[120:121], v[52:53], 0
    v_cvt_pk_bf16_f32 v48, v100, v101
    s_nop 0
    v_mfma_f32_4x4x4_16b_bf16 v[108:111], v[122:123], v[52:53], v[108:111]
    v_cvt_pk_bf16_f32 v49, v102, v103
    s_nop 0
    v_mfma_f32_4x4x4_16b_bf16 v[108:111], v[124:125], v[52:53], v[108:111]
    v_mfma_f32_4x4x4_16b_bf16 v[112:115], v[120:121], v[54:55], 0
    v_cvt_pk_bf16_f32 v50, v104, v105
    s_nop 0
    v_mfma_f32_4x4x4_16b_bf16 v[112:115], v[122:123], v[54:55], v[112:115]
    v_cvt_pk_bf16_f32 v51, v106, v107
    s_nop 0
    v_mfma_f32_4x4x4_16b_bf16 v[112:115], v[124:125], v[54:55], v[112:115]
    v_mfma_f32_4x4x4_16b_bf16 v[100:103], v[120:121], v[56:57], 0
    v_cvt_pk_bf16_f32 v52, v108, v109
    s_nop 0
    v_mfma_f32_4x4x4_16b_bf16 v[100:103], v[122:123], v[56:57], v[100:103]
    v_cvt_pk_bf16_f32 v53, v110, v111
    s_nop 0
    v_mfma_f32_4x4x4_16b_bf16 v[100:103], v[124:125], v[56:57], v[100:103]
    v_mfma_f32_4x4x4_16b_bf16 v[104:107], v[120:121], v[58:59], 0
    v_cvt_pk_bf16_f32 v54, v112, v113
    s_nop 0
    v_mfma_f32_4x4x4_16b_bf16 v[104:107], v[122:123], v[58:59], v[104:107]
    v_cvt_pk_bf16_f32 v55, v114, v115
    s_nop 0
    v_mfma_f32_4x4x4_16b_bf16 v[104:107], v[124:125], v[58:59], v[104:107]
    v_cvt_pk_bf16_f32 v56, v100, v101
    v_cvt_pk_bf16_f32 v57, v102, v103
    s_nop 2
    v_cvt_pk_bf16_f32 v58, v104, v105
    v_cvt_pk_bf16_f32 v59, v106, v107
    buffer_store_dwordx4 v[40:43], v5, s[12:15], s28 offen offset:0
    buffer_store_dwordx4 v[44:47], v5, s[12:15], s28 offen offset:256
    buffer_store_dwordx4 v[48:51], v5, s[12:15], s28 offen offset:512
    buffer_store_dwordx4 v[52:55], v5, s[12:15], s28 offen offset:768
    buffer_store_dwordx4 v[56:59], v5, s[12:15], s28 offen offset:1024
    v_mov_b32 v28, 0
    v_mov_b32 v29, 0
    s_waitcnt vmcnt(5)
    v_dot2c_f32_bf16 v28, v40, v60
    v_dot2c_f32_bf16 v29, v41, v61
    v_dot2c_f32_bf16 v28, v42, v62
    v_dot2c_f32_bf16 v29, v43, v63
    v_dot2c_f32_bf16 v28, v44, v64
    v_dot2c_f32_bf16 v29, v45, v65
    v_dot2c_f32_bf16 v28, v46, v66
    v_dot2c_f32_bf16 v29, v47, v67
    v_dot2c_f32_bf16 v28, v48, v68
    v_dot2c_f32_bf16 v29, v49, v69
    v_dot2c_f32_bf16 v28, v50, v70
    v_dot2c_f32_bf16 v29, v51, v71
    v_dot2c_f32_bf16 v28, v52, v72
    v_dot2c_f32_bf16 v29, v53, v73
    v_dot2c_f32_bf16 v28, v54, v74
    v_dot2c_f32_bf16 v29, v55, v75
    v_dot2c_f32_bf16 v28, v56, v76
    v_dot2c_f32_bf16 v29, v57, v77
    v_dot2c_f32_bf16 v28, v58, v78
    v_dot2c_f32_bf16 v29, v59, v79
    s_nop 2
    v_add_f32 v28, v28, v29
    s_nop 1
    v_add_f32_dpp v28, v28, v28 row_ror:8 row_mask:0xf bank_mask:0xf
    s_nop 1
    v_add_f32_dpp v28, v28, v28 row_ror:4 row_mask:0xf bank_mask:0xf
    s_nop 1
    v_add_f32_dpp v28, v28, v28 row_ror:2 row_mask:0xf bank_mask:0xf
    s_nop 1
    v_add_f32_dpp v28, v28, v28 row_ror:1 row_mask:0xf bank_mask:0xf
    v_cvt_pk_bf16_f32 v28, 0, v28
    s_mov_b64 exec, s[56:57]
    buffer_store_dword v28, v39, s[12:15], s29 offen
    s_mov_b64 exec, -1
    v_ashrrev_i32 v29, 31, v28
    v_or_b32 v29, 0x80000000, v29
    v_xor_b32 v29, v28, v29
    v_and_b32 v29, 0xffff0000, v29
    v_lshrrev_b32 v30, 2, v39
    v_sub_u32 v30, s42, v30
    v_or_b32 v29, v29, v30
    v_med3_u32 v127, v126, v127, v29
    v_max_u32 v126, v126, v29
    v_add_u32 v6, 1344, v6
    v_add_u32 v7, 1344, v7
    v_add_u32 v8, 1344, v8
    v_add_u32 v9, 1344, v9
    v_add_u32 v10, 1344, v10
    v_add_u32 v5, 5120, v5
    v_add_u32 v39, 16, v39
    s_sub_u32 s40, s40, 1
    s_cmp_lg_u32 s40, 0
    s_nop 3
    s_cbranch_scc1 LK1_xn_loop
    v_readlane_b32 s20, v126, 0
    v_readlane_b32 s21, v127, 0
    v_readlane_b32 s22, v126, 16
    v_readlane_b32 s23, v127, 16
    v_readlane_b32 s24, v126, 32
    v_readlane_b32 s25, v127, 32
    v_readlane_b32 s26, v126, 48
    v_readlane_b32 s27, v127, 48
    s_nop 3
    s_min_u32 s42, s20, s22
    s_max_u32 s20, s20, s22
    s_max_u32 s21, s21, s23
    s_max_u32 s21, s21, s42
    s_min_u32 s42, s24, s26
    s_max_u32 s24, s24, s26
    s_max_u32 s25, s25, s27
    s_max_u32 s25, s25, s42
    s_min_u32 s42, s20, s24
    s_max_u32 s20, s20, s24
    s_max_u32 s21, s21, s25
    s_max_u32 s21, s21, s42
    s_sub_u32 s24, s19, 30
    s_lshl_b32 s24, s24, 1
    s_add_u32 s24, s24, s41
    s_lshl_b32 s25, s16, 2
    s_add_u32 s24, s24, s25
    s_lshl_b32 s24, s24, 3
    s_add_u32 s24, s24, 13123584
    v_mov_b32 v126, s20
    v_mov_b32 v127, s21
    v_mov_b32 v125, s24
    s_mov_b64 exec, 1
    buffer_store_dwordx2 v[126:127], v125, s[12:15], 0 offen
    s_and_b32 s24, s43, 15
    s_lshl_b32 s24, s24, 9
    s_add_u32 s24, s24, 13139968
    v_mov_b32 v125, s24
    v_mov_b32 v126, 0
    buffer_store_dword v126, v125, s[12:15], 0 offen
    s_mov_b64 exec, -1
    v_lshl_or_b32 v192, v133, 16, v132
    v_lshl_or_b32 v193, v135, 16, v134
    v_lshl_or_b32 v194, v137, 16, v136
    v_lshl_or_b32 v195, v139, 16, v138
    buffer_store_dwordx4 v[192:195], v129, s[12:15], s84 offen
    v_lshl_or_b32 v196, v141, 16, v140
    v_lshl_or_b32 v197, v143, 16, v142
    v_lshl_or_b32 v198, v145, 16, v144
    v_lshl_or_b32 v199, v147, 16, v146
    buffer_store_dwordx4 v[196:199], v129, s[12:15], s85 offen
    v_lshl_or_b32 v200, v149, 16, v148
    v_lshl_or_b32 v201, v151, 16, v150
    v_lshl_or_b32 v202, v153, 16, v152
    v_lshl_or_b32 v203, v155, 16, v154
    buffer_store_dwordx4 v[200:203], v129, s[12:15], s86 offen
    v_lshl_or_b32 v204, v157, 16, v156
    v_lshl_or_b32 v205, v159, 16, v158
    v_lshl_or_b32 v206, v161, 16, v160
    v_lshl_or_b32 v207, v163, 16, v162
    buffer_store_dwordx4 v[204:207], v129, s[12:15], s87 offen
    v_lshl_or_b32 v208, v165, 16, v164
    v_lshl_or_b32 v209, v167, 16, v166
    v_lshl_or_b32 v210, v169, 16, v168
    v_lshl_or_b32 v211, v171, 16, v170
    buffer_store_dwordx4 v[208:211], v129, s[12:15], s88 offen
    v_lshl_or_b32 v212, v173, 16, v172
    v_lshl_or_b32 v213, v175, 16, v174
    v_lshl_or_b32 v214, v177, 16, v176
    v_lshl_or_b32 v215, v179, 16, v178
    buffer_store_dwordx4 v[212:215], v129, s[12:15], s89 offen
    v_lshl_or_b32 v216, v181, 16, v180
    v_lshl_or_b32 v217, v183, 16, v182
    v_lshl_or_b32 v218, v185, 16, v184
    v_lshl_or_b32 v219, v187, 16, v186
    buffer_store_dwordx4 v[216:219], v129, s[12:15], s90 offen
LK1_exit:
    s_endpgm
.section .rodata,"a"
.p2align 6
.amdhsa_kernel k1_kernel
  .amdhsa_next_free_vgpr 256
  .amdhsa_next_free_sgpr 96
  .amdhsa_accum_offset 256
  .amdhsa_group_segment_fixed_size 0
  .amdhsa_kernarg_size 88
  .amdhsa_user_sgpr_count 2
  .amdhsa_user_sgpr_kernarg_segment_ptr 1
  .amdhsa_system_sgpr_workgroup_id_x 1
.end_amdhsa_kernel
.text
.globl k2_kernel
.p2align 8
.type k2_kernel,@function
k2_kernel:
    s_cmp_ge_u32 s2, 256
    s_cbranch_scc1 LH_exit
    v_readfirstlane_b32 s3, v0
    s_nop 3
    s_cmp_ge_u32 s3, 512
    s_cbranch_scc1 LH_start
    s_setprio 3
    s_load_dwordx2 s[22:23], s[0:1], 80
    v_and_b32 v24, 63, v0
    v_lshrrev_b32 v25, 6, v0
    s_and_b32 s24, s2, 7
    s_lshr_b32 s25, s2, 3
    s_and_b32 s26, s25, 3
    s_lshl_b32 s24, s24, 2
    s_add_u32 s24, s24, s26
    s_lshr_b32 s25, s25, 2
    v_readfirstlane_b32 s26, v25
    s_lshl_b32 s25, s25, 2
    s_lshr_b32 s21, s26, 2
    s_and_b32 s26, s26, 3
    s_add_u32 s25, s25, s26
    s_mul_i32 s27, s24, 163840
    v_and_b32 v26, 31, v24
    v_lshrrev_b32 v27, 5, v24
    v_lshlrev_b32 v1, 4, v24
    v_lshlrev_b32 v2, 3, v26
    v_add_u32 v2, 1024, v2
    v_mul_u32_u24 v3, 20, v27
    v_add_u32 v3, v3, v26
    v_lshlrev_b32 v3, 4, v3
    v_add_u32 v3, 1280, v3
    v_cmp_gt_u32 s[18:19], 20, v26
    s_mul_i32 s16, s21, 81920
    s_lshl_b32 s17, s26, 10
    s_add_u32 s17, s17, s16
    s_mul_i32 s30, s24, 81920
    s_mul_i32 s26, s25, 2560
    s_add_u32 s30, s30, s26
    v_mov_b32 v12, 0
    v_mov_b32 v13, 0
    v_mov_b32 v14, 0
    v_mov_b32 v15, 0
    s_waitcnt lgkmcnt(0)
    s_add_u32 s4, s22, s27
    s_addc_u32 s5, s23, 0
    s_mov_b32 s6, 163840
    s_mov_b32 s7, 0x00020000
    s_add_u32 s8, s22, 5242880
    s_addc_u32 s9, s23, 0
    s_mov_b32 s10, 2621440
    s_mov_b32 s11, 0x00020000
    s_add_u32 s12, s22, 7864320
    s_addc_u32 s13, s23, 0
    s_mov_b32 s14, 2621440
    s_mov_b32 s15, 0x00020000
    s_mov_b32 m0, s17
    s_nop 0
    buffer_load_dwordx4 v1, s[4:7], s17 offen lds
    s_add_u32 s17, s17, 4096
    buffer_load_dwordx4 v[4:7], v1, s[8:11], s30 offen
    buffer_load_dwordx4 v[8:11], v1, s[8:11], s30 offen offset:1280
    s_mov_b32 exec_hi, 0
    buffer_load_dwordx2 v[12:13], v2, s[8:11], s30 offen
    buffer_load_dwordx2 v[14:15], v2, s[8:11], s30 offen offset:1280
    s_mov_b32 exec_hi, -1
    s_mov_b32 m0, s17
    s_nop 0
    buffer_load_dwordx4 v1, s[4:7], s17 offen lds
    s_add_u32 s17, s17, 4096
    s_mov_b32 m0, s17
    s_nop 0
    buffer_load_dwordx4 v1, s[4:7], s17 offen lds
    s_add_u32 s17, s17, 4096
    s_mov_b32 m0, s17
    s_nop 0
    buffer_load_dwordx4 v1, s[4:7], s17 offen lds
    s_add_u32 s17, s17, 4096
    s_load_dwordx2 s[56:57], s[0:1], 0
    s_load_dwordx4 s[60:63], s[0:1], 64
    v_and_b32 v164, 0xff, v0
    v_add_u32 v165, 0, v164
    v_mul_u32_u24 v166, 3277, v165
    v_lshrrev_b32 v158, 16, v166
    v_mul_u32_u24 v166, 20, v158
    v_sub_u32 v166, v165, v166
    v_mul_u32_u24 v153, 336, v158
    v_lshl_add_u32 v153, v166, 4, v153
    v_mul_u32_u24 v148, 0x500, v158
    v_lshl_add_u32 v148, v166, 3, v148
    v_add_u32 v165, 256, v164
    v_mul_u32_u24 v166, 3277, v165
    v_lshrrev_b32 v159, 16, v166
    v_mul_u32_u24 v166, 20, v159
    v_sub_u32 v166, v165, v166
    v_mul_u32_u24 v154, 336, v159
    v_lshl_add_u32 v154, v166, 4, v154
    v_mul_u32_u24 v149, 0x500, v159
    v_lshl_add_u32 v149, v166, 3, v149
    v_add_u32 v165, 512, v164
    v_mul_u32_u24 v166, 3277, v165
    v_lshrrev_b32 v160, 16, v166
    v_mul_u32_u24 v166, 20, v160
    v_sub_u32 v166, v165, v166
    v_mul_u32_u24 v155, 336, v160
    v_lshl_add_u32 v155, v166, 4, v155
    v_mul_u32_u24 v150, 0x500, v160
    v_lshl_add_u32 v150, v166, 3, v150
    v_add_u32 v165, 768, v164
    v_mul_u32_u24 v166, 3277, v165
    v_lshrrev_b32 v161, 16, v166
    v_mul_u32_u24 v166, 20, v161
    v_sub_u32 v166, v165, v166
    v_mul_u32_u24 v156, 336, v161
    v_lshl_add_u32 v156, v166, 4, v156
    v_mul_u32_u24 v151, 0x500, v161
    v_lshl_add_u32 v151, v166, 3, v151
    v_add_u32 v165, 1024, v164
    v_mul_u32_u24 v166, 3277, v165
    v_lshrrev_b32 v162, 16, v166
    v_mul_u32_u24 v166, 20, v162
    v_sub_u32 v166, v165, v166
    v_mul_u32_u24 v157, 336, v162
    v_lshl_add_u32 v157, v166, 4, v157
    v_mul_u32_u24 v152, 0x500, v162
    v_lshl_add_u32 v152, v166, 3, v152
    s_waitcnt lgkmcnt(0)
    s_mov_b32 s48, s56
    s_mov_b32 s49, s57
    s_mov_b32 s50, 2621440
    s_mov_b32 s51, 0x00020000
    s_mov_b32 s52, s60
    s_mov_b32 s53, s61
    s_mov_b32 s54, 2621440
    s_mov_b32 s55, 0x00020000
    s_mov_b32 s32, s62
    s_mov_b32 s33, s63
    s_mov_b32 s34, 256
    s_mov_b32 s35, 0x00020000
    s_mov_b32 s44, s22
    s_mov_b32 s45, s23
    s_mov_b32 s46, 16777216
    s_mov_b32 s47, 0x00020000
    v_mov_b32 v108, 0x3f80
    v_mov_b32 v109, 0
    v_mov_b32 v124, 0x3f80
    v_mov_b32 v125, 0
    v_and_b32 v30, 27, v26
    v_cmp_eq_u32 vcc, 24, v30
    v_mov_b32 v31, 0x3f803f80
    s_nop 0
    v_cndmask_b32 v31, 0, v31, vcc
    v_mov_b32 v100, v31
    v_mov_b32 v101, v31
    v_mov_b32 v102, v31
    v_mov_b32 v103, v31
    v_mov_b32 v104, v31
    v_mov_b32 v105, v31
    v_mov_b32 v106, v31
    v_mov_b32 v107, v31
    v_mov_b32 v116, v31
    v_mov_b32 v117, v31
    v_mov_b32 v118, v31
    v_mov_b32 v119, v31
    v_mov_b32 v120, v31
    v_mov_b32 v121, v31
    v_mov_b32 v122, v31
    v_mov_b32 v123, v31
    v_mov_b32 v64, 0
    v_mov_b32 v65, 0
    v_mov_b32 v66, 0
    v_mov_b32 v67, 0
    v_mov_b32 v68, 0
    v_mov_b32 v69, 0
    v_mov_b32 v70, 0
    v_mov_b32 v71, 0
    v_mov_b32 v72, 0
    v_mov_b32 v73, 0
    v_mov_b32 v74, 0
    v_mov_b32 v75, 0
    v_mov_b32 v76, 0
    v_mov_b32 v77, 0
    v_mov_b32 v78, 0
    v_mov_b32 v79, 0
    v_mov_b32 v80, 0
    v_mov_b32 v81, 0
    v_mov_b32 v82, 0
    v_mov_b32 v83, 0
    v_mov_b32 v84, 0
    v_mov_b32 v85, 0
    v_mov_b32 v86, 0
    v_mov_b32 v87, 0
    v_mov_b32 v88, 0
    v_mov_b32 v89, 0
    v_mov_b32 v90, 0
    v_mov_b32 v91, 0
    v_mov_b32 v92, 0
    v_mov_b32 v93, 0
    v_mov_b32 v94, 0
    v_mov_b32 v95, 0
    v_mov_b32 v16, 0
    v_mov_b32 v17, 0
    v_mov_b32 v18, 0
    v_mov_b32 v19, 0
    v_mov_b32 v20, 0
    v_mov_b32 v21, 0
    v_mov_b32 v22, 0
    v_mov_b32 v23, 0
    s_waitcnt vmcnt(0)
    s_barrier
    ds_read_b128 v[112:115], v1 offset:0
    s_mov_b32 exec_hi, 0
    ds_read_b64 v[124:125], v2 offset:0
    s_mov_b32 exec_hi, -1
    v_add_u32 v2, s16, v2
    v_add_u32 v3, s16, v3
    v_add_u32 v1, s16, v1
    ds_read_b128 v[96:99], v1 offset:0
    s_mov_b32 exec_hi, 0
    ds_read_b64 v[108:109], v2 offset:0
    s_mov_b32 exec_hi, -1
    s_waitcnt lgkmcnt(2)
    v_mfma_f32_32x32x16_bf16 v[32:47], v[112:115], v[4:7], 0
    v_mfma_f32_32x32x8_bf16 v[32:47], v[124:125], v[12:13], v[32:47]
    v_mfma_f32_32x32x16_bf16 v[48:63], v[112:115], v[8:11], 0
    v_mfma_f32_32x32x8_bf16 v[48:63], v[124:125], v[14:15], v[48:63]
    ds_read_b128 v[112:115], v1 offset:2560
    s_mov_b32 exec_hi, 0
    ds_read_b64 v[124:125], v2 offset:2560
    s_mov_b32 exec_hi, -1
    s_mov_b64 exec, s[18:19]
    ds_read_b128 v[100:103], v3 offset:0
    ds_read_b128 v[104:107], v3 offset:640
    s_mov_b64 exec, -1
    v_cmp_ne_u32 vcc, 0, v27
    s_nop 0
    v_max3_f32 v30, v32, v33, v34
    v_max3_f32 v30, v30, v35, v36
    v_max3_f32 v30, v30, v37, v38
    v_max3_f32 v30, v30, v39, v40
    v_max3_f32 v30, v30, v41, v42
    v_max3_f32 v30, v30, v43, v44
    v_max3_f32 v30, v30, v45, v46
    v_max_f32 v30, v30, v47
    v_mov_b32 v24, v30
    s_nop 1
    v_permlane32_swap_b32 v30, v24
    v_max_f32 v30, v30, v24
    v_sub_f32 v30, 0xc2a00000, v30
    v_cvt_pk_bf16_f32 v30, v30, 0
    v_cndmask_b32 v12, v12, v30, vcc
    v_max3_f32 v31, v48, v49, v50
    v_max3_f32 v31, v31, v51, v52
    v_max3_f32 v31, v31, v53, v54
    v_max3_f32 v31, v31, v55, v56
    v_max3_f32 v31, v31, v57, v58
    v_max3_f32 v31, v31, v59, v60
    v_max3_f32 v31, v31, v61, v62
    v_max_f32 v31, v31, v63
    v_mov_b32 v24, v31
    s_nop 1
    v_permlane32_swap_b32 v31, v24
    v_max_f32 v31, v31, v24
    v_sub_f32 v31, 0xc2a00000, v31
    v_cvt_pk_bf16_f32 v31, v31, 0
    v_cndmask_b32 v14, v14, v31, vcc
    v_mov_b32 v60, 0
    v_mov_b32 v61, 0
    v_mov_b32 v62, 0
    v_mov_b32 v63, 0
    s_waitcnt lgkmcnt(4)
    v_mfma_f32_32x32x16_bf16 v[32:47], v[96:99], v[4:7], 0
    v_mfma_f32_32x32x8_bf16 v[32:47], v[108:109], v[12:13], v[32:47]
    s_mov_b32 s20, 8
    s_mov_b32 s17, 1
    s_setprio 0
    s_nop 6
    .p2align 6
LA_loop:
    v_cvt_pk_bf16_f32 v22, v60, v61
    v_cvt_pk_bf16_f32 v23, v62, v63
    v_mfma_f32_32x32x16_bf16 v[48:63], v[96:99], v[8:11], 0
    v_exp_f32 v32, v32
    v_exp_f32 v33, v33
    v_exp_f32 v34, v34
    v_exp_f32 v35, v35
    v_cvt_pk_bf16_f32 v16, v32, v33
    v_cvt_pk_bf16_f32 v17, v34, v35
    v_mfma_f32_32x32x8_bf16 v[48:63], v[108:109], v[14:15], v[48:63]
    ds_read_b128 v[96:99], v1 offset:5120
    s_mov_b32 exec_hi, 0
    ds_read_b64 v[108:109], v2 offset:5120
    s_mov_b32 exec_hi, -1
    v_exp_f32 v36, v36
    v_exp_f32 v37, v37
    v_exp_f32 v38, v38
    v_exp_f32 v39, v39
    v_cvt_pk_bf16_f32 v18, v36, v37
    v_cvt_pk_bf16_f32 v19, v38, v39
    v_mfma_f32_32x32x16_bf16 v[80:95], v[120:123], v[20:23], v[80:95]
    s_mov_b64 exec, s[18:19]
    ds_read_b128 v[116:119], v3 offset:2560
    ds_read_b128 v[120:123], v3 offset:3200
    s_mov_b64 exec, -1
    v_exp_f32 v40, v40
    v_exp_f32 v41, v41
    v_exp_f32 v42, v42
    v_exp_f32 v43, v43
    v_cvt_pk_bf16_f32 v20, v40, v41
    v_cvt_pk_bf16_f32 v21, v42, v43
    s_waitcnt lgkmcnt(4)
    v_mfma_f32_32x32x16_bf16 v[64:79], v[100:103], v[16:19], v[64:79]
    v_exp_f32 v44, v44
    v_exp_f32 v45, v45
    v_exp_f32 v46, v46
    v_exp_f32 v47, v47
    v_cvt_pk_bf16_f32 v22, v44, v45
    v_cvt_pk_bf16_f32 v23, v46, v47
    v_mfma_f32_32x32x16_bf16 v[32:47], v[112:115], v[4:7], 0
    v_exp_f32 v48, v48
    v_exp_f32 v49, v49
    v_exp_f32 v50, v50
    v_exp_f32 v51, v51
    v_cvt_pk_bf16_f32 v16, v48, v49
    v_cvt_pk_bf16_f32 v17, v50, v51
    v_mfma_f32_32x32x8_bf16 v[32:47], v[124:125], v[12:13], v[32:47]
    v_exp_f32 v52, v52
    v_exp_f32 v53, v53
    v_exp_f32 v54, v54
    v_exp_f32 v55, v55
    v_cvt_pk_bf16_f32 v18, v52, v53
    v_cvt_pk_bf16_f32 v19, v54, v55
    v_mfma_f32_32x32x16_bf16 v[64:79], v[104:107], v[20:23], v[64:79]
    v_exp_f32 v56, v56
    v_exp_f32 v57, v57
    v_exp_f32 v58, v58
    v_exp_f32 v59, v59
    v_cvt_pk_bf16_f32 v20, v56, v57
    v_cvt_pk_bf16_f32 v21, v58, v59
    v_mfma_f32_32x32x16_bf16 v[80:95], v[100:103], v[16:19], v[80:95]
    v_exp_f32 v60, v60
    v_exp_f32 v61, v61
    v_exp_f32 v62, v62
    v_exp_f32 v63, v63
    v_cvt_pk_bf16_f32 v22, v60, v61
    v_cvt_pk_bf16_f32 v23, v62, v63
    v_mfma_f32_32x32x16_bf16 v[48:63], v[112:115], v[8:11], 0
    v_exp_f32 v32, v32
    v_exp_f32 v33, v33
    v_exp_f32 v34, v34
    v_exp_f32 v35, v35
    v_cvt_pk_bf16_f32 v16, v32, v33
    v_cvt_pk_bf16_f32 v17, v34, v35
    v_mfma_f32_32x32x8_bf16 v[48:63], v[124:125], v[14:15], v[48:63]
    ds_read_b128 v[112:115], v1 offset:7680
    s_mov_b32 exec_hi, 0
    ds_read_b64 v[124:125], v2 offset:7680
    s_mov_b32 exec_hi, -1
    v_exp_f32 v36, v36
    v_exp_f32 v37, v37
    v_exp_f32 v38, v38
    v_exp_f32 v39, v39
    v_cvt_pk_bf16_f32 v18, v36, v37
    v_cvt_pk_bf16_f32 v19, v38, v39
    v_mfma_f32_32x32x16_bf16 v[80:95], v[104:107], v[20:23], v[80:95]
    s_mov_b64 exec, s[18:19]
    ds_read_b128 v[100:103], v3 offset:5120
    ds_read_b128 v[104:107], v3 offset:5760
    s_mov_b64 exec, -1
    v_exp_f32 v40, v40
    v_exp_f32 v41, v41
    v_exp_f32 v42, v42
    v_exp_f32 v43, v43
    v_cvt_pk_bf16_f32 v20, v40, v41
    v_cvt_pk_bf16_f32 v21, v42, v43
    s_waitcnt lgkmcnt(4)
    v_mfma_f32_32x32x16_bf16 v[64:79], v[116:119], v[16:19], v[64:79]
    v_exp_f32 v44, v44
    v_exp_f32 v45, v45
    v_exp_f32 v46, v46
    v_exp_f32 v47, v47
    v_cvt_pk_bf16_f32 v22, v44, v45
    v_cvt_pk_bf16_f32 v23, v46, v47
    v_mfma_f32_32x32x16_bf16 v[32:47], v[96:99], v[4:7], 0
    v_exp_f32 v48, v48
    v_exp_f32 v49, v49
    v_exp_f32 v50, v50
    v_exp_f32 v51, v51
    v_cvt_pk_bf16_f32 v16, v48, v49
    v_cvt_pk_bf16_f32 v17, v50, v51
    v_mfma_f32_32x32x8_bf16 v[32:47], v[108:109], v[12:13], v[32:47]
    v_exp_f32 v52, v52
    v_exp_f32 v53, v53
    v_exp_f32 v54, v54
    v_exp_f32 v55, v55
    v_cvt_pk_bf16_f32 v18, v52, v53
    v_cvt_pk_bf16_f32 v19, v54, v55
    v_mfma_f32_32x32x16_bf16 v[64:79], v[120:123], v[20:23], v[64:79]
    v_exp_f32 v56, v56
    v_exp_f32 v57, v57
    v_exp_f32 v58, v58
    v_exp_f32 v59, v59
    v_cvt_pk_bf16_f32 v20, v56, v57
    v_cvt_pk_bf16_f32 v21, v58, v59
    v_mfma_f32_32x32x16_bf16 v[80:95], v[116:119], v[16:19], v[80:95]
    v_exp_f32 v60, v60
    v_exp_f32 v61, v61
    v_exp_f32 v62, v62
    v_exp_f32 v63, v63
    v_cvt_pk_bf16_f32 v22, v60, v61
    v_cvt_pk_bf16_f32 v23, v62, v63
    v_mfma_f32_32x32x16_bf16 v[48:63], v[96:99], v[8:11], 0
    v_exp_f32 v32, v32
    v_exp_f32 v33, v33
    v_exp_f32 v34, v34
    v_exp_f32 v35, v35
    v_cvt_pk_bf16_f32 v16, v32, v33
    v_cvt_pk_bf16_f32 v17, v34, v35
    v_mfma_f32_32x32x8_bf16 v[48:63], v[108:109], v[14:15], v[48:63]
    ds_read_b128 v[96:99], v1 offset:10240
    s_mov_b32 exec_hi, 0
    ds_read_b64 v[108:109], v2 offset:10240
    s_mov_b32 exec_hi, -1
    v_exp_f32 v36, v36
    v_exp_f32 v37, v37
    v_exp_f32 v38, v38
    v_exp_f32 v39, v39
    v_cvt_pk_bf16_f32 v18, v36, v37
    v_cvt_pk_bf16_f32 v19, v38, v39
    v_mfma_f32_32x32x16_bf16 v[80:95], v[120:123], v[20:23], v[80:95]
    s_mov_b64 exec, s[18:19]
    ds_read_b128 v[116:119], v3 offset:7680
    ds_read_b128 v[120:123], v3 offset:8320
    s_mov_b64 exec, -1
    v_exp_f32 v40, v40
    v_exp_f32 v41, v41
    v_exp_f32 v42, v42
    v_exp_f32 v43, v43
    v_cvt_pk_bf16_f32 v20, v40, v41
    v_cvt_pk_bf16_f32 v21, v42, v43
    s_waitcnt lgkmcnt(4)
    v_mfma_f32_32x32x16_bf16 v[64:79], v[100:103], v[16:19], v[64:79]
    v_exp_f32 v44, v44
    v_exp_f32 v45, v45
    v_exp_f32 v46, v46
    v_exp_f32 v47, v47
    v_cvt_pk_bf16_f32 v22, v44, v45
    v_cvt_pk_bf16_f32 v23, v46, v47
    v_mfma_f32_32x32x16_bf16 v[32:47], v[112:115], v[4:7], 0
    v_exp_f32 v48, v48
    v_exp_f32 v49, v49
    v_exp_f32 v50, v50
    v_exp_f32 v51, v51
    v_cvt_pk_bf16_f32 v16, v48, v49
    v_cvt_pk_bf16_f32 v17, v50, v51
    v_mfma_f32_32x32x8_bf16 v[32:47], v[124:125], v[12:13], v[32:47]
    v_exp_f32 v52, v52
    v_exp_f32 v53, v53
    v_exp_f32 v54, v54
    v_exp_f32 v55, v55
    v_cvt_pk_bf16_f32 v18, v52, v53
    v_cvt_pk_bf16_f32 v19, v54, v55
    v_mfma_f32_32x32x16_bf16 v[64:79], v[104:107], v[20:23], v[64:79]
    v_exp_f32 v56, v56
    v_exp_f32 v57, v57
    v_exp_f32 v58, v58
    v_exp_f32 v59, v59
    v_cvt_pk_bf16_f32 v20, v56, v57
    v_cvt_pk_bf16_f32 v21, v58, v59
    v_mfma_f32_32x32x16_bf16 v[80:95], v[100:103], v[16:19], v[80:95]
    v_exp_f32 v60, v60
    v_exp_f32 v61, v61
    v_exp_f32 v62, v62
    v_exp_f32 v63, v63
    v_cvt_pk_bf16_f32 v22, v60, v61
    v_cvt_pk_bf16_f32 v23, v62, v63
    v_mfma_f32_32x32x16_bf16 v[48:63], v[112:115], v[8:11], 0
    v_exp_f32 v32, v32
    v_exp_f32 v33, v33
    v_exp_f32 v34, v34
    v_exp_f32 v35, v35
    v_cvt_pk_bf16_f32 v16, v32, v33
    v_cvt_pk_bf16_f32 v17, v34, v35
    v_mfma_f32_32x32x8_bf16 v[48:63], v[124:125], v[14:15], v[48:63]
    ds_read_b128 v[112:115], v1 offset:12800
    s_mov_b32 exec_hi, 0
    ds_read_b64 v[124:125], v2 offset:12800
    s_mov_b32 exec_hi, -1
    v_exp_f32 v36, v36
    v_exp_f32 v37, v37
    v_exp_f32 v38, v38
    v_exp_f32 v39, v39
    v_cvt_pk_bf16_f32 v18, v36, v37
    v_cvt_pk_bf16_f32 v19, v38, v39
    v_mfma_f32_32x32x16_bf16 v[80:95], v[104:107], v[20:23], v[80:95]
    s_mov_b64 exec, s[18:19]
    ds_read_b128 v[100:103], v3 offset:10240
    ds_read_b128 v[104:107], v3 offset:10880
    s_mov_b64 exec, -1
    v_exp_f32 v40, v40
    v_exp_f32 v41, v41
    v_exp_f32 v42, v42
    v_exp_f32 v43, v43
    v_cvt_pk_bf16_f32 v20, v40, v41
    v_cvt_pk_bf16_f32 v21, v42, v43
    s_waitcnt lgkmcnt(4)
    v_mfma_f32_32x32x16_bf16 v[64:79], v[116:119], v[16:19], v[64:79]
    v_exp_f32 v44, v44
    v_exp_f32 v45, v45
    v_exp_f32 v46, v46
    v_exp_f32 v47, v47
    v_cvt_pk_bf16_f32 v22, v44, v45
    v_cvt_pk_bf16_f32 v23, v46, v47
    v_mfma_f32_32x32x16_bf16 v[32:47], v[96:99], v[4:7], 0
    v_exp_f32 v48, v48
    v_exp_f32 v49, v49
    v_exp_f32 v50, v50
    v_exp_f32 v51, v51
    v_cvt_pk_bf16_f32 v16, v48, v49
    v_cvt_pk_bf16_f32 v17, v50, v51
    v_mfma_f32_32x32x8_bf16 v[32:47], v[108:109], v[12:13], v[32:47]
    v_exp_f32 v52, v52
    v_exp_f32 v53, v53
    v_exp_f32 v54, v54
    v_exp_f32 v55, v55
    v_cvt_pk_bf16_f32 v18, v52, v53
    v_cvt_pk_bf16_f32 v19, v54, v55
    v_mfma_f32_32x32x16_bf16 v[64:79], v[120:123], v[20:23], v[64:79]
    v_exp_f32 v56, v56
    v_exp_f32 v57, v57
    v_exp_f32 v58, v58
    v_exp_f32 v59, v59
    v_cvt_pk_bf16_f32 v20, v56, v57
    v_cvt_pk_bf16_f32 v21, v58, v59
    v_mfma_f32_32x32x16_bf16 v[80:95], v[116:119], v[16:19], v[80:95]
    v_exp_f32 v60, v60
    v_exp_f32 v61, v61
    v_exp_f32 v62, v62
    v_exp_f32 v63, v63
    v_add_u32 v1, 10240, v1
    v_add_u32 v2, 10240, v2
    v_add_u32 v3, 10240, v3
    s_cmp_eq_u32 s17, 0
    s_cbranch_scc1 LA_nobar
    s_mov_b32 s17, 0
    s_waitcnt vmcnt(0)
    s_barrier
LA_nobar:
    s_sub_u32 s20, s20, 1
    s_cmp_lg_u32 s20, 0
    s_cbranch_scc1 LA_loop
    v_cvt_pk_bf16_f32 v22, v60, v61
    v_cvt_pk_bf16_f32 v23, v62, v63
    s_nop 1
    v_mfma_f32_32x32x16_bf16 v[80:95], v[120:123], v[20:23], v[80:95]
    s_nop 15
    s_waitcnt lgkmcnt(0)
    v_and_b32 v2, 63, v0
    v_lshlrev_b32 v2, 4, v2
    s_mov_b32 s40, 13123584
    buffer_load_dwordx4 v[164:167], v2, s[44:47], s40 offen
    s_cmp_lg_u32 s21, 0
    s_cbranch_scc1 LT_noearly
    s_lshr_b32 s36, s2, 5
    s_lshl_b32 s37, s36, 2
    s_lshr_b32 s39, s24, 3
    s_add_u32 s37, s37, s39
    s_and_b32 s38, s24, 7
    s_mul_i32 s40, s37, 81920
    s_mul_i32 s41, s38, 160
    s_add_u32 s40, s40, s41
    s_add_u32 s41, s40, 10485760
    buffer_load_dwordx2 v[128:129], v148, s[48:51], s40 offen
    buffer_load_dwordx2 v[138:139], v148, s[44:47], s41 offen
    buffer_load_dwordx2 v[130:131], v149, s[48:51], s40 offen
    buffer_load_dwordx2 v[140:141], v149, s[44:47], s41 offen
    buffer_load_dwordx2 v[132:133], v150, s[48:51], s40 offen
    buffer_load_dwordx2 v[142:143], v150, s[44:47], s41 offen
    buffer_load_dwordx2 v[134:135], v151, s[48:51], s40 offen
    buffer_load_dwordx2 v[144:145], v151, s[44:47], s41 offen
    buffer_load_dwordx2 v[136:137], v152, s[48:51], s40 offen
    buffer_load_dwordx2 v[146:147], v152, s[44:47], s41 offen
    s_and_b32 s39, s25, 3
    s_lshl_b32 s40, s39, 2
    v_mov_b32 v1, s40
    v_mov_b32 v3, -1
    ds_write_b32 v1, v3
    v_mov_b32 v1, 0
LT_fl:
    ds_read_b128 v[96:99], v1
    s_waitcnt lgkmcnt(0)
    v_and_b32 v96, v96, v97
    v_and_b32 v98, v98, v99
    v_and_b32 v96, v96, v98
    s_nop 0
    v_readfirstlane_b32 s40, v96
    s_nop 3
    s_cmp_eq_u32 s40, -1
    s_cbranch_scc1 LT_fl_ok
    s_sleep 2
    s_branch LT_fl
LT_fl_ok:
    s_mul_i32 s40, s38, 102400
    s_add_u32 s40, s40, 13631488
    s_add_u32 s41, s39, 1
    s_lshl_b32 s41, s41, 10
LT_dma0:
    s_mov_b32 m0, s41
    s_add_u32 s42, s40, s41
    buffer_load_dwordx4 v2, s[44:47], s42 offen lds
    s_add_u32 s41, s41, 4096
    s_cmp_lt_u32 s41, 81920
    s_cbranch_scc1 LT_dma0
LT_noearly:
    s_barrier
    s_and_b32 s26, s25, 3
    s_lshl_b32 s26, s26, 13
    s_lshl_b32 s27, s21, 12
    s_add_u32 s27, s27, s26
    s_add_u32 s27, s27, 131072
    s_xor_b32 s26, s27, 4096
    v_and_b32 v24, 63, v0
    v_lshl_add_u32 v30, v24, 4, s27
    v_lshl_add_u32 v31, v24, 4, s26
    s_cmp_eq_u32 s21, 0
    s_cbranch_scc0 LA_up
    ds_write_b128 v30, v[80:83] offset:0
    ds_write_b128 v30, v[84:87] offset:1024
    ds_write_b128 v30, v[88:91] offset:2048
    ds_write_b128 v30, v[92:95] offset:3072
    s_branch LA_xch
LA_up:
    ds_write_b128 v30, v[64:67] offset:0
    ds_write_b128 v30, v[68:71] offset:1024
    ds_write_b128 v30, v[72:75] offset:2048
    ds_write_b128 v30, v[76:79] offset:3072
    s_waitcnt lgkmcnt(0)
    v_mov_b32 v64, v80
    v_mov_b32 v65, v81
    v_mov_b32 v66, v82
    v_mov_b32 v67, v83
    v_mov_b32 v68, v84
    v_mov_b32 v69, v85
    v_mov_b32 v70, v86
    v_mov_b32 v71, v87
    v_mov_b32 v72, v88
    v_mov_b32 v73, v89
    v_mov_b32 v74, v90
    v_mov_b32 v75, v91
    v_mov_b32 v76, v92
    v_mov_b32 v4, v8
    v_mov_b32 v5, v9
    v_mov_b32 v6, v10
    v_mov_b32 v7, v11
    v_mov_b32 v12, v14
    v_mov_b32 v13, v15
LA_xch:
    s_waitcnt lgkmcnt(0)
    s_barrier
    ds_read_b128 v[32:35], v31 offset:0
    ds_read_b128 v[36:39], v31 offset:1024
    ds_read_b128 v[40:43], v31 offset:2048
    ds_read_b128 v[44:47], v31 offset:3072
    s_waitcnt lgkmcnt(0)
    v_add_f32 v64, v64, v32
    v_add_f32 v65, v65, v33
    v_add_f32 v66, v66, v34
    v_add_f32 v67, v67, v35
    v_add_f32 v68, v68, v36
    v_add_f32 v69, v69, v37
    v_add_f32 v70, v70, v38
    v_add_f32 v71, v71, v39
    v_add_f32 v72, v72, v40
    v_add_f32 v73, v73, v41
    v_add_f32 v74, v74, v42
    v_add_f32 v75, v75, v43
    v_add_f32 v76, v76, v44
    v_add_f32 v24, |v64|, |v65|
    v_add_f32 v24, v24, |v66|
    v_add_f32 v24, v24, |v67|
    v_add_f32 v24, v24, |v68|
    v_add_f32 v24, v24, |v69|
    v_add_f32 v24, v24, |v70|
    v_add_f32 v24, v24, |v71|
    v_add_f32 v24, v24, |v72|
    v_add_f32 v24, v24, |v73|
    v_add_f32 v24, v24, |v74|
    v_add_f32 v24, v24, |v75|
    v_add_f32 v24, v24, |v76|
    v_mov_b32 v25, 0x7f000000
    v_cmp_lt_f32 vcc, v24, v25
    v_mov_b32 v25, 0x03800000
    v_cmp_gt_f32 s[28:29], v76, v25
    s_nop 4
    s_and_b64 vcc, vcc, s[28:29]
    s_cmp_eq_u64 vcc, exec
    s_cbranch_scc0 LA_fallback
LA_epi:
    v_rcp_f32 v24, v76
    s_nop 0
    v_mul_f32 v64, v64, v24
    v_mul_f32 v65, v65, v24
    v_mul_f32 v66, v66, v24
    v_mul_f32 v67, v67, v24
    v_mul_f32 v68, v68, v24
    v_mul_f32 v69, v69, v24
    v_mul_f32 v70, v70, v24
    v_mul_f32 v71, v71, v24
    v_mul_f32 v72, v72, v24
    v_mul_f32 v73, v73, v24
    v_mul_f32 v74, v74, v24
    v_mul_f32 v75, v75, v24
    v_cvt_pk_bf16_f32 v16, v64, v65
    v_cvt_pk_bf16_f32 v17, v66, v67
    v_cvt_pk_bf16_f32 v18, v68, v69
    v_cvt_pk_bf16_f32 v19, v70, v71
    v_cvt_pk_bf16_f32 v20, v72, v73
    v_cvt_pk_bf16_f32 v21, v74, v75
    s_lshl_b32 s26, s25, 6
    s_lshl_b32 s27, s21, 5
    s_add_u32 s26, s26, s27
    v_add_u32 v29, s26, v26
    v_lshrrev_b32 v30, 4, v29
    v_mul_u32_u24 v30, 20480, v30
    v_and_b32 v29, 15, v29
    v_lshl_add_u32 v30, v29, 4, v30
    s_mul_i32 s26, s24, 5
    v_add_u32 v29, s26, v27
    v_lshrrev_b32 v31, 1, v29
    v_lshl_add_u32 v31, v31, 8, v30
    v_and_b32 v25, 1, v29
    v_lshl_add_u32 v31, v25, 3, v31
    buffer_store_dwordx2 v[16:17], v31, s[12:15], 0 offen sc1
    v_add_u32 v29, 2, v29
    v_lshrrev_b32 v31, 1, v29
    v_lshl_add_u32 v31, v31, 8, v30
    v_and_b32 v25, 1, v29
    v_lshl_add_u32 v31, v25, 3, v31
    buffer_store_dwordx2 v[18:19], v31, s[12:15], 0 offen sc1
    v_add_u32 v29, 2, v29
    v_lshrrev_b32 v31, 1, v29
    v_lshl_add_u32 v31, v31, 8, v30
    v_and_b32 v25, 1, v29
    v_lshl_add_u32 v31, v25, 3, v31
    s_mov_b32 exec_hi, 0
    buffer_store_dwordx2 v[20:21], v31, s[12:15], 0 offen sc1
    s_branch LT_start
LA_fallback:
    s_waitcnt vmcnt(0) lgkmcnt(0)
    v_and_b32 v24, 63, v0
    v_lshlrev_b32 v1, 4, v24
    v_lshlrev_b32 v2, 3, v26
    v_add_u32 v2, 1024, v2
    v_mul_u32_u24 v3, 20, v27
    v_add_u32 v3, v3, v26
    v_lshlrev_b32 v3, 4, v3
    v_add_u32 v3, 1280, v3
    v_cmp_eq_u32 vcc, 0, v27
    v_mov_b32 v30, 0xff800000
    s_nop 0
    v_cndmask_b32 v12, 0, v12, vcc
    s_mov_b32 s16, 0
    s_mov_b32 s20, 64
LA_fb1:
    buffer_load_dwordx4 v[96:99], v1, s[4:7], s16 offen
    s_mov_b32 exec_hi, 0
    buffer_load_dwordx2 v[108:109], v2, s[4:7], s16 offen
    s_mov_b32 exec_hi, -1
    s_waitcnt vmcnt(0)
    v_mfma_f32_32x32x16_bf16 v[32:47], v[96:99], v[4:7], 0
    v_mfma_f32_32x32x8_bf16 v[32:47], v[108:109], v[12:13], v[32:47]
    s_nop 11
    v_max3_f32 v30, v30, v32, v33
    v_max3_f32 v30, v30, v34, v35
    v_max3_f32 v30, v30, v36, v37
    v_max3_f32 v30, v30, v38, v39
    v_max3_f32 v30, v30, v40, v41
    v_max3_f32 v30, v30, v42, v43
    v_max3_f32 v30, v30, v44, v45
    v_max3_f32 v30, v30, v46, v47
    s_add_u32 s16, s16, 2560
    s_sub_u32 s20, s20, 1
    s_cmp_lg_u32 s20, 0
    s_nop 7
    s_cbranch_scc1 LA_fb1
    v_mov_b32 v31, v30
    s_nop 1
    v_permlane32_swap_b32 v30, v31
    v_max_f32 v30, v30, v31
    v_mov_b32 v64, 0
    v_mov_b32 v65, 0
    v_mov_b32 v66, 0
    v_mov_b32 v67, 0
    v_mov_b32 v68, 0
    v_mov_b32 v69, 0
    v_mov_b32 v70, 0
    v_mov_b32 v71, 0
    v_mov_b32 v72, 0
    v_mov_b32 v73, 0
    v_mov_b32 v74, 0
    v_mov_b32 v75, 0
    v_mov_b32 v76, 0
    v_mov_b32 v77, 0
    v_mov_b32 v78, 0
    v_mov_b32 v79, 0
    s_mov_b32 s16, 0
    s_mov_b32 s20, 64
LA_fb2:
    buffer_load_dwordx4 v[96:99], v1, s[4:7], s16 offen
    s_mov_b32 exec_hi, 0
    buffer_load_dwordx2 v[108:109], v2, s[4:7], s16 offen
    s_mov_b32 exec_hi, -1
    s_mov_b64 exec, s[18:19]
    buffer_load_dwordx4 v[100:103], v3, s[4:7], s16 offen
    buffer_load_dwordx4 v[104:107], v3, s[4:7], s16 offen offset:640
    s_mov_b64 exec, -1
    s_waitcnt vmcnt(0)
    v_mfma_f32_32x32x16_bf16 v[32:47], v[96:99], v[4:7], 0
    v_mfma_f32_32x32x8_bf16 v[32:47], v[108:109], v[12:13], v[32:47]
    s_nop 11
    v_sub_f32 v32, v32, v30
    v_exp_f32 v32, v32
    v_sub_f32 v33, v33, v30
    v_exp_f32 v33, v33
    v_sub_f32 v34, v34, v30
    v_exp_f32 v34, v34
    v_sub_f32 v35, v35, v30
    v_exp_f32 v35, v35
    v_sub_f32 v36, v36, v30
    v_exp_f32 v36, v36
    v_sub_f32 v37, v37, v30
    v_exp_f32 v37, v37
    v_sub_f32 v38, v38, v30
    v_exp_f32 v38, v38
    v_sub_f32 v39, v39, v30
    v_exp_f32 v39, v39
    v_sub_f32 v40, v40, v30
    v_exp_f32 v40, v40
    v_sub_f32 v41, v41, v30
    v_exp_f32 v41, v41
    v_sub_f32 v42, v42, v30
    v_exp_f32 v42, v42
    v_sub_f32 v43, v43, v30
    v_exp_f32 v43, v43
    v_sub_f32 v44, v44, v30
    v_exp_f32 v44, v44
    v_sub_f32 v45, v45, v30
    v_exp_f32 v45, v45
    v_sub_f32 v46, v46, v30
    v_exp_f32 v46, v46
    v_sub_f32 v47, v47, v30
    v_exp_f32 v47, v47
    v_cvt_pk_bf16_f32 v16, v32, v33
    v_cvt_pk_bf16_f32 v17, v34, v35
    v_cvt_pk_bf16_f32 v18, v36, v37
    v_cvt_pk_bf16_f32 v19, v38, v39
    v_cvt_pk_bf16_f32 v20, v40, v41
    v_cvt_pk_bf16_f32 v21, v42, v43
    v_cvt_pk_bf16_f32 v22, v44, v45
    v_cvt_pk_bf16_f32 v23, v46, v47
    v_mfma_f32_32x32x16_bf16 v[64:79], v[100:103], v[16:19], v[64:79]
    s_nop 0
    v_mfma_f32_32x32x16_bf16 v[64:79], v[104:107], v[20:23], v[64:79]
    s_add_u32 s16, s16, 2560
    s_sub_u32 s20, s20, 1
    s_cmp_lg_u32 s20, 0
    s_nop 15
    s_cbranch_scc1 LA_fb2
    s_nop 15
    s_branch LA_epi
LT_start:
    s_mov_b64 exec, -1
    v_and_b32 v1, 63, v0
    v_lshrrev_b32 v4, 6, v0
    v_and_b32 v2, 15, v0
    v_bfe_u32 v3, v0, 4, 2
    v_readfirstlane_b32 s18, v4
    v_lshlrev_b32 v5, 4, v1
    s_lshr_b32 s26, s2, 5
    s_mov_b32 s27, s24
    s_mov_b32 s20, 0
    s_mov_b32 s19, 0
    s_mov_b32 s58, 0
    s_waitcnt vmcnt(3)
    v_max_u32 v8, v164, v166
    v_min_u32 v9, v164, v166
    v_max3_u32 v9, v9, v165, v167
    v_mov_b32 v10, v8
    s_nop 1
    v_max_u32_dpp v10, v10, v10 row_ror:8 row_mask:0xf bank_mask:0xf
    s_nop 1
    v_max_u32_dpp v10, v10, v10 row_ror:4 row_mask:0xf bank_mask:0xf
    s_nop 1
    v_max_u32_dpp v10, v10, v10 row_ror:2 row_mask:0xf bank_mask:0xf
    s_nop 1
    v_max_u32_dpp v10, v10, v10 row_ror:1 row_mask:0xf bank_mask:0xf
    s_nop 0
    v_readlane_b32 s4, v10, 0
    v_readlane_b32 s5, v10, 16
    v_readlane_b32 s6, v10, 32
    v_readlane_b32 s7, v10, 48
    s_nop 1
    s_max_u32 s4, s4, s5
    s_max_u32 s6, s6, s7
    s_max_u32 s38, s4, s6
    v_cmp_eq_u32 vcc, s38, v8
    s_nop 1
    v_cndmask_b32 v8, v8, v9, vcc
    v_mov_b32 v10, v8
    s_nop 1
    v_max_u32_dpp v10, v10, v10 row_ror:8 row_mask:0xf bank_mask:0xf
    s_nop 1
    v_max_u32_dpp v10, v10, v10 row_ror:4 row_mask:0xf bank_mask:0xf
    s_nop 1
    v_max_u32_dpp v10, v10, v10 row_ror:2 row_mask:0xf bank_mask:0xf
    s_nop 1
    v_max_u32_dpp v10, v10, v10 row_ror:1 row_mask:0xf bank_mask:0xf
    s_nop 0
    v_readlane_b32 s4, v10, 0
    v_readlane_b32 s5, v10, 16
    v_readlane_b32 s6, v10, 32
    v_readlane_b32 s7, v10, 48
    s_nop 1
    s_max_u32 s4, s4, s5
    s_max_u32 s6, s6, s7
    s_max_u32 s39, s4, s6
    s_and_b32 s38, s38, 0x7ff
    s_sub_u32 s38, 2047, s38
    s_and_b32 s39, s39, 0x7ff
    s_sub_u32 s39, 2047, s39
    s_lshl_b32 s16, s26, 2
    s_lshr_b32 s4, s27, 3
    s_add_u32 s16, s16, s4
    s_and_b32 s17, s27, 7
    s_mul_i32 s10, s16, 81920
    s_mul_i32 s6, s17, 160
    s_add_u32 s10, s10, s6
    s_waitcnt vmcnt(0)
    s_barrier
    s_cmp_eq_u32 s18, 7
    s_cbranch_scc1 LT_arr
    s_mul_i32 s4, s17, 102400
    s_add_u32 s4, s4, 13631488
    s_add_u32 s5, s18, 79
LT_dma1:
    s_cmp_eq_u32 s5, 79
    s_cselect_b32 s7, 0, s5
    s_lshl_b32 s7, s7, 10
    s_mov_b32 m0, s7
    s_add_u32 s6, s4, s7
    buffer_load_dwordx4 v5, s[44:47], s6 offen lds
    s_add_u32 s5, s5, 7
    s_cmp_lt_u32 s5, 100
    s_cbranch_scc1 LT_dma1
    s_branch LT_join
LT_arr:
    s_lshl_b32 s4, s26, 10
    s_add_u32 s4, s4, 13139968
    s_lshl_b32 s5, 1, s27
    v_mov_b32 v6, s4
    v_mov_b32 v7, s5
    s_mov_b64 exec, 1
    buffer_atomic_or v7, v6, s[44:47], 0 offen sc0
    s_waitcnt vmcnt(0)
    s_mov_b64 exec, -1
    v_readfirstlane_b32 s4, v7
    s_nop 3
    s_or_b32 s4, s4, s5
    s_cmp_eq_u32 s4, -1
    s_cselect_b32 s19, 1, 0
    s_branch LT_join
LT_item:
    s_lshl_b32 s16, s26, 2
    s_lshr_b32 s4, s27, 3
    s_add_u32 s16, s16, s4
    s_and_b32 s17, s27, 7
    s_mul_i32 s4, s17, 102400
    s_add_u32 s4, s4, 13631488
    s_lshl_b32 s5, s18, 10
LT_dma:
    s_mov_b32 m0, s5
    s_add_u32 s6, s4, s5
    buffer_load_dwordx4 v5, s[44:47], s6 offen lds
    s_add_u32 s5, s5, 8192
    s_cmp_lt_u32 s5, 102400
    s_cbranch_scc1 LT_dma
    s_mul_i32 s10, s16, 81920
    s_mul_i32 s6, s17, 160
    s_add_u32 s10, s10, s6
    s_cmp_ge_u32 s18, 4
    s_cbranch_scc1 LT_join
    s_mul_i32 s10, s16, 81920
    s_mul_i32 s6, s17, 160
    s_add_u32 s10, s10, s6
    s_add_u32 s6, s10, 10485760
    buffer_load_dwordx2 v[128:129], v148, s[48:51], s10 offen
    buffer_load_dwordx2 v[138:139], v148, s[44:47], s6 offen
    buffer_load_dwordx2 v[130:131], v149, s[48:51], s10 offen
    buffer_load_dwordx2 v[140:141], v149, s[44:47], s6 offen
    buffer_load_dwordx2 v[132:133], v150, s[48:51], s10 offen
    buffer_load_dwordx2 v[142:143], v150, s[44:47], s6 offen
    buffer_load_dwordx2 v[134:135], v151, s[48:51], s10 offen
    buffer_load_dwordx2 v[144:145], v151, s[44:47], s6 offen
    buffer_load_dwordx2 v[136:137], v152, s[48:51], s10 offen
    buffer_load_dwordx2 v[146:147], v152, s[44:47], s6 offen
LT_join:
    s_lshr_b32 s4, s38, 6
    s_lshr_b32 s5, s39, 6
    s_cmp_eq_u32 s4, s16
    s_cselect_b32 s36, 1, 0
    s_cmp_eq_u32 s5, s16
    s_cselect_b32 s36, 1, s36
    s_cmp_lg_u32 s18, 7
    s_cbranch_scc1 LT_dec_done
    s_mov_b32 s37, 1
    s_lshl_b32 s59, s26, 10
    s_add_u32 s59, s59, 13139968
    s_add_u32 s60, s59, 512
    s_mov_b32 s61, 168
    s_mov_b32 s5, 4000
    s_cmp_lg_u32 s20, 0
    s_cbranch_scc1 LT_py
    s_cmp_eq_u32 s19, 0
    s_cbranch_scc1 LT_pq
    v_mov_b32 v6, s60
    v_mov_b32 v7, 0
    s_mov_b64 exec, 1
    buffer_atomic_or v7, v6, s[44:47], 0 offen sc0
    s_waitcnt vmcnt(0)
    s_mov_b64 exec, -1
    v_readfirstlane_b32 s58, v7
    s_nop 3
    s_branch LT_py
LT_pq:
    v_mov_b32 v6, s59
    v_mov_b32 v7, 0
    s_mov_b64 exec, 1
    buffer_atomic_or v7, v6, s[44:47], 0 offen sc0
    s_waitcnt vmcnt(0)
    s_mov_b64 exec, -1
    v_readfirstlane_b32 s6, v7
    s_nop 3
    s_cmp_eq_u32 s6, -1
    s_cbranch_scc1 LT_py
    s_sleep 2
    s_sub_u32 s5, s5, 1
    s_cmp_lg_u32 s5, 0
    s_cbranch_scc1 LT_pq
LT_giveup:
    s_lshl_b32 s7, 1, s27
    v_mov_b32 v6, s60
    v_mov_b32 v7, s7
    s_mov_b64 exec, 1
    buffer_atomic_or v7, v6, s[44:47], 0 offen sc0
    s_waitcnt vmcnt(0)
    s_mov_b64 exec, -1
    v_readfirstlane_b32 s6, v7
    s_nop 3
    v_mov_b32 v6, s59
    v_mov_b32 v7, 0
    s_mov_b64 exec, 1
    buffer_atomic_or v7, v6, s[44:47], 0 offen sc0
    s_waitcnt vmcnt(0)
    s_mov_b64 exec, -1
    v_readfirstlane_b32 s6, v7
    s_nop 3
    s_mov_b32 s5, 0x7fffffff
    s_cmp_eq_u32 s6, -1
    s_cbranch_scc1 LT_py
    s_mov_b32 s37, 0
    s_branch LT_dec_wr
LT_py:
    s_cmp_eq_u32 s36, 0
    s_cbranch_scc1 LT_dec_wr
LT_py2:
    v_mov_b32 v6, s61
    v_mov_b32 v7, 0
    s_mov_b64 exec, 1
    buffer_atomic_add v7, v6, s[32:35], 0 offen sc0
    s_waitcnt vmcnt(0)
    s_mov_b64 exec, -1
    v_readfirstlane_b32 s6, v7
    s_nop 3
    s_cmp_ge_u32 s6, 10
    s_cbranch_scc1 LT_dec_wr
    s_sleep 8
    s_branch LT_py2
LT_dec_wr:
    s_cmp_lg_u32 s58, 0
    s_cselect_b32 s4, 2, 0
    s_or_b32 s4, s4, s37
    v_mov_b32 v7, s4
    v_mov_b32 v6, 110592
    ds_write_b32 v6, v7
LT_dec_done:
    s_waitcnt vmcnt(0) lgkmcnt(0)
    s_barrier
    v_mov_b32 v6, 110592
    ds_read_b32 v7, v6
    s_waitcnt lgkmcnt(0)
    v_readfirstlane_b32 s4, v7
    s_nop 3
    s_lshr_b32 s62, s4, 1
    s_bitcmp0_b32 s4, 0
    s_cbranch_scc1 LT_exit
    s_and_b32 s4, s18, 3
    s_lshr_b32 s5, s18, 2
    s_lshl_b32 s6, s16, 2
    s_lshl_b32 s7, s5, 1
    s_add_u32 s6, s6, s7
    s_mul_i32 s6, s6, 20480
    s_mul_i32 s7, s4, 5120
    s_add_u32 s6, s6, s7
    s_add_u32 s6, s6, 7864320
    s_add_u32 s7, s6, 20480
    s_add_u32 s8, s6, 4096
    s_add_u32 s9, s7, 4096
    buffer_load_dwordx4 v[48:51], v5, s[44:47], s6 offen offset:0 sc1
    buffer_load_dwordx4 v[52:55], v5, s[44:47], s7 offen offset:0 sc1
    buffer_load_dwordx4 v[56:59], v5, s[44:47], s6 offen offset:1024 sc1
    buffer_load_dwordx4 v[60:63], v5, s[44:47], s7 offen offset:1024 sc1
    buffer_load_dwordx4 v[64:67], v5, s[44:47], s6 offen offset:2048 sc1
    buffer_load_dwordx4 v[68:71], v5, s[44:47], s7 offen offset:2048 sc1
    buffer_load_dwordx4 v[72:75], v5, s[44:47], s6 offen offset:3072 sc1
    buffer_load_dwordx4 v[76:79], v5, s[44:47], s7 offen offset:3072 sc1
    buffer_load_dwordx4 v[80:83], v5, s[44:47], s8 offen offset:0 sc1
    buffer_load_dwordx4 v[84:87], v5, s[44:47], s9 offen offset:0 sc1
    s_cmp_eq_u32 s36, 0
    s_cbranch_scc1 LT_noy
    s_cmp_ge_u32 s18, 4
    s_cbranch_scc1 LT_noy
    v_mov_b32 v12, 0
    v_mov_b32 v13, 0
    v_mov_b32 v14, 0
    v_mov_b32 v15, 0
    v_mov_b32 v16, 0
    v_mov_b32 v17, 0
    v_mov_b32 v18, 0
    v_mov_b32 v19, 0
    v_mov_b32 v20, 0
    v_mov_b32 v21, 0
    v_mov_b32 v22, 0
    v_mov_b32 v23, 0
    v_mov_b32 v24, 0
    v_mov_b32 v25, 0
    v_mov_b32 v26, 0
    v_mov_b32 v27, 0
    v_mov_b32 v28, 0
    v_mov_b32 v29, 0
    v_mov_b32 v30, 0
    v_mov_b32 v31, 0
    s_lshr_b32 s6, s38, 6
    s_cmp_lg_u32 s6, s16
    s_cbranch_scc1 LT_ny0
    s_and_b32 s6, s38, 63
    s_mul_i32 s7, s17, 320
    s_add_u32 s7, s7, 13500416
    s_mul_i32 s8, s6, 2560
    v_lshlrev_b32 v6, 1, v148
    v_subrev_u32 v6, s8, v6
    v_cmp_eq_u32 vcc, s6, v158
    s_and_saveexec_b64 s[56:57], vcc
    s_cbranch_execz LT_sk0_0
    buffer_load_dwordx4 v[12:15], v6, s[44:47], s7 offen sc1
LT_sk0_0:
    s_mov_b64 exec, s[56:57]
    v_lshlrev_b32 v6, 1, v149
    v_subrev_u32 v6, s8, v6
    v_cmp_eq_u32 vcc, s6, v159
    s_and_saveexec_b64 s[56:57], vcc
    s_cbranch_execz LT_sk0_1
    buffer_load_dwordx4 v[16:19], v6, s[44:47], s7 offen sc1
LT_sk0_1:
    s_mov_b64 exec, s[56:57]
    v_lshlrev_b32 v6, 1, v150
    v_subrev_u32 v6, s8, v6
    v_cmp_eq_u32 vcc, s6, v160
    s_and_saveexec_b64 s[56:57], vcc
    s_cbranch_execz LT_sk0_2
    buffer_load_dwordx4 v[20:23], v6, s[44:47], s7 offen sc1
LT_sk0_2:
    s_mov_b64 exec, s[56:57]
    v_lshlrev_b32 v6, 1, v151
    v_subrev_u32 v6, s8, v6
    v_cmp_eq_u32 vcc, s6, v161
    s_and_saveexec_b64 s[56:57], vcc
    s_cbranch_execz LT_sk0_3
    buffer_load_dwordx4 v[24:27], v6, s[44:47], s7 offen sc1
LT_sk0_3:
    s_mov_b64 exec, s[56:57]
    v_lshlrev_b32 v6, 1, v152
    v_subrev_u32 v6, s8, v6
    v_cmp_eq_u32 vcc, s6, v162
    s_and_saveexec_b64 s[56:57], vcc
    s_cbranch_execz LT_sk0_4
    buffer_load_dwordx4 v[28:31], v6, s[44:47], s7 offen sc1
LT_sk0_4:
    s_mov_b64 exec, s[56:57]
LT_ny0:
    s_lshr_b32 s6, s39, 6
    s_cmp_lg_u32 s6, s16
    s_cbranch_scc1 LT_ny1
    s_and_b32 s6, s39, 63
    s_mul_i32 s7, s17, 320
    s_add_u32 s7, s7, 13502976
    s_mul_i32 s8, s6, 2560
    v_lshlrev_b32 v6, 1, v148
    v_subrev_u32 v6, s8, v6
    v_cmp_eq_u32 vcc, s6, v158
    s_and_saveexec_b64 s[56:57], vcc
    s_cbranch_execz LT_sk1_0
    buffer_load_dwordx4 v[12:15], v6, s[44:47], s7 offen sc1
LT_sk1_0:
    s_mov_b64 exec, s[56:57]
    v_lshlrev_b32 v6, 1, v149
    v_subrev_u32 v6, s8, v6
    v_cmp_eq_u32 vcc, s6, v159
    s_and_saveexec_b64 s[56:57], vcc
    s_cbranch_execz LT_sk1_1
    buffer_load_dwordx4 v[16:19], v6, s[44:47], s7 offen sc1
LT_sk1_1:
    s_mov_b64 exec, s[56:57]
    v_lshlrev_b32 v6, 1, v150
    v_subrev_u32 v6, s8, v6
    v_cmp_eq_u32 vcc, s6, v160
    s_and_saveexec_b64 s[56:57], vcc
    s_cbranch_execz LT_sk1_2
    buffer_load_dwordx4 v[20:23], v6, s[44:47], s7 offen sc1
LT_sk1_2:
    s_mov_b64 exec, s[56:57]
    v_lshlrev_b32 v6, 1, v151
    v_subrev_u32 v6, s8, v6
    v_cmp_eq_u32 vcc, s6, v161
    s_and_saveexec_b64 s[56:57], vcc
    s_cbranch_execz LT_sk1_3
    buffer_load_dwordx4 v[24:27], v6, s[44:47], s7 offen sc1
LT_sk1_3:
    s_mov_b64 exec, s[56:57]
    v_lshlrev_b32 v6, 1, v152
    v_subrev_u32 v6, s8, v6
    v_cmp_eq_u32 vcc, s6, v162
    s_and_saveexec_b64 s[56:57], vcc
    s_cbranch_execz LT_sk1_4
    buffer_load_dwordx4 v[28:31], v6, s[44:47], s7 offen sc1
LT_sk1_4:
    s_mov_b64 exec, s[56:57]
LT_ny1:
    s_waitcnt vmcnt(0)
LT_noy:
    s_mul_i32 s6, s4, 25600
    v_add_u32 v6, s6, v5
    ds_read_b128 v[32:35], v6 offset:0
    ds_read_b128 v[36:39], v6 offset:1024
    ds_read_b128 v[40:43], v6 offset:2048
    ds_read_b128 v[44:47], v6 offset:3072
    s_waitcnt vmcnt(8) lgkmcnt(3)
    v_mfma_f32_16x16x32_bf16 v[88:91], v[32:35], v[48:51], 0
    v_mfma_f32_16x16x32_bf16 v[108:111], v[32:35], v[52:55], 0
    ds_read_b128 v[32:35], v6 offset:4096
    s_waitcnt lgkmcnt(3)
    v_mfma_f32_16x16x32_bf16 v[92:95], v[36:39], v[48:51], 0
    v_mfma_f32_16x16x32_bf16 v[112:115], v[36:39], v[52:55], 0
    ds_read_b128 v[36:39], v6 offset:5120
    s_waitcnt lgkmcnt(3)
    v_mfma_f32_16x16x32_bf16 v[96:99], v[40:43], v[48:51], 0
    v_mfma_f32_16x16x32_bf16 v[116:119], v[40:43], v[52:55], 0
    ds_read_b128 v[40:43], v6 offset:6144
    s_waitcnt lgkmcnt(3)
    v_mfma_f32_16x16x32_bf16 v[100:103], v[44:47], v[48:51], 0
    v_mfma_f32_16x16x32_bf16 v[120:123], v[44:47], v[52:55], 0
    ds_read_b128 v[44:47], v6 offset:7168
    s_waitcnt lgkmcnt(3)
    v_mfma_f32_16x16x32_bf16 v[104:107], v[32:35], v[48:51], 0
    v_mfma_f32_16x16x32_bf16 v[124:127], v[32:35], v[52:55], 0
    ds_read_b128 v[32:35], v6 offset:8192
    s_waitcnt vmcnt(6) lgkmcnt(3)
    v_mfma_f32_16x16x32_bf16 v[88:91], v[36:39], v[56:59], v[88:91]
    v_mfma_f32_16x16x32_bf16 v[108:111], v[36:39], v[60:63], v[108:111]
    ds_read_b128 v[36:39], v6 offset:9216
    s_waitcnt lgkmcnt(3)
    v_mfma_f32_16x16x32_bf16 v[92:95], v[40:43], v[56:59], v[92:95]
    v_mfma_f32_16x16x32_bf16 v[112:115], v[40:43], v[60:63], v[112:115]
    ds_read_b128 v[40:43], v6 offset:10240
    s_waitcnt lgkmcnt(3)
    v_mfma_f32_16x16x32_bf16 v[96:99], v[44:47], v[56:59], v[96:99]
    v_mfma_f32_16x16x32_bf16 v[116:119], v[44:47], v[60:63], v[116:119]
    ds_read_b128 v[44:47], v6 offset:11264
    s_waitcnt lgkmcnt(3)
    v_mfma_f32_16x16x32_bf16 v[100:103], v[32:35], v[56:59], v[100:103]
    v_mfma_f32_16x16x32_bf16 v[120:123], v[32:35], v[60:63], v[120:123]
    ds_read_b128 v[32:35], v6 offset:12288
    s_waitcnt lgkmcnt(3)
    v_mfma_f32_16x16x32_bf16 v[104:107], v[36:39], v[56:59], v[104:107]
    v_mfma_f32_16x16x32_bf16 v[124:127], v[36:39], v[60:63], v[124:127]
    ds_read_b128 v[36:39], v6 offset:13312
    s_waitcnt vmcnt(4) lgkmcnt(3)
    v_mfma_f32_16x16x32_bf16 v[88:91], v[40:43], v[64:67], v[88:91]
    v_mfma_f32_16x16x32_bf16 v[108:111], v[40:43], v[68:71], v[108:111]
    ds_read_b128 v[40:43], v6 offset:14336
    s_waitcnt lgkmcnt(3)
    v_mfma_f32_16x16x32_bf16 v[92:95], v[44:47], v[64:67], v[92:95]
    v_mfma_f32_16x16x32_bf16 v[112:115], v[44:47], v[68:71], v[112:115]
    ds_read_b128 v[44:47], v6 offset:15360
    s_waitcnt lgkmcnt(3)
    v_mfma_f32_16x16x32_bf16 v[96:99], v[32:35], v[64:67], v[96:99]
    v_mfma_f32_16x16x32_bf16 v[116:119], v[32:35], v[68:71], v[116:119]
    ds_read_b128 v[32:35], v6 offset:16384
    s_waitcnt lgkmcnt(3)
    v_mfma_f32_16x16x32_bf16 v[100:103], v[36:39], v[64:67], v[100:103]
    v_mfma_f32_16x16x32_bf16 v[120:123], v[36:39], v[68:71], v[120:123]
    ds_read_b128 v[36:39], v6 offset:17408
    s_waitcnt lgkmcnt(3)
    v_mfma_f32_16x16x32_bf16 v[104:107], v[40:43], v[64:67], v[104:107]
    v_mfma_f32_16x16x32_bf16 v[124:127], v[40:43], v[68:71], v[124:127]
    ds_read_b128 v[40:43], v6 offset:18432
    s_waitcnt vmcnt(2) lgkmcnt(3)
    v_mfma_f32_16x16x32_bf16 v[88:91], v[44:47], v[72:75], v[88:91]
    v_mfma_f32_16x16x32_bf16 v[108:111], v[44:47], v[76:79], v[108:111]
    ds_read_b128 v[44:47], v6 offset:19456
    s_waitcnt lgkmcnt(3)
    v_mfma_f32_16x16x32_bf16 v[92:95], v[32:35], v[72:75], v[92:95]
    v_mfma_f32_16x16x32_bf16 v[112:115], v[32:35], v[76:79], v[112:115]
    ds_read_b128 v[32:35], v6 offset:20480
    s_waitcnt lgkmcnt(3)
    v_mfma_f32_16x16x32_bf16 v[96:99], v[36:39], v[72:75], v[96:99]
    v_mfma_f32_16x16x32_bf16 v[116:119], v[36:39], v[76:79], v[116:119]
    ds_read_b128 v[36:39], v6 offset:21504
    s_waitcnt lgkmcnt(3)
    v_mfma_f32_16x16x32_bf16 v[100:103], v[40:43], v[72:75], v[100:103]
    v_mfma_f32_16x16x32_bf16 v[120:123], v[40:43], v[76:79], v[120:123]
    ds_read_b128 v[40:43], v6 offset:22528
    s_waitcnt lgkmcnt(3)
    v_mfma_f32_16x16x32_bf16 v[104:107], v[44:47], v[72:75], v[104:107]
    v_mfma_f32_16x16x32_bf16 v[124:127], v[44:47], v[76:79], v[124:127]
    ds_read_b128 v[44:47], v6 offset:23552
    s_waitcnt vmcnt(0) lgkmcnt(3)
    v_mfma_f32_16x16x32_bf16 v[88:91], v[32:35], v[80:83], v[88:91]
    v_mfma_f32_16x16x32_bf16 v[108:111], v[32:35], v[84:87], v[108:111]
    ds_read_b128 v[32:35], v6 offset:24576
    s_waitcnt lgkmcnt(3)
    v_mfma_f32_16x16x32_bf16 v[92:95], v[36:39], v[80:83], v[92:95]
    v_mfma_f32_16x16x32_bf16 v[112:115], v[36:39], v[84:87], v[112:115]
    s_waitcnt lgkmcnt(2)
    v_mfma_f32_16x16x32_bf16 v[96:99], v[40:43], v[80:83], v[96:99]
    v_mfma_f32_16x16x32_bf16 v[116:119], v[40:43], v[84:87], v[116:119]
    s_waitcnt lgkmcnt(1)
    v_mfma_f32_16x16x32_bf16 v[100:103], v[44:47], v[80:83], v[100:103]
    v_mfma_f32_16x16x32_bf16 v[120:123], v[44:47], v[84:87], v[120:123]
    s_waitcnt lgkmcnt(0)
    v_mfma_f32_16x16x32_bf16 v[104:107], v[32:35], v[80:83], v[104:107]
    v_mfma_f32_16x16x32_bf16 v[124:127], v[32:35], v[84:87], v[124:127]
    s_mul_i32 s6, s4, 21504
    s_mul_i32 s7, s5, 10752
    s_add_u32 s6, s6, s7
    v_mul_u32_u24 v6, 336, v2
    v_lshl_add_u32 v6, v3, 4, v6
    v_add_u32 v6, s6, v6
    s_barrier
    ds_write_b128 v6, v[88:91] offset:0
    ds_write_b128 v6, v[92:95] offset:64
    ds_write_b128 v6, v[96:99] offset:128
    ds_write_b128 v6, v[100:103] offset:192
    ds_write_b128 v6, v[104:107] offset:256
    ds_write_b128 v6, v[108:111] offset:5376
    ds_write_b128 v6, v[112:115] offset:5440
    ds_write_b128 v6, v[116:119] offset:5504
    ds_write_b128 v6, v[120:123] offset:5568
    ds_write_b128 v6, v[124:127] offset:5632
    s_waitcnt lgkmcnt(0)
    s_barrier
    s_cmp_ge_u32 s18, 4
    s_cbranch_scc1 LT_done
    ds_read_b128 v[48:51], v153 offset:0
    ds_read_b128 v[52:55], v153 offset:21504
    ds_read_b128 v[56:59], v153 offset:43008
    ds_read_b128 v[60:63], v153 offset:64512
    ds_read_b128 v[64:67], v154 offset:0
    ds_read_b128 v[68:71], v154 offset:21504
    ds_read_b128 v[72:75], v154 offset:43008
    ds_read_b128 v[76:79], v154 offset:64512
    ds_read_b128 v[80:83], v155 offset:0
    ds_read_b128 v[84:87], v155 offset:21504
    ds_read_b128 v[88:91], v155 offset:43008
    ds_read_b128 v[92:95], v155 offset:64512
    ds_read_b128 v[96:99], v156 offset:0
    ds_read_b128 v[100:103], v156 offset:21504
    ds_read_b128 v[104:107], v156 offset:43008
    ds_read_b128 v[108:111], v156 offset:64512
    ds_read_b128 v[112:115], v157 offset:0
    ds_read_b128 v[116:119], v157 offset:21504
    ds_read_b128 v[120:123], v157 offset:43008
    ds_read_b128 v[124:127], v157 offset:64512
    s_waitcnt lgkmcnt(15)
    v_add_f32 v48, v48, v52
    v_add_f32 v56, v56, v60
    v_add_f32 v48, v48, v56
    v_cvt_pk_bf16_f32 v48, 0, v48
    v_add_f32 v49, v49, v53
    v_add_f32 v57, v57, v61
    v_add_f32 v49, v49, v57
    v_cvt_pk_bf16_f32 v49, 0, v49
    v_add_f32 v50, v50, v54
    v_add_f32 v58, v58, v62
    v_add_f32 v50, v50, v58
    v_cvt_pk_bf16_f32 v50, 0, v50
    v_add_f32 v51, v51, v55
    v_add_f32 v59, v59, v63
    v_add_f32 v51, v51, v59
    v_cvt_pk_bf16_f32 v51, 0, v51
    v_lshlrev_b32 v52, 16, v128
    v_and_b32 v53, 0xffff0000, v128
    v_lshlrev_b32 v56, 16, v138
    v_and_b32 v57, 0xffff0000, v138
    v_lshlrev_b32 v54, 16, v129
    v_and_b32 v55, 0xffff0000, v129
    v_lshlrev_b32 v58, 16, v139
    v_and_b32 v59, 0xffff0000, v139
    v_add_f32 v48, v48, v52
    v_cvt_pk_bf16_f32 v48, 0, v48
    v_add_f32 v49, v49, v53
    v_cvt_pk_bf16_f32 v49, 0, v49
    v_add_f32 v50, v50, v54
    v_cvt_pk_bf16_f32 v50, 0, v50
    v_add_f32 v51, v51, v55
    v_cvt_pk_bf16_f32 v51, 0, v51
    s_waitcnt lgkmcnt(12)
    v_add_f32 v64, v64, v68
    v_add_f32 v72, v72, v76
    v_add_f32 v64, v64, v72
    v_cvt_pk_bf16_f32 v64, 0, v64
    v_add_f32 v65, v65, v69
    v_add_f32 v73, v73, v77
    v_add_f32 v65, v65, v73
    v_cvt_pk_bf16_f32 v65, 0, v65
    v_add_f32 v66, v66, v70
    v_add_f32 v74, v74, v78
    v_add_f32 v66, v66, v74
    v_cvt_pk_bf16_f32 v66, 0, v66
    v_add_f32 v67, v67, v71
    v_add_f32 v75, v75, v79
    v_add_f32 v67, v67, v75
    v_cvt_pk_bf16_f32 v67, 0, v67
    v_lshlrev_b32 v68, 16, v130
    v_and_b32 v69, 0xffff0000, v130
    v_lshlrev_b32 v72, 16, v140
    v_and_b32 v73, 0xffff0000, v140
    v_lshlrev_b32 v70, 16, v131
    v_and_b32 v71, 0xffff0000, v131
    v_lshlrev_b32 v74, 16, v141
    v_and_b32 v75, 0xffff0000, v141
    v_add_f32 v64, v64, v68
    v_cvt_pk_bf16_f32 v64, 0, v64
    v_add_f32 v65, v65, v69
    v_cvt_pk_bf16_f32 v65, 0, v65
    v_add_f32 v66, v66, v70
    v_cvt_pk_bf16_f32 v66, 0, v66
    v_add_f32 v67, v67, v71
    v_cvt_pk_bf16_f32 v67, 0, v67
    s_waitcnt lgkmcnt(8)
    v_add_f32 v80, v80, v84
    v_add_f32 v88, v88, v92
    v_add_f32 v80, v80, v88
    v_cvt_pk_bf16_f32 v80, 0, v80
    v_add_f32 v81, v81, v85
    v_add_f32 v89, v89, v93
    v_add_f32 v81, v81, v89
    v_cvt_pk_bf16_f32 v81, 0, v81
    v_add_f32 v82, v82, v86
    v_add_f32 v90, v90, v94
    v_add_f32 v82, v82, v90
    v_cvt_pk_bf16_f32 v82, 0, v82
    v_add_f32 v83, v83, v87
    v_add_f32 v91, v91, v95
    v_add_f32 v83, v83, v91
    v_cvt_pk_bf16_f32 v83, 0, v83
    v_lshlrev_b32 v84, 16, v132
    v_and_b32 v85, 0xffff0000, v132
    v_lshlrev_b32 v88, 16, v142
    v_and_b32 v89, 0xffff0000, v142
    v_lshlrev_b32 v86, 16, v133
    v_and_b32 v87, 0xffff0000, v133
    v_lshlrev_b32 v90, 16, v143
    v_and_b32 v91, 0xffff0000, v143
    v_add_f32 v80, v80, v84
    v_cvt_pk_bf16_f32 v80, 0, v80
    v_add_f32 v81, v81, v85
    v_cvt_pk_bf16_f32 v81, 0, v81
    v_add_f32 v82, v82, v86
    v_cvt_pk_bf16_f32 v82, 0, v82
    v_add_f32 v83, v83, v87
    v_cvt_pk_bf16_f32 v83, 0, v83
    s_waitcnt lgkmcnt(4)
    v_add_f32 v96, v96, v100
    v_add_f32 v104, v104, v108
    v_add_f32 v96, v96, v104
    v_cvt_pk_bf16_f32 v96, 0, v96
    v_add_f32 v97, v97, v101
    v_add_f32 v105, v105, v109
    v_add_f32 v97, v97, v105
    v_cvt_pk_bf16_f32 v97, 0, v97
    v_add_f32 v98, v98, v102
    v_add_f32 v106, v106, v110
    v_add_f32 v98, v98, v106
    v_cvt_pk_bf16_f32 v98, 0, v98
    v_add_f32 v99, v99, v103
    v_add_f32 v107, v107, v111
    v_add_f32 v99, v99, v107
    v_cvt_pk_bf16_f32 v99, 0, v99
    v_lshlrev_b32 v100, 16, v134
    v_and_b32 v101, 0xffff0000, v134
    v_lshlrev_b32 v104, 16, v144
    v_and_b32 v105, 0xffff0000, v144
    v_lshlrev_b32 v102, 16, v135
    v_and_b32 v103, 0xffff0000, v135
    v_lshlrev_b32 v106, 16, v145
    v_and_b32 v107, 0xffff0000, v145
    v_add_f32 v96, v96, v100
    v_cvt_pk_bf16_f32 v96, 0, v96
    v_add_f32 v97, v97, v101
    v_cvt_pk_bf16_f32 v97, 0, v97
    v_add_f32 v98, v98, v102
    v_cvt_pk_bf16_f32 v98, 0, v98
    v_add_f32 v99, v99, v103
    v_cvt_pk_bf16_f32 v99, 0, v99
    s_waitcnt lgkmcnt(0)
    v_add_f32 v112, v112, v116
    v_add_f32 v120, v120, v124
    v_add_f32 v112, v112, v120
    v_cvt_pk_bf16_f32 v112, 0, v112
    v_add_f32 v113, v113, v117
    v_add_f32 v121, v121, v125
    v_add_f32 v113, v113, v121
    v_cvt_pk_bf16_f32 v113, 0, v113
    v_add_f32 v114, v114, v118
    v_add_f32 v122, v122, v126
    v_add_f32 v114, v114, v122
    v_cvt_pk_bf16_f32 v114, 0, v114
    v_add_f32 v115, v115, v119
    v_add_f32 v123, v123, v127
    v_add_f32 v115, v115, v123
    v_cvt_pk_bf16_f32 v115, 0, v115
    v_lshlrev_b32 v116, 16, v136
    v_and_b32 v117, 0xffff0000, v136
    v_lshlrev_b32 v120, 16, v146
    v_and_b32 v121, 0xffff0000, v146
    v_lshlrev_b32 v118, 16, v137
    v_and_b32 v119, 0xffff0000, v137
    v_lshlrev_b32 v122, 16, v147
    v_and_b32 v123, 0xffff0000, v147
    v_add_f32 v112, v112, v116
    v_cvt_pk_bf16_f32 v112, 0, v112
    v_add_f32 v113, v113, v117
    v_cvt_pk_bf16_f32 v113, 0, v113
    v_add_f32 v114, v114, v118
    v_cvt_pk_bf16_f32 v114, 0, v114
    v_add_f32 v115, v115, v119
    v_cvt_pk_bf16_f32 v115, 0, v115
    s_cmp_eq_u32 s36, 0
    s_cbranch_scc1 LT_fin
    v_add_f32 v56, v56, v12
    v_cvt_pk_bf16_f32 v56, 0, v56
    v_add_f32 v57, v57, v13
    v_cvt_pk_bf16_f32 v57, 0, v57
    v_add_f32 v58, v58, v14
    v_cvt_pk_bf16_f32 v58, 0, v58
    v_add_f32 v59, v59, v15
    v_cvt_pk_bf16_f32 v59, 0, v59
    v_add_f32 v72, v72, v16
    v_cvt_pk_bf16_f32 v72, 0, v72
    v_add_f32 v73, v73, v17
    v_cvt_pk_bf16_f32 v73, 0, v73
    v_add_f32 v74, v74, v18
    v_cvt_pk_bf16_f32 v74, 0, v74
    v_add_f32 v75, v75, v19
    v_cvt_pk_bf16_f32 v75, 0, v75
    v_add_f32 v88, v88, v20
    v_cvt_pk_bf16_f32 v88, 0, v88
    v_add_f32 v89, v89, v21
    v_cvt_pk_bf16_f32 v89, 0, v89
    v_add_f32 v90, v90, v22
    v_cvt_pk_bf16_f32 v90, 0, v90
    v_add_f32 v91, v91, v23
    v_cvt_pk_bf16_f32 v91, 0, v91
    v_add_f32 v104, v104, v24
    v_cvt_pk_bf16_f32 v104, 0, v104
    v_add_f32 v105, v105, v25
    v_cvt_pk_bf16_f32 v105, 0, v105
    v_add_f32 v106, v106, v26
    v_cvt_pk_bf16_f32 v106, 0, v106
    v_add_f32 v107, v107, v27
    v_cvt_pk_bf16_f32 v107, 0, v107
    v_add_f32 v120, v120, v28
    v_cvt_pk_bf16_f32 v120, 0, v120
    v_add_f32 v121, v121, v29
    v_cvt_pk_bf16_f32 v121, 0, v121
    v_add_f32 v122, v122, v30
    v_cvt_pk_bf16_f32 v122, 0, v122
    v_add_f32 v123, v123, v31
    v_cvt_pk_bf16_f32 v123, 0, v123
LT_fin:
    v_add_f32 v48, v48, v56
    v_add_f32 v49, v49, v57
    v_add_f32 v50, v50, v58
    v_add_f32 v51, v51, v59
    v_cvt_pk_bf16_f32 v52, v48, v49
    v_cvt_pk_bf16_f32 v53, v50, v51
    buffer_store_dwordx2 v[52:53], v148, s[52:55], s10 offen
    v_add_f32 v64, v64, v72
    v_add_f32 v65, v65, v73
    v_add_f32 v66, v66, v74
    v_add_f32 v67, v67, v75
    v_cvt_pk_bf16_f32 v68, v64, v65
    v_cvt_pk_bf16_f32 v69, v66, v67
    buffer_store_dwordx2 v[68:69], v149, s[52:55], s10 offen
    v_add_f32 v80, v80, v88
    v_add_f32 v81, v81, v89
    v_add_f32 v82, v82, v90
    v_add_f32 v83, v83, v91
    v_cvt_pk_bf16_f32 v84, v80, v81
    v_cvt_pk_bf16_f32 v85, v82, v83
    buffer_store_dwordx2 v[84:85], v150, s[52:55], s10 offen
    v_add_f32 v96, v96, v104
    v_add_f32 v97, v97, v105
    v_add_f32 v98, v98, v106
    v_add_f32 v99, v99, v107
    v_cvt_pk_bf16_f32 v100, v96, v97
    v_cvt_pk_bf16_f32 v101, v98, v99
    buffer_store_dwordx2 v[100:101], v151, s[52:55], s10 offen
    v_add_f32 v112, v112, v120
    v_add_f32 v113, v113, v121
    v_add_f32 v114, v114, v122
    v_add_f32 v115, v115, v123
    v_cvt_pk_bf16_f32 v116, v112, v113
    v_cvt_pk_bf16_f32 v117, v114, v115
    buffer_store_dwordx2 v[116:117], v152, s[52:55], s10 offen
LT_done:
    s_cmp_eq_u32 s62, 0
    s_cbranch_scc1 LT_exit
    s_cmp_lg_u32 s18, 7
    s_cbranch_scc1 LT_st_done
    s_ff1_i32_b32 s8, s58
    s_bitset0_b32 s58, s8
    v_mov_b32 v7, s8
    v_mov_b32 v6, 110608
    ds_write_b32 v6, v7
LT_st_done:
    s_waitcnt vmcnt(0) lgkmcnt(0)
    s_barrier
    v_mov_b32 v6, 110608
    ds_read_b32 v7, v6
    s_waitcnt lgkmcnt(0)
    v_readfirstlane_b32 s27, v7
    s_nop 3
    s_cmp_eq_i32 s27, -1
    s_cbranch_scc1 LT_exit
    s_mov_b32 s20, 1
    s_branch LT_item
LT_exit:
    s_endpgm
LH_start:
    s_setprio 2
    s_load_dwordx4 s[44:47], s[0:1], 40
    s_load_dwordx2 s[48:49], s[0:1], 56
    s_load_dwordx2 s[50:51], s[0:1], 16
    s_load_dwordx4 s[52:55], s[0:1], 72
    v_and_b32 v1, 63, v0
    v_and_b32 v2, 15, v0
    v_bfe_u32 v3, v0, 4, 2
    s_mov_b32 s68, 0x05040100
    s_mov_b32 s69, 0x07060302
    v_mul_u32_u24 v16, 27648, v3
    v_lshl_add_u32 v16, v2, 3, v16
    v_and_b32 v4, 1, v3
    v_lshrrev_b32 v5, 1, v3
    v_lshl_add_u32 v4, v4, 5, v5
    v_mul_u32_u24 v17, 1280, v4
    v_lshl_add_u32 v17, v2, 3, v17
    v_and_b32 v4, 1, v2
    v_lshlrev_b32 v4, 5, v4
    v_lshl_add_u32 v4, v3, 2, v4
    v_lshlrev_b32 v19, 2, v4
    v_lshlrev_b32 v6, 4, v1
    v_cmp_gt_u32 s[42:43], 2, v2
    v_mul_u32_u24 v7, 10240, v3
    v_lshl_add_u32 v7, v2, 1, v7
    s_waitcnt lgkmcnt(0)
    s_mov_b32 s8, s44
    s_mov_b32 s9, s45
    s_mov_b32 s10, 2211840
    s_mov_b32 s11, 0x00020000
    s_mov_b32 s12, s46
    s_mov_b32 s13, s47
    s_mov_b32 s14, 2211840
    s_mov_b32 s15, 0x00020000
    s_mov_b32 s16, s48
    s_mov_b32 s17, s49
    s_mov_b32 s18, 2211840
    s_mov_b32 s19, 0x00020000
    s_mov_b32 s60, s50
    s_mov_b32 s61, s51
    s_mov_b32 s62, 819200
    s_mov_b32 s63, 0x00020000
    s_mov_b32 s56, s52
    s_mov_b32 s57, s53
    s_mov_b32 s58, 256
    s_mov_b32 s59, 0x00020000
    s_mov_b32 s4, s54
    s_mov_b32 s5, s55
    s_mov_b32 s6, 16777216
    s_mov_b32 s7, 0x00020000
    s_and_b32 s24, s2, 7
    s_bfe_u32 s25, s2, 0x20003
    s_lshl_b32 s24, s24, 2
    s_add_u32 s24, s24, s25
    s_mul_i32 s24, s24, 163840
    s_add_u32 s36, s54, s24
    s_addc_u32 s37, s55, 0
    s_mov_b32 s38, 163840
    s_mov_b32 s39, 0x00020000
    s_mov_b32 s24, 16384
    s_barrier
LH_dma:
    s_add_u32 s25, s24, 0
    s_mov_b32 m0, s25
    s_nop 0
    buffer_load_dwordx4 v6, s[36:39], s25 offen offset:0 lds
    buffer_load_dwordx4 v6, s[36:39], s25 offen offset:1024 lds
    buffer_load_dwordx4 v6, s[36:39], s25 offen offset:2048 lds
    buffer_load_dwordx4 v6, s[36:39], s25 offen offset:3072 lds
    s_add_u32 s25, s24, 81920
    s_mov_b32 m0, s25
    s_nop 0
    buffer_load_dwordx4 v6, s[36:39], s25 offen offset:0 lds
    buffer_load_dwordx4 v6, s[36:39], s25 offen offset:1024 lds
    buffer_load_dwordx4 v6, s[36:39], s25 offen offset:2048 lds
    buffer_load_dwordx4 v6, s[36:39], s25 offen offset:3072 lds
    s_add_u32 s24, s24, 4096
    s_cmp_lt_u32 s24, 81920
    s_cbranch_scc1 LH_dma
    s_waitcnt vmcnt(0)
    s_barrier
    s_mov_b32 s24, 13123584
    buffer_load_dwordx4 v[56:59], v6, s[4:7], s24 offen
    s_waitcnt vmcnt(0)
    v_max_u32 v4, v56, v58
    v_min_u32 v5, v56, v58
    v_max3_u32 v5, v5, v57, v59
    v_mov_b32 v8, v4
    s_nop 1
    v_max_u32_dpp v8, v8, v8 row_ror:8 row_mask:0xf bank_mask:0xf
    s_nop 1
    v_max_u32_dpp v8, v8, v8 row_ror:4 row_mask:0xf bank_mask:0xf
    s_nop 1
    v_max_u32_dpp v8, v8, v8 row_ror:2 row_mask:0xf bank_mask:0xf
    s_nop 1
    v_max_u32_dpp v8, v8, v8 row_ror:1 row_mask:0xf bank_mask:0xf
    s_nop 0
    v_readlane_b32 s24, v8, 0
    v_readlane_b32 s25, v8, 16
    v_readlane_b32 s26, v8, 32
    v_readlane_b32 s27, v8, 48
    s_nop 1
    s_max_u32 s24, s24, s25
    s_max_u32 s26, s26, s27
    s_max_u32 s20, s24, s26
    v_cmp_eq_u32 vcc, s20, v4
    s_nop 1
    v_cndmask_b32 v4, v4, v5, vcc
    v_mov_b32 v8, v4
    s_nop 1
    v_max_u32_dpp v8, v8, v8 row_ror:8 row_mask:0xf bank_mask:0xf
    s_nop 1
    v_max_u32_dpp v8, v8, v8 row_ror:4 row_mask:0xf bank_mask:0xf
    s_nop 1
    v_max_u32_dpp v8, v8, v8 row_ror:2 row_mask:0xf bank_mask:0xf
    s_nop 1
    v_max_u32_dpp v8, v8, v8 row_ror:1 row_mask:0xf bank_mask:0xf
    s_nop 0
    v_readlane_b32 s24, v8, 0
    v_readlane_b32 s25, v8, 16
    v_readlane_b32 s26, v8, 32
    v_readlane_b32 s27, v8, 48
    s_nop 1
    s_max_u32 s24, s24, s25
    s_max_u32 s26, s26, s27
    s_max_u32 s21, s24, s26
    s_and_b32 s22, s20, 0x7ff
    s_sub_u32 s22, 2047, s22
    s_and_b32 s23, s21, 0x7ff
    s_sub_u32 s23, 2047, s23
    v_and_b32 v4, 1, v2
    v_cmp_eq_u32 vcc, 1, v4
    v_mov_b32 v4, s22
    v_mov_b32 v5, s23
    v_cndmask_b32 v4, v4, v5, vcc
    v_mul_u32_u24 v18, 0x500, v4
    v_lshl_add_u32 v18, v3, 4, v18
    s_cmp_lg_u32 s2, 0
    s_cbranch_scc1 LH_nohdr
    v_mov_b32 v8, s22
    v_mov_b32 v9, s23
    v_mov_b32 v10, 13172736
    s_mov_b64 exec, 1
    buffer_store_dwordx2 v[8:9], v10, s[4:7], 0 offen
    s_mov_b64 exec, -1
LH_nohdr:
    s_mov_b32 s32, s2
    s_add_u32 s33, s2, 1
    s_min_u32 s33, s33, 216
    s_mov_b32 s34, 0
    s_mov_b32 s35, s2
LH_gloop:
    s_cmp_ge_u32 s32, s33
    s_cbranch_scc1 LH_gdone
    s_bitcmp1_b32 s32, 2
    s_cselect_b32 s36, s12, s8
    s_cselect_b32 s37, s13, s9
    s_mov_b32 s38, 2211840
    s_mov_b32 s39, 0x00020000
    s_and_b32 s24, s32, 3
    s_lshr_b32 s25, s32, 3
    s_mul_i32 s26, s24, 552960
    s_lshl_b32 s27, s25, 7
    s_add_u32 s26, s26, s27
    s_mul_i32 s27, s24, 320
    s_add_u32 s27, s27, 10485760
    s_waitcnt vmcnt(0)
    buffer_load_dwordx4 v[36:39], v18, s[4:7], s27 offen offset:0
    buffer_load_dwordx4 v[40:43], v18, s[4:7], s27 offen offset:64
    buffer_load_dwordx4 v[44:47], v18, s[4:7], s27 offen offset:128
    buffer_load_dwordx4 v[48:51], v18, s[4:7], s27 offen offset:192
    buffer_load_dwordx4 v[52:55], v18, s[4:7], s27 offen offset:256
    buffer_load_dwordx2 v[64:65], v16, s[36:39], s26 offen
    buffer_load_dwordx2 v[66:67], v16, s[36:39], s26 offen offset:3456
    s_add_u32 s26, s26, 6912
    buffer_load_dwordx2 v[68:69], v16, s[36:39], s26 offen
    buffer_load_dwordx2 v[70:71], v16, s[36:39], s26 offen offset:3456
    s_add_u32 s26, s26, 6912
    buffer_load_dwordx2 v[72:73], v16, s[36:39], s26 offen
    buffer_load_dwordx2 v[74:75], v16, s[36:39], s26 offen offset:3456
    s_add_u32 s26, s26, 6912
    buffer_load_dwordx2 v[76:77], v16, s[36:39], s26 offen
    buffer_load_dwordx2 v[78:79], v16, s[36:39], s26 offen offset:3456
    s_add_u32 s26, s26, 89856
    buffer_load_dwordx2 v[80:81], v16, s[36:39], s26 offen
    buffer_load_dwordx2 v[82:83], v16, s[36:39], s26 offen offset:3456
    s_add_u32 s26, s26, 6912
    buffer_load_dwordx2 v[84:85], v16, s[36:39], s26 offen
    buffer_load_dwordx2 v[86:87], v16, s[36:39], s26 offen offset:3456
    s_add_u32 s26, s26, 6912
    buffer_load_dwordx2 v[88:89], v16, s[36:39], s26 offen
    buffer_load_dwordx2 v[90:91], v16, s[36:39], s26 offen offset:3456
    s_add_u32 s26, s26, 6912
    buffer_load_dwordx2 v[92:93], v16, s[36:39], s26 offen
    buffer_load_dwordx2 v[94:95], v16, s[36:39], s26 offen offset:3456
    s_add_u32 s26, s26, 89856
    buffer_load_dwordx2 v[96:97], v16, s[36:39], s26 offen
    buffer_load_dwordx2 v[98:99], v16, s[36:39], s26 offen offset:3456
    s_add_u32 s26, s26, 6912
    buffer_load_dwordx2 v[100:101], v16, s[36:39], s26 offen
    buffer_load_dwordx2 v[102:103], v16, s[36:39], s26 offen offset:3456
    s_add_u32 s26, s26, 6912
    buffer_load_dwordx2 v[104:105], v16, s[36:39], s26 offen
    buffer_load_dwordx2 v[106:107], v16, s[36:39], s26 offen offset:3456
    s_add_u32 s26, s26, 6912
    buffer_load_dwordx2 v[108:109], v16, s[36:39], s26 offen
    buffer_load_dwordx2 v[110:111], v16, s[36:39], s26 offen offset:3456
    s_add_u32 s26, s26, 89856
    buffer_load_dwordx2 v[112:113], v16, s[36:39], s26 offen
    buffer_load_dwordx2 v[114:115], v16, s[36:39], s26 offen offset:3456
    s_add_u32 s26, s26, 6912
    buffer_load_dwordx2 v[116:117], v16, s[36:39], s26 offen
    buffer_load_dwordx2 v[118:119], v16, s[36:39], s26 offen offset:3456
    s_add_u32 s26, s26, 6912
    buffer_load_dwordx2 v[120:121], v16, s[36:39], s26 offen
    buffer_load_dwordx2 v[122:123], v16, s[36:39], s26 offen offset:3456
    s_add_u32 s26, s26, 6912
    buffer_load_dwordx2 v[124:125], v16, s[36:39], s26 offen
    buffer_load_dwordx2 v[126:127], v16, s[36:39], s26 offen offset:3456
    s_add_u32 s26, s26, 89856
    s_waitcnt vmcnt(24)
    v_perm_b32 v56, v66, v64, s68
    v_perm_b32 v57, v70, v68, s68
    v_perm_b32 v58, v74, v72, s68
    v_perm_b32 v59, v78, v76, s68
    v_perm_b32 v60, v66, v64, s69
    v_perm_b32 v61, v70, v68, s69
    v_perm_b32 v62, v74, v72, s69
    v_perm_b32 v63, v78, v76, s69
    v_mfma_f32_16x16x32_bf16 v[20:23], v[56:59], v[36:39], 0
    s_nop 0
    v_mfma_f32_16x16x32_bf16 v[24:27], v[60:63], v[36:39], 0
    v_perm_b32 v56, v67, v65, s68
    v_perm_b32 v57, v71, v69, s68
    v_perm_b32 v58, v75, v73, s68
    v_perm_b32 v59, v79, v77, s68
    v_perm_b32 v60, v67, v65, s69
    v_perm_b32 v61, v71, v69, s69
    v_perm_b32 v62, v75, v73, s69
    v_perm_b32 v63, v79, v77, s69
    buffer_load_dwordx2 v[64:65], v16, s[36:39], s26 offen
    buffer_load_dwordx2 v[66:67], v16, s[36:39], s26 offen offset:3456
    s_add_u32 s26, s26, 6912
    buffer_load_dwordx2 v[68:69], v16, s[36:39], s26 offen
    buffer_load_dwordx2 v[70:71], v16, s[36:39], s26 offen offset:3456
    s_add_u32 s26, s26, 6912
    buffer_load_dwordx2 v[72:73], v16, s[36:39], s26 offen
    buffer_load_dwordx2 v[74:75], v16, s[36:39], s26 offen offset:3456
    s_add_u32 s26, s26, 6912
    buffer_load_dwordx2 v[76:77], v16, s[36:39], s26 offen
    buffer_load_dwordx2 v[78:79], v16, s[36:39], s26 offen offset:3456
    s_add_u32 s26, s26, 89856
    v_mfma_f32_16x16x32_bf16 v[28:31], v[56:59], v[36:39], 0
    v_mfma_f32_16x16x32_bf16 v[32:35], v[60:63], v[36:39], 0
    s_waitcnt vmcnt(24)
    v_perm_b32 v56, v82, v80, s68
    v_perm_b32 v57, v86, v84, s68
    v_perm_b32 v58, v90, v88, s68
    v_perm_b32 v59, v94, v92, s68
    v_perm_b32 v60, v82, v80, s69
    v_perm_b32 v61, v86, v84, s69
    v_perm_b32 v62, v90, v88, s69
    v_perm_b32 v63, v94, v92, s69
    v_mfma_f32_16x16x32_bf16 v[20:23], v[56:59], v[40:43], v[20:23]
    s_nop 0
    v_mfma_f32_16x16x32_bf16 v[24:27], v[60:63], v[40:43], v[24:27]
    v_perm_b32 v56, v83, v81, s68
    v_perm_b32 v57, v87, v85, s68
    v_perm_b32 v58, v91, v89, s68
    v_perm_b32 v59, v95, v93, s68
    v_perm_b32 v60, v83, v81, s69
    v_perm_b32 v61, v87, v85, s69
    v_perm_b32 v62, v91, v89, s69
    v_perm_b32 v63, v95, v93, s69
    v_mfma_f32_16x16x32_bf16 v[28:31], v[56:59], v[40:43], v[28:31]
    s_nop 0
    v_mfma_f32_16x16x32_bf16 v[32:35], v[60:63], v[40:43], v[32:35]
    s_waitcnt vmcnt(16)
    v_perm_b32 v56, v98, v96, s68
    v_perm_b32 v57, v102, v100, s68
    v_perm_b32 v58, v106, v104, s68
    v_perm_b32 v59, v110, v108, s68
    v_perm_b32 v60, v98, v96, s69
    v_perm_b32 v61, v102, v100, s69
    v_perm_b32 v62, v106, v104, s69
    v_perm_b32 v63, v110, v108, s69
    v_mfma_f32_16x16x32_bf16 v[20:23], v[56:59], v[44:47], v[20:23]
    s_nop 0
    v_mfma_f32_16x16x32_bf16 v[24:27], v[60:63], v[44:47], v[24:27]
    v_perm_b32 v56, v99, v97, s68
    v_perm_b32 v57, v103, v101, s68
    v_perm_b32 v58, v107, v105, s68
    v_perm_b32 v59, v111, v109, s68
    v_perm_b32 v60, v99, v97, s69
    v_perm_b32 v61, v103, v101, s69
    v_perm_b32 v62, v107, v105, s69
    v_perm_b32 v63, v111, v109, s69
    v_mfma_f32_16x16x32_bf16 v[28:31], v[56:59], v[44:47], v[28:31]
    s_nop 0
    v_mfma_f32_16x16x32_bf16 v[32:35], v[60:63], v[44:47], v[32:35]
    s_waitcnt vmcnt(8)
    v_perm_b32 v56, v114, v112, s68
    v_perm_b32 v57, v118, v116, s68
    v_perm_b32 v58, v122, v120, s68
    v_perm_b32 v59, v126, v124, s68
    v_perm_b32 v60, v114, v112, s69
    v_perm_b32 v61, v118, v116, s69
    v_perm_b32 v62, v122, v120, s69
    v_perm_b32 v63, v126, v124, s69
    v_mfma_f32_16x16x32_bf16 v[20:23], v[56:59], v[48:51], v[20:23]
    s_nop 0
    v_mfma_f32_16x16x32_bf16 v[24:27], v[60:63], v[48:51], v[24:27]
    v_perm_b32 v56, v115, v113, s68
    v_perm_b32 v57, v119, v117, s68
    v_perm_b32 v58, v123, v121, s68
    v_perm_b32 v59, v127, v125, s68
    v_perm_b32 v60, v115, v113, s69
    v_perm_b32 v61, v119, v117, s69
    v_perm_b32 v62, v123, v121, s69
    v_perm_b32 v63, v127, v125, s69
    v_mfma_f32_16x16x32_bf16 v[28:31], v[56:59], v[48:51], v[28:31]
    s_nop 0
    v_mfma_f32_16x16x32_bf16 v[32:35], v[60:63], v[48:51], v[32:35]
    s_waitcnt vmcnt(0)
    v_perm_b32 v56, v66, v64, s68
    v_perm_b32 v57, v70, v68, s68
    v_perm_b32 v58, v74, v72, s68
    v_perm_b32 v59, v78, v76, s68
    v_perm_b32 v60, v66, v64, s69
    v_perm_b32 v61, v70, v68, s69
    v_perm_b32 v62, v74, v72, s69
    v_perm_b32 v63, v78, v76, s69
    v_mfma_f32_16x16x32_bf16 v[20:23], v[56:59], v[52:55], v[20:23]
    s_nop 0
    v_mfma_f32_16x16x32_bf16 v[24:27], v[60:63], v[52:55], v[24:27]
    v_perm_b32 v56, v67, v65, s68
    v_perm_b32 v57, v71, v69, s68
    v_perm_b32 v58, v75, v73, s68
    v_perm_b32 v59, v79, v77, s68
    v_perm_b32 v60, v67, v65, s69
    v_perm_b32 v61, v71, v69, s69
    v_perm_b32 v62, v75, v73, s69
    v_perm_b32 v63, v79, v77, s69
    v_mfma_f32_16x16x32_bf16 v[28:31], v[56:59], v[52:55], v[28:31]
    s_nop 0
    v_mfma_f32_16x16x32_bf16 v[32:35], v[60:63], v[52:55], v[32:35]
    v_lshlrev_b32 v4, 8, v2
    v_lshl_add_u32 v4, v3, 4, v4
    s_lshl_b32 s26, s32, 9
    s_add_u32 s26, s26, 13176832
    s_nop 7
    s_mov_b64 exec, s[42:43]
    buffer_store_dwordx4 v[20:23], v4, s[4:7], s26 offen offset:0 sc1
    buffer_store_dwordx4 v[24:27], v4, s[4:7], s26 offen offset:64 sc1
    buffer_store_dwordx4 v[28:31], v4, s[4:7], s26 offen offset:128 sc1
    buffer_store_dwordx4 v[32:35], v4, s[4:7], s26 offen offset:192 sc1
    s_mov_b64 exec, -1
    s_waitcnt vmcnt(0)
    s_cmp_lg_u32 s34, 0
    s_cbranch_scc1 LH_nosig
    s_lshl_b32 s26, s25, 2
    v_mov_b32 v4, s26
    v_mov_b32 v5, 1
    s_mov_b64 exec, 1
    buffer_atomic_add v5, v4, s[56:59], 0 offen
    s_mov_b64 exec, -1
LH_nosig:
    s_add_u32 s32, s32, 1
    s_branch LH_gloop
LH_gdone:
    s_mul_i32 s40, s35, 6554
    s_lshr_b32 s40, s40, 16
    s_mul_i32 s41, s40, 10
    s_sub_u32 s41, s35, s41
    s_mul_i32 s26, s40, 81920
    s_lshl_b32 s27, s41, 7
    s_add_u32 s26, s26, s27
    s_waitcnt vmcnt(0)
    s_add_u32 s27, s26, 0
    buffer_load_dwordx2 v[64:65], v17, s[16:19], s27 offen
    s_add_u32 s27, s26, 5120
    buffer_load_dwordx2 v[66:67], v17, s[16:19], s27 offen
    s_add_u32 s27, s26, 10240
    buffer_load_dwordx2 v[68:69], v17, s[16:19], s27 offen
    s_add_u32 s27, s26, 15360
    buffer_load_dwordx2 v[70:71], v17, s[16:19], s27 offen
    s_add_u32 s27, s26, 20480
    buffer_load_dwordx2 v[72:73], v17, s[16:19], s27 offen
    s_add_u32 s27, s26, 25600
    buffer_load_dwordx2 v[74:75], v17, s[16:19], s27 offen
    s_add_u32 s27, s26, 30720
    buffer_load_dwordx2 v[76:77], v17, s[16:19], s27 offen
    s_add_u32 s27, s26, 35840
    buffer_load_dwordx2 v[78:79], v17, s[16:19], s27 offen
    s_add_u32 s27, s26, 2560
    buffer_load_dwordx2 v[80:81], v17, s[16:19], s27 offen
    s_add_u32 s27, s26, 7680
    buffer_load_dwordx2 v[82:83], v17, s[16:19], s27 offen
    s_add_u32 s27, s26, 12800
    buffer_load_dwordx2 v[84:85], v17, s[16:19], s27 offen
    s_add_u32 s27, s26, 17920
    buffer_load_dwordx2 v[86:87], v17, s[16:19], s27 offen
    s_add_u32 s27, s26, 23040
    buffer_load_dwordx2 v[88:89], v17, s[16:19], s27 offen
    s_add_u32 s27, s26, 28160
    buffer_load_dwordx2 v[90:91], v17, s[16:19], s27 offen
    s_add_u32 s27, s26, 33280
    buffer_load_dwordx2 v[92:93], v17, s[16:19], s27 offen
    s_add_u32 s27, s26, 38400
    buffer_load_dwordx2 v[94:95], v17, s[16:19], s27 offen
    s_cmp_lg_u32 s34, 0
    s_cbranch_scc1 LH_ready
    s_lshl_b32 s26, s40, 2
    v_mov_b32 v4, s26
    s_mov_b32 s27, 2000
LH_spin:
    v_mov_b32 v5, 0
    s_mov_b64 exec, 1
    buffer_atomic_add v5, v4, s[56:59], 0 offen sc0
    s_waitcnt vmcnt(0)
    s_mov_b64 exec, -1
    v_readfirstlane_b32 s26, v5
    s_nop 3
    s_cmp_ge_u32 s26, 8
    s_cbranch_scc1 LH_ready
    s_sleep 32
    s_sub_u32 s27, s27, 1
    s_cmp_lg_u32 s27, 0
    s_cbranch_scc1 LH_spin
    s_lshl_b32 s32, s40, 3
    s_add_u32 s33, s32, 8
    s_mov_b32 s34, 1
    s_branch LH_gloop
LH_ready:
    s_mov_b32 s34, 0
    v_lshlrev_b32 v4, 3, v1
    s_lshl_b32 s26, s40, 12
    s_add_u32 s26, s26, 13176832
    buffer_load_dwordx2 v[36:37], v4, s[4:7], s26 offen offset:0 sc1
    buffer_load_dwordx2 v[38:39], v4, s[4:7], s26 offen offset:512 sc1
    buffer_load_dwordx2 v[40:41], v4, s[4:7], s26 offen offset:1024 sc1
    buffer_load_dwordx2 v[42:43], v4, s[4:7], s26 offen offset:1536 sc1
    buffer_load_dwordx2 v[44:45], v4, s[4:7], s26 offen offset:2048 sc1
    buffer_load_dwordx2 v[46:47], v4, s[4:7], s26 offen offset:2560 sc1
    buffer_load_dwordx2 v[48:49], v4, s[4:7], s26 offen offset:3072 sc1
    buffer_load_dwordx2 v[50:51], v4, s[4:7], s26 offen offset:3584 sc1
    s_waitcnt vmcnt(0)
    v_add_f32 v36, v36, v38
    v_add_f32 v40, v40, v42
    v_add_f32 v36, v36, v40
    v_cvt_pk_bf16_f32 v36, 0, v36
    v_add_f32 v44, v44, v46
    v_add_f32 v48, v48, v50
    v_add_f32 v44, v44, v48
    v_cvt_pk_bf16_f32 v44, 0, v44
    v_mul_f32 v8, 0xbfb8aa3b, v36
    v_exp_f32 v8, v8
    s_nop 0
    v_add_f32 v8, 1.0, v8
    v_rcp_f32 v8, v8
    s_nop 0
    v_mul_f32 v8, v8, v36
    v_cvt_pk_bf16_f32 v8, 0, v8
    v_mul_f32 v8, v8, v44
    v_add_f32 v37, v37, v39
    v_add_f32 v41, v41, v43
    v_add_f32 v37, v37, v41
    v_cvt_pk_bf16_f32 v37, 0, v37
    v_add_f32 v45, v45, v47
    v_add_f32 v49, v49, v51
    v_add_f32 v45, v45, v49
    v_cvt_pk_bf16_f32 v45, 0, v45
    v_mul_f32 v9, 0xbfb8aa3b, v37
    v_exp_f32 v9, v9
    s_nop 0
    v_add_f32 v9, 1.0, v9
    v_rcp_f32 v9, v9
    s_nop 0
    v_mul_f32 v9, v9, v37
    v_cvt_pk_bf16_f32 v9, 0, v9
    v_mul_f32 v9, v9, v45
    v_cvt_pk_bf16_f32 v8, v8, v9
    ds_bpermute_b32 v36, v19, v8 offset:0
    ds_bpermute_b32 v37, v19, v8 offset:4
    ds_bpermute_b32 v38, v19, v8 offset:8
    ds_bpermute_b32 v39, v19, v8 offset:12
    ds_bpermute_b32 v40, v19, v8 offset:64
    ds_bpermute_b32 v41, v19, v8 offset:68
    ds_bpermute_b32 v42, v19, v8 offset:72
    ds_bpermute_b32 v43, v19, v8 offset:76
    v_mul_u32_u24 v4, 2560, v2
    v_lshl_add_u32 v4, v3, 4, v4
    s_mul_i32 s26, s40, 5120
    s_lshl_b32 s27, s41, 8
    s_add_u32 s26, s26, s27
    s_add_u32 s26, s26, 13303808
    s_waitcnt lgkmcnt(0)
    v_perm_b32 v56, v66, v64, s68
    v_perm_b32 v57, v70, v68, s68
    v_perm_b32 v58, v74, v72, s68
    v_perm_b32 v59, v78, v76, s68
    v_perm_b32 v60, v66, v64, s69
    v_perm_b32 v61, v70, v68, s69
    v_perm_b32 v62, v74, v72, s69
    v_perm_b32 v63, v78, v76, s69
    v_mfma_f32_16x16x32_bf16 v[20:23], v[56:59], v[36:39], 0
    s_nop 0
    v_mfma_f32_16x16x32_bf16 v[24:27], v[60:63], v[36:39], 0
    v_perm_b32 v56, v67, v65, s68
    v_perm_b32 v57, v71, v69, s68
    v_perm_b32 v58, v75, v73, s68
    v_perm_b32 v59, v79, v77, s68
    v_perm_b32 v60, v67, v65, s69
    v_perm_b32 v61, v71, v69, s69
    v_perm_b32 v62, v75, v73, s69
    v_perm_b32 v63, v79, v77, s69
    v_mfma_f32_16x16x32_bf16 v[28:31], v[56:59], v[36:39], 0
    s_nop 0
    v_mfma_f32_16x16x32_bf16 v[32:35], v[60:63], v[36:39], 0
    v_perm_b32 v56, v82, v80, s68
    v_perm_b32 v57, v86, v84, s68
    v_perm_b32 v58, v90, v88, s68
    v_perm_b32 v59, v94, v92, s68
    v_perm_b32 v60, v82, v80, s69
    v_perm_b32 v61, v86, v84, s69
    v_perm_b32 v62, v90, v88, s69
    v_perm_b32 v63, v94, v92, s69
    v_mfma_f32_16x16x32_bf16 v[20:23], v[56:59], v[40:43], v[20:23]
    s_nop 0
    v_mfma_f32_16x16x32_bf16 v[24:27], v[60:63], v[40:43], v[24:27]
    v_perm_b32 v56, v83, v81, s68
    v_perm_b32 v57, v87, v85, s68
    v_perm_b32 v58, v91, v89, s68
    v_perm_b32 v59, v95, v93, s68
    v_perm_b32 v60, v83, v81, s69
    v_perm_b32 v61, v87, v85, s69
    v_perm_b32 v62, v91, v89, s69
    v_perm_b32 v63, v95, v93, s69
    v_mfma_f32_16x16x32_bf16 v[28:31], v[56:59], v[40:43], v[28:31]
    s_nop 0
    v_mfma_f32_16x16x32_bf16 v[32:35], v[60:63], v[40:43], v[32:35]
    s_nop 7
    s_mov_b64 exec, s[42:43]
    buffer_store_dwordx4 v[20:23], v4, s[4:7], s26 offen offset:0 sc1
    buffer_store_dwordx4 v[24:27], v4, s[4:7], s26 offen offset:64 sc1
    buffer_store_dwordx4 v[28:31], v4, s[4:7], s26 offen offset:128 sc1
    buffer_store_dwordx4 v[32:35], v4, s[4:7], s26 offen offset:192 sc1
    s_mov_b64 exec, -1
    s_waitcnt vmcnt(0)
    s_lshl_b32 s26, s41, 2
    s_add_u32 s26, s26, 128
    v_mov_b32 v4, s26
    v_mov_b32 v5, 1
    s_mov_b64 exec, 1
    buffer_atomic_add v5, v4, s[56:59], 0 offen sc0
    s_waitcnt vmcnt(0)
    s_mov_b64 exec, -1
    v_readfirstlane_b32 s26, v5
    s_nop 3
    s_cmp_lg_u32 s26, 26
    s_cbranch_scc1 LH_next
    v_lshrrev_b32 v4, 5, v1
    v_mul_u32_u24 v7, 2560, v4
    v_and_b32 v6, 31, v1
    v_lshl_add_u32 v5, v6, 3, v7
    s_lshl_b32 s27, s41, 8
    s_add_u32 s26, s27, 13303808
    buffer_load_dwordx2 v[64:65], v5, s[4:7], s26 offen sc1
    s_add_u32 s26, s26, 5120
    buffer_load_dwordx2 v[66:67], v5, s[4:7], s26 offen sc1
    s_add_u32 s26, s26, 5120
    buffer_load_dwordx2 v[68:69], v5, s[4:7], s26 offen sc1
    s_add_u32 s26, s26, 5120
    buffer_load_dwordx2 v[70:71], v5, s[4:7], s26 offen sc1
    s_add_u32 s26, s26, 5120
    buffer_load_dwordx2 v[72:73], v5, s[4:7], s26 offen sc1
    s_add_u32 s26, s26, 5120
    buffer_load_dwordx2 v[74:75], v5, s[4:7], s26 offen sc1
    s_add_u32 s26, s26, 5120
    buffer_load_dwordx2 v[76:77], v5, s[4:7], s26 offen sc1
    s_add_u32 s26, s26, 5120
    buffer_load_dwordx2 v[78:79], v5, s[4:7], s26 offen sc1
    s_add_u32 s26, s26, 5120
    buffer_load_dwordx2 v[80:81], v5, s[4:7], s26 offen sc1
    s_add_u32 s26, s26, 5120
    buffer_load_dwordx2 v[82:83], v5, s[4:7], s26 offen sc1
    s_add_u32 s26, s26, 5120
    buffer_load_dwordx2 v[84:85], v5, s[4:7], s26 offen sc1
    s_add_u32 s26, s26, 5120
    buffer_load_dwordx2 v[86:87], v5, s[4:7], s26 offen sc1
    s_add_u32 s26, s26, 5120
    buffer_load_dwordx2 v[88:89], v5, s[4:7], s26 offen sc1
    s_add_u32 s26, s26, 5120
    buffer_load_dwordx2 v[90:91], v5, s[4:7], s26 offen sc1
    s_add_u32 s26, s26, 5120
    buffer_load_dwordx2 v[92:93], v5, s[4:7], s26 offen sc1
    s_add_u32 s26, s26, 5120
    buffer_load_dwordx2 v[94:95], v5, s[4:7], s26 offen sc1
    s_add_u32 s26, s26, 5120
    buffer_load_dwordx2 v[96:97], v5, s[4:7], s26 offen sc1
    s_add_u32 s26, s26, 5120
    buffer_load_dwordx2 v[98:99], v5, s[4:7], s26 offen sc1
    s_add_u32 s26, s26, 5120
    buffer_load_dwordx2 v[100:101], v5, s[4:7], s26 offen sc1
    s_add_u32 s26, s26, 5120
    buffer_load_dwordx2 v[102:103], v5, s[4:7], s26 offen sc1
    s_add_u32 s26, s26, 5120
    buffer_load_dwordx2 v[104:105], v5, s[4:7], s26 offen sc1
    s_add_u32 s26, s26, 5120
    buffer_load_dwordx2 v[106:107], v5, s[4:7], s26 offen sc1
    s_add_u32 s26, s26, 5120
    buffer_load_dwordx2 v[108:109], v5, s[4:7], s26 offen sc1
    s_add_u32 s26, s26, 5120
    buffer_load_dwordx2 v[110:111], v5, s[4:7], s26 offen sc1
    s_add_u32 s26, s26, 5120
    buffer_load_dwordx2 v[112:113], v5, s[4:7], s26 offen sc1
    s_add_u32 s26, s26, 5120
    buffer_load_dwordx2 v[114:115], v5, s[4:7], s26 offen sc1
    s_add_u32 s26, s26, 5120
    buffer_load_dwordx2 v[116:117], v5, s[4:7], s26 offen sc1
    s_add_u32 s26, s26, 5120
    v_bfe_u32 v10, v6, 1, 2
    v_lshlrev_b32 v10, 4, v10
    v_and_b32 v11, 1, v6
    v_lshl_add_u32 v10, v11, 3, v10
    v_lshrrev_b32 v11, 3, v6
    v_add_u32 v10, v10, v11
    v_lshl_add_u32 v10, v10, 2, v7
    s_and_b32 s28, s20, 0xffff0000
    s_ashr_i32 s29, s28, 31
    s_not_b32 s29, s29
    s_or_b32 s29, s29, 0x80000000
    s_xor_b32 s28, s28, s29
    s_and_b32 s30, s28, 0xffff0000
    s_and_b32 s28, s21, 0xffff0000
    s_ashr_i32 s29, s28, 31
    s_not_b32 s29, s29
    s_or_b32 s29, s29, 0x80000000
    s_xor_b32 s28, s28, s29
    s_and_b32 s31, s28, 0xffff0000
    v_cmp_eq_u32 vcc, 1, v4
    v_mov_b32 v8, s30
    v_mov_b32 v9, s31
    v_cndmask_b32 v8, v8, v9, vcc
    v_mul_f32 v8, 0xbfb8aa3b, v8
    v_exp_f32 v8, v8
    s_nop 0
    v_add_f32 v8, 1.0, v8
    v_rcp_f32 v8, v8
    s_nop 0
    v_cvt_pk_bf16_f32 v8, 0, v8
    s_waitcnt vmcnt(0)
    v_add_f32 v64, v64, v66
    v_add_f32 v65, v65, v67
    v_add_f32 v64, v64, v68
    v_add_f32 v65, v65, v69
    v_add_f32 v64, v64, v70
    v_add_f32 v65, v65, v71
    v_add_f32 v64, v64, v72
    v_add_f32 v65, v65, v73
    v_add_f32 v64, v64, v74
    v_add_f32 v65, v65, v75
    v_add_f32 v64, v64, v76
    v_add_f32 v65, v65, v77
    v_add_f32 v64, v64, v78
    v_add_f32 v65, v65, v79
    v_add_f32 v64, v64, v80
    v_add_f32 v65, v65, v81
    v_add_f32 v64, v64, v82
    v_add_f32 v65, v65, v83
    v_add_f32 v64, v64, v84
    v_add_f32 v65, v65, v85
    v_add_f32 v64, v64, v86
    v_add_f32 v65, v65, v87
    v_add_f32 v64, v64, v88
    v_add_f32 v65, v65, v89
    v_add_f32 v64, v64, v90
    v_add_f32 v65, v65, v91
    v_add_f32 v64, v64, v92
    v_add_f32 v65, v65, v93
    v_add_f32 v64, v64, v94
    v_add_f32 v65, v65, v95
    v_add_f32 v64, v64, v96
    v_add_f32 v65, v65, v97
    v_add_f32 v64, v64, v98
    v_add_f32 v65, v65, v99
    v_add_f32 v64, v64, v100
    v_add_f32 v65, v65, v101
    v_add_f32 v64, v64, v102
    v_add_f32 v65, v65, v103
    v_add_f32 v64, v64, v104
    v_add_f32 v65, v65, v105
    v_add_f32 v64, v64, v106
    v_add_f32 v65, v65, v107
    v_add_f32 v64, v64, v108
    v_add_f32 v65, v65, v109
    v_add_f32 v64, v64, v110
    v_add_f32 v65, v65, v111
    v_add_f32 v64, v64, v112
    v_add_f32 v65, v65, v113
    v_add_f32 v64, v64, v114
    v_add_f32 v65, v65, v115
    v_add_f32 v64, v64, v116
    v_add_f32 v65, v65, v117
    v_cvt_pk_bf16_f32 v64, 0, v64
    v_mul_f32 v64, v64, v8
    v_cvt_pk_bf16_f32 v64, 0, v64
    v_cvt_pk_bf16_f32 v65, 0, v65
    v_mul_f32 v65, v65, v8
    v_cvt_pk_bf16_f32 v65, 0, v65
    s_add_u32 s26, s27, 13500416
    buffer_store_dword v64, v10, s[4:7], s26 offen sc1
    buffer_store_dword v65, v10, s[4:7], s26 offen offset:16 sc1
    s_waitcnt vmcnt(0)
    v_mov_b32 v4, 168
    v_mov_b32 v5, 1
    s_mov_b64 exec, 1
    buffer_atomic_add v5, v4, s[56:59], 0 offen
    s_mov_b64 exec, -1
LH_next:
    s_cmp_ge_u32 s35, 256
    s_cbranch_scc1 LH_exit
    s_add_u32 s35, s35, 40
    s_cmp_lt_u32 s35, 256
    s_cbranch_scc1 LH_exit
    s_cmp_ge_u32 s35, 270
    s_cbranch_scc1 LH_exit
    s_nop 1
    s_branch LH_gdone
LH_exit:
    s_endpgm
.section .rodata,"a"
.p2align 6
.amdhsa_kernel k2_kernel
  .amdhsa_next_free_vgpr 168
  .amdhsa_next_free_sgpr 72
  .amdhsa_accum_offset 168
  .amdhsa_group_segment_fixed_size 0
  .amdhsa_kernarg_size 88
  .amdhsa_user_sgpr_count 2
  .amdhsa_user_sgpr_kernarg_segment_ptr 1
  .amdhsa_system_sgpr_workgroup_id_x 1
.end_amdhsa_kernel
.text
```
